```python
import torch

def _softmax(x, axis=-1):
    return torch.softmax(x, dim=axis)
def _gelu(x):
    return torch.nn.functional.gelu(x, approximate="tanh")
def _silu(x):
    return torch.nn.functional.silu(x)
def _sigmoid(x):
    return torch.sigmoid(x)
def _layernorm(x, axis=-1, eps=1e-5):
    m = x.mean(dim=axis, keepdim=True)
    v = x.var(dim=axis, keepdim=True, unbiased=False)
    return (x - m) / torch.sqrt(v + eps)
def _scatter_add(tgt, idx, src, axis=0):
    return tgt.clone().index_add_(axis, idx, src)
def _segment_sum(src, seg, n):
    out = torch.zeros((n,) + src.shape[1:], dtype=src.dtype)
    return out.index_add_(0, seg, src)
def _pad(x, pw):
    flat = tuple(v for pair in reversed(pw) for v in pair)
    return torch.nn.functional.pad(x, flat)

kernel_name = 'concat_heads__mha_block_cached__gqa_block_cached__near_ridge'

def setup_inputs():

    _w = (lambda a: (lambda t: t.to(torch.bfloat16) if t.is_floating_point() else t)(torch.as_tensor(a)))
    def _A_setup():
        B, Sq, D = 16, 32, 1024
        H, Sk, Dh = 32, 32, 128
        return {
            "x": _w((lambda *s: torch.randn(*s, dtype=torch.bfloat16) * 0.8)(B, Sq, D)),
            "k_cache": _w((lambda *s: torch.randn(*s, dtype=torch.bfloat16) * 0.8)(B, H, Sk, Dh)),
            "v_cache": _w((lambda *s: torch.randn(*s, dtype=torch.bfloat16) * 0.05)(B, H, Sk, Dh)),
            "wq": _w((lambda *s: torch.randn(*s, dtype=torch.bfloat16) * 0.8)(D, H * Dh) * (D ** -0.5)),
            "wo": _w((lambda *s: torch.randn(*s, dtype=torch.bfloat16) * 0.05)(H * Dh, D) * ((H * Dh) ** -0.5)),
        }
    _A_in = _A_setup()

    def _B_setup():
        B, Sq, D = 16, 32, 1024
        Hq, Hkv, Sk, Dh = 32, 32, 32, 128
        assert Hq % Hkv == 0, (Hq, Hkv)
        return {
            "x": _w((lambda *s: torch.randn(*s, dtype=torch.bfloat16) * 0.8)(B, Sq, D)),
            "k_cache": _w((lambda *s: torch.randn(*s, dtype=torch.bfloat16) * 0.8)(B, Hkv, Sk, Dh)),
            "v_cache": _w((lambda *s: torch.randn(*s, dtype=torch.bfloat16) * 0.05)(B, Hkv, Sk, Dh)),
            "wq": _w((lambda *s: torch.randn(*s, dtype=torch.bfloat16) * 0.8)(D, Hq * Dh) * (D ** -0.5)),
            "wo": _w((lambda *s: torch.randn(*s, dtype=torch.bfloat16) * 0.05)(Hq * Dh, D) * ((Hq * Dh) ** -0.5)),
        }
    _B_in = _B_setup()

    return {
        "A_x": _A_in["x"],
        "A_k_cache": _A_in["k_cache"],
        "A_v_cache": _A_in["v_cache"],
        "A_wq": _A_in["wq"],
        "A_wo": _A_in["wo"],
        "B_x": _B_in["x"],
        "B_k_cache": _B_in["k_cache"],
        "B_v_cache": _B_in["v_cache"],
        "B_wq": _B_in["wq"],
        "B_wo": _B_in["wo"],
    }

def reference(A_x, A_k_cache, A_v_cache, A_wq, A_wo, B_x, B_k_cache, B_v_cache, B_wq, B_wo):
    def _A_ref(x, k_cache, v_cache, wq, wo):
        B, Sq, D = x.shape
        H, Dh = 32, 128
        q = (lambda x, *d: x.permute(*d))((x @ wq).reshape(B, Sq, H, Dh), 0, 2, 1, 3)
        scores = torch.einsum("bhqd,bhkd->bhqk", q, k_cache) * (Dh ** -0.5)
        p = _softmax(scores, axis=-1)
        o = torch.einsum("bhqk,bhkd->bhqd", p, v_cache)
        return (lambda x, *d: x.permute(*d))(o, 0, 2, 1, 3).reshape(B, Sq, H * Dh) @ wo

    def _B_ref(x, k_cache, v_cache, wq, wo):
        B, Sq, D = x.shape
        Hq, Dh = 32, 128
        Hkv = k_cache.shape[1]
        rep = Hq // Hkv
        q = (lambda x, *d: x.permute(*d))((x @ wq).reshape(B, Sq, Hq, Dh), 0, 2, 1, 3)
        k = (lambda x, n, axis: torch.repeat_interleave(x, n, dim=axis))(k_cache, rep, axis=1)
        v = (lambda x, n, axis: torch.repeat_interleave(x, n, dim=axis))(v_cache, rep, axis=1)
        scores = torch.einsum("bhqd,bhkd->bhqk", q, k) * (Dh ** -0.5)
        p = _softmax(scores, axis=-1)
        o = torch.einsum("bhqk,bhkd->bhqd", p, v)
        return (lambda x, *d: x.permute(*d))(o, 0, 2, 1, 3).reshape(B, Sq, Hq * Dh) @ wo

    a = _A_ref(A_x, A_k_cache, A_v_cache, A_wq, A_wo)
    b = _B_ref(B_x, B_k_cache, B_v_cache, B_wq, B_wo)
    return torch.concatenate([a, b], axis=-1)
```

```asm
; @launch grid=(256,1,1) block=(512,1,1) lds=163840
.amdgcn_target "amdgcn-amd-amdhsa--gfx950"
.text
.globl concat_heads__mha_block_cached__gqa_block_cached__near_ridge_kernel
.p2align 8
.type concat_heads__mha_block_cached__gqa_block_cached__near_ridge_kernel,@function
concat_heads__mha_block_cached__gqa_block_cached__near_ridge_kernel:
    s_cmp_ge_u32 s2, 256
    s_cbranch_scc1 K_END
    s_load_dwordx16 s[16:31], s[0:1], 0
    s_load_dwordx8 s[32:39], s[0:1], 64
    s_load_dwordx2 s[40:41], s[0:1], 96
    s_and_b32 s3, s2, 7
    s_lshr_b32 s4, s2, 3
    s_lshr_b32 s5, s3, 2
    s_and_b32 s6, s3, 3
    s_and_b32 s7, s4, 7
    s_lshr_b32 s4, s4, 3
    v_lshrrev_b32 v1, 6, v0
    v_and_b32 v2, 63, v0
    s_sub_u32 s15, s7, s4
    v_readfirstlane_b32 s14, v1
    s_and_b32 s15, s15, 7
    s_lshl_b32 s12, s6, 3
    s_add_u32 s12, s12, s7
    v_lshlrev_b32 v10, 4, v2
    s_cmp_lt_u32 s14, 4
    s_cbranch_scc1 COMPUTE
    s_and_b32 s8, s14, 3
    s_lshl_b32 s9, s4, 2
    s_add_u32 s9, s9, s8
    s_mov_b32 s44, 15360
    v_lshrrev_b32 v3, 3, v2
    v_and_b32 v4, 7, v2
    v_lshrrev_b32 v5, 4, v2
    s_lshl_b32 s10, s9, 16
    v_xor_b32 v6, v5, v4
    v_lshlrev_b32 v8, 4, v6
    v_xor_b32 v9, 64, v8
    v_lshl_add_u32 v6, v3, 11, s10
    v_add_u32 v16, v6, v8
    v_add3_u32 v17, v6, v9, s44
    v_add_u32 v18, 30720, v16
    v_add_u32 v19, 30720, v17
    v_and_b32 v6, 15, v2
    v_lshlrev_b32 v7, 2, v5
    v_xor_b32 v6, v6, v7
    v_lshlrev_b32 v12, 4, v6
    s_lshl_b32 s10, s8, 17
    s_lshl_b32 s13, s12, 8
    s_add_u32 s10, s10, s13
    v_lshl_add_u32 v6, v5, 13, v12
    v_add_u32 v20, s10, v6
    v_add_u32 v21, 31744, v20
    v_add_u32 v22, 63456, v20
    v_add_u32 v23, 95200, v20
    s_lshl_b32 s78, s4, 1
    s_add_u32 s78, s78, s7
    s_and_b32 s78, s78, 7
    s_lshl_b32 s79, s78, 20
    s_lshl_b32 s78, s78, 8
    s_mul_i32 s77, s8, 4128
    s_lshl_b32 m0, s8, 12
    s_mov_b32 s46, 1048576
    s_mov_b32 s47, 0x00020000
    s_mov_b32 s58, 8388608
    s_mov_b32 s59, 0x00020000
    s_cmp_eq_u32 s5, 1
    s_waitcnt lgkmcnt(0)
    s_cselect_b64 s[44:45], s[26:27], s[16:17]
    s_cselect_b64 s[56:57], s[32:33], s[22:23]
    buffer_load_dwordx4 v16, s[44:47], s78 offen offset:0  lds
    buffer_load_dwordx4 v17, s[44:47], s78 offen offset:1024  lds
    buffer_load_dwordx4 v18, s[44:47], s78 offen offset:2048  lds
    buffer_load_dwordx4 v19, s[44:47], s78 offen offset:3072  lds
    s_cselect_b32 s48, s28, s18
    s_cselect_b32 s49, s29, s19
    s_mov_b32 s50, 0x400000
    s_mov_b32 s51, 0x00020000
    s_cselect_b32 s52, s30, s20
    s_cselect_b32 s53, s31, s21
    s_mov_b32 s54, 0x400000
    s_mov_b32 s55, 0x00020000
    s_cselect_b32 s60, s34, s24
    s_cselect_b32 s61, s35, s25
    s_mov_b32 s62, 0x800000
    s_mov_b32 s63, 0x00020000
    s_add_u32 m0, s77, 65536
    s_nop 0
    buffer_load_dwordx4 v20, s[56:59], s79 offen offset:0  lds
    buffer_load_dwordx4 v21, s[56:59], s79 offen offset:1024  lds
    buffer_load_dwordx4 v22, s[56:59], s79 offen offset:2080  lds
    buffer_load_dwordx4 v23, s[56:59], s79 offen offset:3104  lds
    s_mov_b32 s64, s40
    s_mov_b32 s65, s41
    s_mov_b32 s66, 0x1000000
    s_mov_b32 s67, 0x00020000
    s_mov_b32 s72, s38
    s_mov_b32 s73, s39
    s_mov_b32 s74, 0x100
    s_mov_b32 s75, 0x00020000
    s_lshl_b32 s27, s8, 12
    s_mov_b32 s18, s77
    s_lshl_b32 s28, s7, 1
    s_lshl_b32 s11, s9, 5
    s_lshl_b32 s13, s6, 3
    s_add_u32 s11, s11, s13
    s_lshl_b32 s11, s11, 13
    v_add_u32 v7, 0, v3
    v_lshl_add_u32 v6, v7, 8, v8
    v_add_u32 v6, s11, v6
    v_subrev_u32 v24, 0, v6
    v_add_u32 v7, 8, v3
    v_lshl_add_u32 v6, v7, 8, v9
    v_add_u32 v6, s11, v6
    v_subrev_u32 v25, 1024, v6
    v_add_u32 v7, 16, v3
    v_lshl_add_u32 v6, v7, 8, v8
    v_add_u32 v6, s11, v6
    v_subrev_u32 v26, 2048, v6
    v_add_u32 v7, 24, v3
    v_lshl_add_u32 v6, v7, 8, v9
    v_add_u32 v6, s11, v6
    v_subrev_u32 v27, 3072, v6
    s_lshl_b32 s10, s8, 15
    s_lshl_b32 s13, s15, 8
    s_add_u32 s10, s10, s13
    s_lshl_b32 s13, s6, 21
    s_add_u32 s10, s10, s13
    v_lshl_add_u32 v6, v5, 11, v12
    v_add_u32 v28, s10, v6
    v_add_u32 v29, 7168, v28
    v_add_u32 v30, 14304, v28
    v_add_u32 v31, 21472, v28
    v_and_b32 v6, 7, v2
    v_lshlrev_b32 v32, 3, v6
    s_lshl_b32 s30, s5, 4
    s_add_u32 s30, s30, s9
    s_lshl_b32 s30, s30, 2
    s_add_u32 s30, s30, s6
    s_lshl_b32 s32, s30, 7
    s_add_u32 s32, s32, 2097152
    s_lshl_b32 s34, s30, 14
    s_mul_i32 s35, s8, 6144
    s_add_u32 s35, s35, 131584
    v_lshlrev_b32 v39, 2, v2
    s_cmp_eq_u32 s4, 1
    s_cbranch_scc1 LOADER1
    s_cmp_eq_u32 s4, 2
    s_cbranch_scc1 LOADER2
    s_cmp_eq_u32 s4, 3
    s_cbranch_scc1 LOADER3
    s_add_u32 s26, s28, 4
    s_and_b32 s26, s26, 15
    s_lshl_b32 s24, s26, 7
    s_lshl_b32 s25, s26, 19
    s_add_u32 m0, s27, 16384
    s_nop 0
    buffer_load_dwordx4 v16, s[44:47], s24 offen offset:0  lds
    buffer_load_dwordx4 v17, s[44:47], s24 offen offset:1024  lds
    buffer_load_dwordx4 v18, s[44:47], s24 offen offset:2048  lds
    buffer_load_dwordx4 v19, s[44:47], s24 offen offset:3072  lds
    s_add_u32 m0, s18, 82048
    s_nop 0
    buffer_load_dwordx4 v20, s[56:59], s25 offen offset:0  lds
    buffer_load_dwordx4 v21, s[56:59], s25 offen offset:1024  lds
    buffer_load_dwordx4 v22, s[56:59], s25 offen offset:2080  lds
    buffer_load_dwordx4 v23, s[56:59], s25 offen offset:3104  lds
    s_waitcnt vmcnt(8)
    s_barrier
    s_add_u32 s26, s28, 8
    s_and_b32 s26, s26, 15
    s_lshl_b32 s24, s26, 7
    s_lshl_b32 s25, s26, 19
    s_add_u32 m0, s27, 32768
    s_nop 0
    buffer_load_dwordx4 v16, s[44:47], s24 offen offset:0  lds
    buffer_load_dwordx4 v17, s[44:47], s24 offen offset:1024  lds
    buffer_load_dwordx4 v18, s[44:47], s24 offen offset:2048  lds
    buffer_load_dwordx4 v19, s[44:47], s24 offen offset:3072  lds
    s_add_u32 m0, s18, 98560
    s_nop 0
    buffer_load_dwordx4 v20, s[56:59], s25 offen offset:0  lds
    buffer_load_dwordx4 v21, s[56:59], s25 offen offset:1024  lds
    buffer_load_dwordx4 v22, s[56:59], s25 offen offset:2080  lds
    buffer_load_dwordx4 v23, s[56:59], s25 offen offset:3104  lds
    s_waitcnt vmcnt(8)
    s_barrier
    s_add_u32 s26, s28, 12
    s_and_b32 s26, s26, 15
    s_lshl_b32 s24, s26, 7
    s_lshl_b32 s25, s26, 19
    s_add_u32 m0, s27, 49152
    s_nop 0
    buffer_load_dwordx4 v16, s[44:47], s24 offen offset:0  lds
    buffer_load_dwordx4 v17, s[44:47], s24 offen offset:1024  lds
    buffer_load_dwordx4 v18, s[44:47], s24 offen offset:2048  lds
    buffer_load_dwordx4 v19, s[44:47], s24 offen offset:3072  lds
    s_add_u32 m0, s18, 115072
    s_nop 0
    buffer_load_dwordx4 v20, s[56:59], s25 offen offset:0  lds
    buffer_load_dwordx4 v21, s[56:59], s25 offen offset:1024  lds
    buffer_load_dwordx4 v22, s[56:59], s25 offen offset:2080  lds
    buffer_load_dwordx4 v23, s[56:59], s25 offen offset:3104  lds
    s_waitcnt vmcnt(8)
    s_barrier
    s_add_u32 s26, s28, 2
    s_and_b32 s26, s26, 15
    s_lshl_b32 s24, s26, 7
    s_lshl_b32 s25, s26, 19
    s_add_u32 m0, s27, 0
    s_nop 0
    buffer_load_dwordx4 v16, s[44:47], s24 offen offset:0  lds
    buffer_load_dwordx4 v17, s[44:47], s24 offen offset:1024  lds
    buffer_load_dwordx4 v18, s[44:47], s24 offen offset:2048  lds
    buffer_load_dwordx4 v19, s[44:47], s24 offen offset:3072  lds
    s_add_u32 m0, s18, 65536
    s_nop 0
    buffer_load_dwordx4 v20, s[56:59], s25 offen offset:0  lds
    buffer_load_dwordx4 v21, s[56:59], s25 offen offset:1024  lds
    buffer_load_dwordx4 v22, s[56:59], s25 offen offset:2080  lds
    buffer_load_dwordx4 v23, s[56:59], s25 offen offset:3104  lds
    s_lshl_b32 s24, s7, 13
    s_add_u32 m0, s27, 131584
    s_nop 0
    buffer_load_dwordx4 v24, s[48:51], s24 offen offset:0  lds
    buffer_load_dwordx4 v25, s[48:51], s24 offen offset:1024  lds
    buffer_load_dwordx4 v26, s[48:51], s24 offen offset:2048  lds
    buffer_load_dwordx4 v27, s[48:51], s24 offen offset:3072  lds
    s_waitcnt vmcnt(12)
    s_barrier
    s_add_u32 s26, s28, 6
    s_and_b32 s26, s26, 15
    s_lshl_b32 s24, s26, 7
    s_lshl_b32 s25, s26, 19
    s_add_u32 m0, s27, 16384
    s_nop 0
    buffer_load_dwordx4 v16, s[44:47], s24 offen offset:0  lds
    buffer_load_dwordx4 v17, s[44:47], s24 offen offset:1024  lds
    buffer_load_dwordx4 v18, s[44:47], s24 offen offset:2048  lds
    buffer_load_dwordx4 v19, s[44:47], s24 offen offset:3072  lds
    s_add_u32 m0, s18, 82048
    s_nop 0
    buffer_load_dwordx4 v20, s[56:59], s25 offen offset:0  lds
    buffer_load_dwordx4 v21, s[56:59], s25 offen offset:1024  lds
    buffer_load_dwordx4 v22, s[56:59], s25 offen offset:2080  lds
    buffer_load_dwordx4 v23, s[56:59], s25 offen offset:3104  lds
    s_waitcnt vmcnt(8)
    s_barrier
    buffer_load_dwordx2 v[36:37], off, s[72:75], 0 sc1
    s_add_u32 s26, s28, 10
    s_and_b32 s26, s26, 15
    s_lshl_b32 s24, s26, 7
    s_lshl_b32 s25, s26, 19
    s_add_u32 m0, s27, 32768
    s_nop 0
    buffer_load_dwordx4 v16, s[44:47], s24 offen offset:0  lds
    buffer_load_dwordx4 v17, s[44:47], s24 offen offset:1024  lds
    buffer_load_dwordx4 v18, s[44:47], s24 offen offset:2048  lds
    buffer_load_dwordx4 v19, s[44:47], s24 offen offset:3072  lds
    s_add_u32 m0, s18, 98560
    s_nop 0
    buffer_load_dwordx4 v20, s[56:59], s25 offen offset:0  lds
    buffer_load_dwordx4 v21, s[56:59], s25 offen offset:1024  lds
    buffer_load_dwordx4 v22, s[56:59], s25 offen offset:2080  lds
    buffer_load_dwordx4 v23, s[56:59], s25 offen offset:3104  lds
    s_waitcnt vmcnt(8)
    s_mov_b32 s20, 1048576
TG0:
    v_cmp_eq_u64 vcc, 0, v[36:37]
    s_cbranch_vccz TGOK0
    s_sub_u32 s20, s20, 1
    s_cbranch_scc1 TGOK0
    s_sleep 1
    buffer_load_dwordx2 v[36:37], off, s[72:75], 0 sc1
    s_waitcnt vmcnt(0)
    s_branch TG0
TGOK0:
    s_mov_b32 m0, 162848
    s_mov_b64 exec, 3
    buffer_load_dword v39, s[72:75], 0 offen sc1 lds
    s_mov_b64 exec, -1
    s_barrier
    s_add_u32 s26, s28, 14
    s_and_b32 s26, s26, 15
    s_lshl_b32 s24, s26, 7
    s_lshl_b32 s25, s26, 19
    s_add_u32 m0, s27, 49152
    s_nop 0
    buffer_load_dwordx4 v16, s[44:47], s24 offen offset:0  lds
    buffer_load_dwordx4 v17, s[44:47], s24 offen offset:1024  lds
    buffer_load_dwordx4 v18, s[44:47], s24 offen offset:2048  lds
    buffer_load_dwordx4 v19, s[44:47], s24 offen offset:3072  lds
    s_add_u32 m0, s18, 115072
    s_nop 0
    buffer_load_dwordx4 v20, s[56:59], s25 offen offset:0  lds
    buffer_load_dwordx4 v21, s[56:59], s25 offen offset:1024  lds
    buffer_load_dwordx4 v22, s[56:59], s25 offen offset:2080  lds
    buffer_load_dwordx4 v23, s[56:59], s25 offen offset:3104  lds
    s_waitcnt vmcnt(8)
    s_barrier
    s_add_u32 s26, s28, 1
    s_and_b32 s26, s26, 15
    s_lshl_b32 s24, s26, 7
    s_lshl_b32 s25, s26, 19
    s_add_u32 m0, s27, 0
    s_nop 0
    buffer_load_dwordx4 v16, s[44:47], s24 offen offset:0  lds
    buffer_load_dwordx4 v17, s[44:47], s24 offen offset:1024  lds
    buffer_load_dwordx4 v18, s[44:47], s24 offen offset:2048  lds
    buffer_load_dwordx4 v19, s[44:47], s24 offen offset:3072  lds
    s_add_u32 m0, s18, 65536
    s_nop 0
    buffer_load_dwordx4 v20, s[56:59], s25 offen offset:0  lds
    buffer_load_dwordx4 v21, s[56:59], s25 offen offset:1024  lds
    buffer_load_dwordx4 v22, s[56:59], s25 offen offset:2080  lds
    buffer_load_dwordx4 v23, s[56:59], s25 offen offset:3104  lds
    s_waitcnt vmcnt(8)
    s_barrier
    s_add_u32 s26, s28, 3
    s_and_b32 s26, s26, 15
    s_lshl_b32 s24, s26, 7
    s_lshl_b32 s25, s26, 19
    s_add_u32 m0, s27, 16384
    s_nop 0
    buffer_load_dwordx4 v16, s[44:47], s24 offen offset:0  lds
    buffer_load_dwordx4 v17, s[44:47], s24 offen offset:1024  lds
    buffer_load_dwordx4 v18, s[44:47], s24 offen offset:2048  lds
    buffer_load_dwordx4 v19, s[44:47], s24 offen offset:3072  lds
    s_add_u32 m0, s18, 82048
    s_nop 0
    buffer_load_dwordx4 v20, s[56:59], s25 offen offset:0  lds
    buffer_load_dwordx4 v21, s[56:59], s25 offen offset:1024  lds
    buffer_load_dwordx4 v22, s[56:59], s25 offen offset:2080  lds
    buffer_load_dwordx4 v23, s[56:59], s25 offen offset:3104  lds
    s_lshl_b32 s24, s7, 13
    s_add_u32 s24, s24, 128
    s_add_u32 m0, s27, 131584
    s_nop 0
    buffer_load_dwordx4 v24, s[48:51], s24 offen offset:0  lds
    buffer_load_dwordx4 v25, s[48:51], s24 offen offset:1024  lds
    buffer_load_dwordx4 v26, s[48:51], s24 offen offset:2048  lds
    buffer_load_dwordx4 v27, s[48:51], s24 offen offset:3072  lds
    s_waitcnt vmcnt(12)
    s_barrier
    s_add_u32 s26, s28, 5
    s_and_b32 s26, s26, 15
    s_lshl_b32 s24, s26, 7
    s_lshl_b32 s25, s26, 19
    s_add_u32 m0, s27, 32768
    s_nop 0
    buffer_load_dwordx4 v16, s[44:47], s24 offen offset:0  lds
    buffer_load_dwordx4 v17, s[44:47], s24 offen offset:1024  lds
    buffer_load_dwordx4 v18, s[44:47], s24 offen offset:2048  lds
    buffer_load_dwordx4 v19, s[44:47], s24 offen offset:3072  lds
    s_add_u32 m0, s18, 98560
    s_nop 0
    buffer_load_dwordx4 v20, s[56:59], s25 offen offset:0  lds
    buffer_load_dwordx4 v21, s[56:59], s25 offen offset:1024  lds
    buffer_load_dwordx4 v22, s[56:59], s25 offen offset:2080  lds
    buffer_load_dwordx4 v23, s[56:59], s25 offen offset:3104  lds
    s_waitcnt vmcnt(8)
    s_barrier
    s_add_u32 s26, s28, 9
    s_and_b32 s26, s26, 15
    s_lshl_b32 s24, s26, 7
    s_lshl_b32 s25, s26, 19
    s_add_u32 m0, s27, 49152
    s_nop 0
    buffer_load_dwordx4 v16, s[44:47], s24 offen offset:0  lds
    buffer_load_dwordx4 v17, s[44:47], s24 offen offset:1024  lds
    buffer_load_dwordx4 v18, s[44:47], s24 offen offset:2048  lds
    buffer_load_dwordx4 v19, s[44:47], s24 offen offset:3072  lds
    s_add_u32 m0, s18, 115072
    s_nop 0
    buffer_load_dwordx4 v20, s[56:59], s25 offen offset:0  lds
    buffer_load_dwordx4 v21, s[56:59], s25 offen offset:1024  lds
    buffer_load_dwordx4 v22, s[56:59], s25 offen offset:2080  lds
    buffer_load_dwordx4 v23, s[56:59], s25 offen offset:3104  lds
    s_waitcnt vmcnt(8)
    s_barrier
    s_add_u32 s26, s28, 13
    s_and_b32 s26, s26, 15
    s_lshl_b32 s24, s26, 7
    s_lshl_b32 s25, s26, 19
    s_add_u32 m0, s27, 0
    s_nop 0
    buffer_load_dwordx4 v16, s[44:47], s24 offen offset:0  lds
    buffer_load_dwordx4 v17, s[44:47], s24 offen offset:1024  lds
    buffer_load_dwordx4 v18, s[44:47], s24 offen offset:2048  lds
    buffer_load_dwordx4 v19, s[44:47], s24 offen offset:3072  lds
    s_add_u32 m0, s18, 65536
    s_nop 0
    buffer_load_dwordx4 v20, s[56:59], s25 offen offset:0  lds
    buffer_load_dwordx4 v21, s[56:59], s25 offen offset:1024  lds
    buffer_load_dwordx4 v22, s[56:59], s25 offen offset:2080  lds
    buffer_load_dwordx4 v23, s[56:59], s25 offen offset:3104  lds
    s_waitcnt vmcnt(8)
    s_barrier
    s_add_u32 s26, s28, 7
    s_and_b32 s26, s26, 15
    s_lshl_b32 s24, s26, 7
    s_lshl_b32 s25, s26, 19
    s_add_u32 m0, s27, 16384
    s_nop 0
    buffer_load_dwordx4 v16, s[44:47], s24 offen offset:0  lds
    buffer_load_dwordx4 v17, s[44:47], s24 offen offset:1024  lds
    buffer_load_dwordx4 v18, s[44:47], s24 offen offset:2048  lds
    buffer_load_dwordx4 v19, s[44:47], s24 offen offset:3072  lds
    s_add_u32 m0, s18, 82048
    s_nop 0
    buffer_load_dwordx4 v20, s[56:59], s25 offen offset:0  lds
    buffer_load_dwordx4 v21, s[56:59], s25 offen offset:1024  lds
    buffer_load_dwordx4 v22, s[56:59], s25 offen offset:2080  lds
    buffer_load_dwordx4 v23, s[56:59], s25 offen offset:3104  lds
    s_waitcnt vmcnt(8)
    s_barrier
    s_add_u32 s26, s28, 11
    s_and_b32 s26, s26, 15
    s_lshl_b32 s24, s26, 7
    s_lshl_b32 s25, s26, 19
    s_add_u32 m0, s27, 32768
    s_nop 0
    buffer_load_dwordx4 v16, s[44:47], s24 offen offset:0  lds
    buffer_load_dwordx4 v17, s[44:47], s24 offen offset:1024  lds
    buffer_load_dwordx4 v18, s[44:47], s24 offen offset:2048  lds
    buffer_load_dwordx4 v19, s[44:47], s24 offen offset:3072  lds
    s_add_u32 m0, s18, 98560
    s_nop 0
    buffer_load_dwordx4 v20, s[56:59], s25 offen offset:0  lds
    buffer_load_dwordx4 v21, s[56:59], s25 offen offset:1024  lds
    buffer_load_dwordx4 v22, s[56:59], s25 offen offset:2080  lds
    buffer_load_dwordx4 v23, s[56:59], s25 offen offset:3104  lds
    s_waitcnt vmcnt(8)
    s_barrier
    s_add_u32 s26, s28, 15
    s_and_b32 s26, s26, 15
    s_lshl_b32 s24, s26, 7
    s_lshl_b32 s25, s26, 19
    s_add_u32 m0, s27, 49152
    s_nop 0
    buffer_load_dwordx4 v16, s[44:47], s24 offen offset:0  lds
    buffer_load_dwordx4 v17, s[44:47], s24 offen offset:1024  lds
    buffer_load_dwordx4 v18, s[44:47], s24 offen offset:2048  lds
    buffer_load_dwordx4 v19, s[44:47], s24 offen offset:3072  lds
    s_add_u32 m0, s18, 115072
    s_nop 0
    buffer_load_dwordx4 v20, s[56:59], s25 offen offset:0  lds
    buffer_load_dwordx4 v21, s[56:59], s25 offen offset:1024  lds
    buffer_load_dwordx4 v22, s[56:59], s25 offen offset:2080  lds
    buffer_load_dwordx4 v23, s[56:59], s25 offen offset:3104  lds
    s_waitcnt vmcnt(8)
    s_barrier
    s_add_u32 s26, s15, 0
    s_and_b32 s26, s26, 7
    s_lshl_b32 s24, s26, 13
    s_lshl_b32 s25, s26, 18
    s_add_u32 m0, s27, 0
    s_nop 0
    buffer_load_dwordx4 v24, s[52:55], s24 offen offset:0  lds
    buffer_load_dwordx4 v25, s[52:55], s24 offen offset:1024  lds
    buffer_load_dwordx4 v26, s[52:55], s24 offen offset:2048  lds
    buffer_load_dwordx4 v27, s[52:55], s24 offen offset:3072  lds
    s_add_u32 m0, s18, 65536
    s_nop 0
    buffer_load_dwordx4 v28, s[60:63], s25 offen offset:0  lds
    buffer_load_dwordx4 v29, s[60:63], s25 offen offset:1024  lds
    buffer_load_dwordx4 v30, s[60:63], s25 offen offset:2080  lds
    buffer_load_dwordx4 v31, s[60:63], s25 offen offset:3104  lds
    s_waitcnt vmcnt(8)
    s_barrier
    s_add_u32 s26, s15, 0
    s_and_b32 s26, s26, 7
    s_lshl_b32 s24, s26, 13
    s_lshl_b32 s25, s26, 18
    s_add_u32 s24, s24, 128
    s_add_u32 s25, s25, 131072
    s_add_u32 m0, s27, 16384
    s_nop 0
    buffer_load_dwordx4 v24, s[52:55], s24 offen offset:0  lds
    buffer_load_dwordx4 v25, s[52:55], s24 offen offset:1024  lds
    buffer_load_dwordx4 v26, s[52:55], s24 offen offset:2048  lds
    buffer_load_dwordx4 v27, s[52:55], s24 offen offset:3072  lds
    s_add_u32 m0, s18, 82048
    s_nop 0
    buffer_load_dwordx4 v28, s[60:63], s25 offen offset:0  lds
    buffer_load_dwordx4 v29, s[60:63], s25 offen offset:1024  lds
    buffer_load_dwordx4 v30, s[60:63], s25 offen offset:2080  lds
    buffer_load_dwordx4 v31, s[60:63], s25 offen offset:3104  lds
    s_waitcnt vmcnt(8)
    s_barrier
    s_add_u32 s26, s15, 1
    s_and_b32 s26, s26, 7
    s_lshl_b32 s24, s26, 13
    s_lshl_b32 s25, s26, 18
    s_add_u32 m0, s27, 32768
    s_nop 0
    buffer_load_dwordx4 v24, s[52:55], s24 offen offset:0  lds
    buffer_load_dwordx4 v25, s[52:55], s24 offen offset:1024  lds
    buffer_load_dwordx4 v26, s[52:55], s24 offen offset:2048  lds
    buffer_load_dwordx4 v27, s[52:55], s24 offen offset:3072  lds
    s_add_u32 m0, s18, 98560
    s_nop 0
    buffer_load_dwordx4 v28, s[60:63], s25 offen offset:0  lds
    buffer_load_dwordx4 v29, s[60:63], s25 offen offset:1024  lds
    buffer_load_dwordx4 v30, s[60:63], s25 offen offset:2080  lds
    buffer_load_dwordx4 v31, s[60:63], s25 offen offset:3104  lds
    s_waitcnt vmcnt(8)
    s_barrier
    s_add_u32 s26, s15, 1
    s_and_b32 s26, s26, 7
    s_lshl_b32 s24, s26, 13
    s_lshl_b32 s25, s26, 18
    s_add_u32 s24, s24, 128
    s_add_u32 s25, s25, 131072
    s_add_u32 m0, s27, 49152
    s_nop 0
    buffer_load_dwordx4 v24, s[52:55], s24 offen offset:0  lds
    buffer_load_dwordx4 v25, s[52:55], s24 offen offset:1024  lds
    buffer_load_dwordx4 v26, s[52:55], s24 offen offset:2048  lds
    buffer_load_dwordx4 v27, s[52:55], s24 offen offset:3072  lds
    s_add_u32 m0, s18, 115072
    s_nop 0
    buffer_load_dwordx4 v28, s[60:63], s25 offen offset:0  lds
    buffer_load_dwordx4 v29, s[60:63], s25 offen offset:1024  lds
    buffer_load_dwordx4 v30, s[60:63], s25 offen offset:2080  lds
    buffer_load_dwordx4 v31, s[60:63], s25 offen offset:3104  lds
    s_waitcnt vmcnt(8)
    s_barrier
    s_add_u32 s26, s15, 4
    s_and_b32 s26, s26, 7
    s_lshl_b32 s24, s26, 13
    s_lshl_b32 s25, s26, 18
    s_add_u32 m0, s18, 65536
    s_nop 0
    buffer_load_dwordx4 v28, s[60:63], s25 offen offset:0  lds
    buffer_load_dwordx4 v29, s[60:63], s25 offen offset:1024  lds
    buffer_load_dwordx4 v30, s[60:63], s25 offen offset:2080  lds
    buffer_load_dwordx4 v31, s[60:63], s25 offen offset:3104  lds
    s_add_u32 m0, s27, 0
    s_nop 0
    buffer_load_dwordx4 v24, s[52:55], s24 offen offset:0  lds
    buffer_load_dwordx4 v25, s[52:55], s24 offen offset:1024  lds
    buffer_load_dwordx4 v26, s[52:55], s24 offen offset:2048  lds
    buffer_load_dwordx4 v27, s[52:55], s24 offen offset:3072  lds
    s_waitcnt vmcnt(8)
    s_barrier
    s_add_u32 s26, s15, 4
    s_and_b32 s26, s26, 7
    s_lshl_b32 s24, s26, 13
    s_lshl_b32 s25, s26, 18
    s_add_u32 s24, s24, 128
    s_add_u32 s25, s25, 131072
    s_add_u32 m0, s18, 82048
    s_nop 0
    buffer_load_dwordx4 v28, s[60:63], s25 offen offset:0  lds
    buffer_load_dwordx4 v29, s[60:63], s25 offen offset:1024  lds
    buffer_load_dwordx4 v30, s[60:63], s25 offen offset:2080  lds
    buffer_load_dwordx4 v31, s[60:63], s25 offen offset:3104  lds
    s_add_u32 m0, s27, 16384
    s_nop 0
    buffer_load_dwordx4 v24, s[52:55], s24 offen offset:0  lds
    buffer_load_dwordx4 v25, s[52:55], s24 offen offset:1024  lds
    buffer_load_dwordx4 v26, s[52:55], s24 offen offset:2048  lds
    buffer_load_dwordx4 v27, s[52:55], s24 offen offset:3072  lds
    s_waitcnt vmcnt(8)
    s_barrier
    s_add_u32 s26, s15, 2
    s_and_b32 s26, s26, 7
    s_lshl_b32 s24, s26, 13
    s_lshl_b32 s25, s26, 18
    s_add_u32 m0, s27, 32768
    s_nop 0
    buffer_load_dwordx4 v24, s[52:55], s24 offen offset:0  lds
    buffer_load_dwordx4 v25, s[52:55], s24 offen offset:1024  lds
    buffer_load_dwordx4 v26, s[52:55], s24 offen offset:2048  lds
    buffer_load_dwordx4 v27, s[52:55], s24 offen offset:3072  lds
    s_add_u32 m0, s18, 98560
    s_nop 0
    buffer_load_dwordx4 v28, s[60:63], s25 offen offset:0  lds
    buffer_load_dwordx4 v29, s[60:63], s25 offen offset:1024  lds
    buffer_load_dwordx4 v30, s[60:63], s25 offen offset:2080  lds
    buffer_load_dwordx4 v31, s[60:63], s25 offen offset:3104  lds
    s_waitcnt vmcnt(8)
    s_barrier
    s_add_u32 s26, s15, 2
    s_and_b32 s26, s26, 7
    s_lshl_b32 s24, s26, 13
    s_lshl_b32 s25, s26, 18
    s_add_u32 s24, s24, 128
    s_add_u32 s25, s25, 131072
    s_add_u32 m0, s27, 49152
    s_nop 0
    buffer_load_dwordx4 v24, s[52:55], s24 offen offset:0  lds
    buffer_load_dwordx4 v25, s[52:55], s24 offen offset:1024  lds
    buffer_load_dwordx4 v26, s[52:55], s24 offen offset:2048  lds
    buffer_load_dwordx4 v27, s[52:55], s24 offen offset:3072  lds
    s_add_u32 m0, s18, 115072
    s_nop 0
    buffer_load_dwordx4 v28, s[60:63], s25 offen offset:0  lds
    buffer_load_dwordx4 v29, s[60:63], s25 offen offset:1024  lds
    buffer_load_dwordx4 v30, s[60:63], s25 offen offset:2080  lds
    buffer_load_dwordx4 v31, s[60:63], s25 offen offset:3104  lds
    s_waitcnt vmcnt(8)
    s_barrier
    buffer_load_dwordx2 v[34:35], v32, s[64:67], s32 offen sc1
    s_add_u32 s26, s15, 3
    s_and_b32 s26, s26, 7
    s_lshl_b32 s24, s26, 13
    s_lshl_b32 s25, s26, 18
    s_add_u32 m0, s27, 0
    s_nop 0
    buffer_load_dwordx4 v24, s[52:55], s24 offen offset:0  lds
    buffer_load_dwordx4 v25, s[52:55], s24 offen offset:1024  lds
    buffer_load_dwordx4 v26, s[52:55], s24 offen offset:2048  lds
    buffer_load_dwordx4 v27, s[52:55], s24 offen offset:3072  lds
    s_add_u32 m0, s18, 65536
    s_nop 0
    buffer_load_dwordx4 v28, s[60:63], s25 offen offset:0  lds
    buffer_load_dwordx4 v29, s[60:63], s25 offen offset:1024  lds
    buffer_load_dwordx4 v30, s[60:63], s25 offen offset:2080  lds
    buffer_load_dwordx4 v31, s[60:63], s25 offen offset:3104  lds
    s_waitcnt vmcnt(8)
    s_barrier
    s_mov_b32 s20, 1048576
PC0:
    v_cmp_ne_u64 vcc, v[34:35], v[36:37]
    s_cbranch_vccz PG0
    s_sub_u32 s20, s20, 1
    s_cbranch_scc1 PG0
    buffer_load_dwordx2 v[34:35], v32, s[64:67], s32 offen sc1
    s_waitcnt vmcnt(0)
    s_branch PC0
PG0:
    s_add_u32 s10, s15, 1
    s_and_b32 s10, s10, 7
    s_lshl_b32 s10, s10, 11
    s_add_u32 m0, s35, 0
    s_add_u32 s10, s10, s34
    buffer_load_dwordx4 v10, s[64:67], s10 offen offset:0 sc1 lds
    buffer_load_dwordx4 v10, s[64:67], s10 offen offset:1024 sc1 lds
    s_add_u32 s10, s15, 4
    s_and_b32 s10, s10, 7
    s_lshl_b32 s10, s10, 11
    s_add_u32 m0, s35, 2048
    s_add_u32 s10, s10, s34
    buffer_load_dwordx4 v10, s[64:67], s10 offen offset:0 sc1 lds
    buffer_load_dwordx4 v10, s[64:67], s10 offen offset:1024 sc1 lds
    s_add_u32 s10, s15, 2
    s_and_b32 s10, s10, 7
    s_lshl_b32 s10, s10, 11
    s_add_u32 m0, s35, 4096
    s_add_u32 s10, s10, s34
    buffer_load_dwordx4 v10, s[64:67], s10 offen offset:0 sc1 lds
    buffer_load_dwordx4 v10, s[64:67], s10 offen offset:1024 sc1 lds
    s_add_u32 s26, s15, 3
    s_and_b32 s26, s26, 7
    s_lshl_b32 s24, s26, 13
    s_lshl_b32 s25, s26, 18
    s_add_u32 s24, s24, 128
    s_add_u32 s25, s25, 131072
    s_add_u32 m0, s27, 16384
    s_nop 0
    buffer_load_dwordx4 v24, s[52:55], s24 offen offset:0  lds
    buffer_load_dwordx4 v25, s[52:55], s24 offen offset:1024  lds
    buffer_load_dwordx4 v26, s[52:55], s24 offen offset:2048  lds
    buffer_load_dwordx4 v27, s[52:55], s24 offen offset:3072  lds
    s_add_u32 m0, s18, 82048
    s_nop 0
    buffer_load_dwordx4 v28, s[60:63], s25 offen offset:0  lds
    buffer_load_dwordx4 v29, s[60:63], s25 offen offset:1024  lds
    buffer_load_dwordx4 v30, s[60:63], s25 offen offset:2080  lds
    buffer_load_dwordx4 v31, s[60:63], s25 offen offset:3104  lds
    s_waitcnt vmcnt(8)
    s_barrier
    s_add_u32 s26, s15, 5
    s_and_b32 s26, s26, 7
    s_lshl_b32 s24, s26, 13
    s_lshl_b32 s25, s26, 18
    s_add_u32 m0, s27, 32768
    s_nop 0
    buffer_load_dwordx4 v24, s[52:55], s24 offen offset:0  lds
    buffer_load_dwordx4 v25, s[52:55], s24 offen offset:1024  lds
    buffer_load_dwordx4 v26, s[52:55], s24 offen offset:2048  lds
    buffer_load_dwordx4 v27, s[52:55], s24 offen offset:3072  lds
    s_add_u32 m0, s18, 98560
    s_nop 0
    buffer_load_dwordx4 v28, s[60:63], s25 offen offset:0  lds
    buffer_load_dwordx4 v29, s[60:63], s25 offen offset:1024  lds
    buffer_load_dwordx4 v30, s[60:63], s25 offen offset:2080  lds
    buffer_load_dwordx4 v31, s[60:63], s25 offen offset:3104  lds
    s_waitcnt vmcnt(8)
    s_barrier
    s_add_u32 s10, s15, 3
    s_and_b32 s10, s10, 7
    s_lshl_b32 s10, s10, 11
    s_add_u32 m0, s35, 0
    s_add_u32 s10, s10, s34
    buffer_load_dwordx4 v10, s[64:67], s10 offen offset:0 sc1 lds
    buffer_load_dwordx4 v10, s[64:67], s10 offen offset:1024 sc1 lds
    s_add_u32 s10, s15, 5
    s_and_b32 s10, s10, 7
    s_lshl_b32 s10, s10, 11
    s_add_u32 m0, s35, 2048
    s_add_u32 s10, s10, s34
    buffer_load_dwordx4 v10, s[64:67], s10 offen offset:0 sc1 lds
    buffer_load_dwordx4 v10, s[64:67], s10 offen offset:1024 sc1 lds
    s_add_u32 s26, s15, 5
    s_and_b32 s26, s26, 7
    s_lshl_b32 s24, s26, 13
    s_lshl_b32 s25, s26, 18
    s_add_u32 s24, s24, 128
    s_add_u32 s25, s25, 131072
    s_add_u32 m0, s27, 49152
    s_nop 0
    buffer_load_dwordx4 v24, s[52:55], s24 offen offset:0  lds
    buffer_load_dwordx4 v25, s[52:55], s24 offen offset:1024  lds
    buffer_load_dwordx4 v26, s[52:55], s24 offen offset:2048  lds
    buffer_load_dwordx4 v27, s[52:55], s24 offen offset:3072  lds
    s_add_u32 m0, s18, 115072
    s_nop 0
    buffer_load_dwordx4 v28, s[60:63], s25 offen offset:0  lds
    buffer_load_dwordx4 v29, s[60:63], s25 offen offset:1024  lds
    buffer_load_dwordx4 v30, s[60:63], s25 offen offset:2080  lds
    buffer_load_dwordx4 v31, s[60:63], s25 offen offset:3104  lds
    s_waitcnt vmcnt(12)
    s_barrier
    s_add_u32 s26, s15, 6
    s_and_b32 s26, s26, 7
    s_lshl_b32 s24, s26, 13
    s_lshl_b32 s25, s26, 18
    s_add_u32 m0, s27, 0
    s_nop 0
    buffer_load_dwordx4 v24, s[52:55], s24 offen offset:0  lds
    buffer_load_dwordx4 v25, s[52:55], s24 offen offset:1024  lds
    buffer_load_dwordx4 v26, s[52:55], s24 offen offset:2048  lds
    buffer_load_dwordx4 v27, s[52:55], s24 offen offset:3072  lds
    s_add_u32 m0, s18, 65536
    s_nop 0
    buffer_load_dwordx4 v28, s[60:63], s25 offen offset:0  lds
    buffer_load_dwordx4 v29, s[60:63], s25 offen offset:1024  lds
    buffer_load_dwordx4 v30, s[60:63], s25 offen offset:2080  lds
    buffer_load_dwordx4 v31, s[60:63], s25 offen offset:3104  lds
    s_waitcnt vmcnt(8)
    s_barrier
    s_add_u32 s10, s15, 6
    s_and_b32 s10, s10, 7
    s_lshl_b32 s10, s10, 11
    s_add_u32 m0, s35, 4096
    s_add_u32 s10, s10, s34
    buffer_load_dwordx4 v10, s[64:67], s10 offen offset:0 sc1 lds
    buffer_load_dwordx4 v10, s[64:67], s10 offen offset:1024 sc1 lds
    s_add_u32 s26, s15, 6
    s_and_b32 s26, s26, 7
    s_lshl_b32 s24, s26, 13
    s_lshl_b32 s25, s26, 18
    s_add_u32 s24, s24, 128
    s_add_u32 s25, s25, 131072
    s_add_u32 m0, s27, 16384
    s_nop 0
    buffer_load_dwordx4 v24, s[52:55], s24 offen offset:0  lds
    buffer_load_dwordx4 v25, s[52:55], s24 offen offset:1024  lds
    buffer_load_dwordx4 v26, s[52:55], s24 offen offset:2048  lds
    buffer_load_dwordx4 v27, s[52:55], s24 offen offset:3072  lds
    s_add_u32 m0, s18, 82048
    s_nop 0
    buffer_load_dwordx4 v28, s[60:63], s25 offen offset:0  lds
    buffer_load_dwordx4 v29, s[60:63], s25 offen offset:1024  lds
    buffer_load_dwordx4 v30, s[60:63], s25 offen offset:2080  lds
    buffer_load_dwordx4 v31, s[60:63], s25 offen offset:3104  lds
    s_waitcnt vmcnt(10)
    s_barrier
    s_add_u32 s26, s15, 7
    s_and_b32 s26, s26, 7
    s_lshl_b32 s24, s26, 13
    s_lshl_b32 s25, s26, 18
    s_add_u32 m0, s27, 32768
    s_nop 0
    buffer_load_dwordx4 v24, s[52:55], s24 offen offset:0  lds
    buffer_load_dwordx4 v25, s[52:55], s24 offen offset:1024  lds
    buffer_load_dwordx4 v26, s[52:55], s24 offen offset:2048  lds
    buffer_load_dwordx4 v27, s[52:55], s24 offen offset:3072  lds
    s_add_u32 m0, s18, 98560
    s_nop 0
    buffer_load_dwordx4 v28, s[60:63], s25 offen offset:0  lds
    buffer_load_dwordx4 v29, s[60:63], s25 offen offset:1024  lds
    buffer_load_dwordx4 v30, s[60:63], s25 offen offset:2080  lds
    buffer_load_dwordx4 v31, s[60:63], s25 offen offset:3104  lds
    s_waitcnt vmcnt(8)
    s_barrier
    s_add_u32 s10, s15, 7
    s_and_b32 s10, s10, 7
    s_lshl_b32 s10, s10, 11
    s_add_u32 m0, s35, 0
    s_add_u32 s10, s10, s34
    buffer_load_dwordx4 v10, s[64:67], s10 offen offset:0 sc1 lds
    buffer_load_dwordx4 v10, s[64:67], s10 offen offset:1024 sc1 lds
    s_add_u32 s26, s15, 7
    s_and_b32 s26, s26, 7
    s_lshl_b32 s24, s26, 13
    s_lshl_b32 s25, s26, 18
    s_add_u32 s24, s24, 128
    s_add_u32 s25, s25, 131072
    s_add_u32 m0, s27, 49152
    s_nop 0
    buffer_load_dwordx4 v24, s[52:55], s24 offen offset:0  lds
    buffer_load_dwordx4 v25, s[52:55], s24 offen offset:1024  lds
    buffer_load_dwordx4 v26, s[52:55], s24 offen offset:2048  lds
    buffer_load_dwordx4 v27, s[52:55], s24 offen offset:3072  lds
    s_add_u32 m0, s18, 115072
    s_nop 0
    buffer_load_dwordx4 v28, s[60:63], s25 offen offset:0  lds
    buffer_load_dwordx4 v29, s[60:63], s25 offen offset:1024  lds
    buffer_load_dwordx4 v30, s[60:63], s25 offen offset:2080  lds
    buffer_load_dwordx4 v31, s[60:63], s25 offen offset:3104  lds
    s_waitcnt vmcnt(10)
    s_barrier
    s_waitcnt vmcnt(0)
    s_barrier
    s_endpgm
LOADER1:
    s_add_u32 s26, s28, 0
    s_and_b32 s26, s26, 15
    s_lshl_b32 s24, s26, 7
    s_lshl_b32 s25, s26, 19
    s_add_u32 m0, s27, 16384
    s_nop 0
    buffer_load_dwordx4 v16, s[44:47], s24 offen offset:0  lds
    buffer_load_dwordx4 v17, s[44:47], s24 offen offset:1024  lds
    buffer_load_dwordx4 v18, s[44:47], s24 offen offset:2048  lds
    buffer_load_dwordx4 v19, s[44:47], s24 offen offset:3072  lds
    s_add_u32 m0, s18, 82048
    s_nop 0
    buffer_load_dwordx4 v20, s[56:59], s25 offen offset:0  lds
    buffer_load_dwordx4 v21, s[56:59], s25 offen offset:1024  lds
    buffer_load_dwordx4 v22, s[56:59], s25 offen offset:2080  lds
    buffer_load_dwordx4 v23, s[56:59], s25 offen offset:3104  lds
    s_waitcnt vmcnt(8)
    s_barrier
    s_add_u32 s26, s28, 8
    s_and_b32 s26, s26, 15
    s_lshl_b32 s24, s26, 7
    s_lshl_b32 s25, s26, 19
    s_add_u32 m0, s27, 32768
    s_nop 0
    buffer_load_dwordx4 v16, s[44:47], s24 offen offset:0  lds
    buffer_load_dwordx4 v17, s[44:47], s24 offen offset:1024  lds
    buffer_load_dwordx4 v18, s[44:47], s24 offen offset:2048  lds
    buffer_load_dwordx4 v19, s[44:47], s24 offen offset:3072  lds
    s_add_u32 m0, s18, 98560
    s_nop 0
    buffer_load_dwordx4 v20, s[56:59], s25 offen offset:0  lds
    buffer_load_dwordx4 v21, s[56:59], s25 offen offset:1024  lds
    buffer_load_dwordx4 v22, s[56:59], s25 offen offset:2080  lds
    buffer_load_dwordx4 v23, s[56:59], s25 offen offset:3104  lds
    s_waitcnt vmcnt(8)
    s_barrier
    s_add_u32 s26, s28, 12
    s_and_b32 s26, s26, 15
    s_lshl_b32 s24, s26, 7
    s_lshl_b32 s25, s26, 19
    s_add_u32 m0, s27, 49152
    s_nop 0
    buffer_load_dwordx4 v16, s[44:47], s24 offen offset:0  lds
    buffer_load_dwordx4 v17, s[44:47], s24 offen offset:1024  lds
    buffer_load_dwordx4 v18, s[44:47], s24 offen offset:2048  lds
    buffer_load_dwordx4 v19, s[44:47], s24 offen offset:3072  lds
    s_add_u32 m0, s18, 115072
    s_nop 0
    buffer_load_dwordx4 v20, s[56:59], s25 offen offset:0  lds
    buffer_load_dwordx4 v21, s[56:59], s25 offen offset:1024  lds
    buffer_load_dwordx4 v22, s[56:59], s25 offen offset:2080  lds
    buffer_load_dwordx4 v23, s[56:59], s25 offen offset:3104  lds
    s_waitcnt vmcnt(8)
    s_barrier
    s_add_u32 s26, s28, 6
    s_and_b32 s26, s26, 15
    s_lshl_b32 s24, s26, 7
    s_lshl_b32 s25, s26, 19
    s_add_u32 m0, s27, 0
    s_nop 0
    buffer_load_dwordx4 v16, s[44:47], s24 offen offset:0  lds
    buffer_load_dwordx4 v17, s[44:47], s24 offen offset:1024  lds
    buffer_load_dwordx4 v18, s[44:47], s24 offen offset:2048  lds
    buffer_load_dwordx4 v19, s[44:47], s24 offen offset:3072  lds
    s_add_u32 m0, s18, 65536
    s_nop 0
    buffer_load_dwordx4 v20, s[56:59], s25 offen offset:0  lds
    buffer_load_dwordx4 v21, s[56:59], s25 offen offset:1024  lds
    buffer_load_dwordx4 v22, s[56:59], s25 offen offset:2080  lds
    buffer_load_dwordx4 v23, s[56:59], s25 offen offset:3104  lds
    s_lshl_b32 s24, s7, 13
    s_add_u32 m0, s27, 131584
    s_nop 0
    buffer_load_dwordx4 v24, s[48:51], s24 offen offset:0  lds
    buffer_load_dwordx4 v25, s[48:51], s24 offen offset:1024  lds
    buffer_load_dwordx4 v26, s[48:51], s24 offen offset:2048  lds
    buffer_load_dwordx4 v27, s[48:51], s24 offen offset:3072  lds
    s_waitcnt vmcnt(12)
    s_barrier
    s_add_u32 s26, s28, 2
    s_and_b32 s26, s26, 15
    s_lshl_b32 s24, s26, 7
    s_lshl_b32 s25, s26, 19
    s_add_u32 m0, s27, 16384
    s_nop 0
    buffer_load_dwordx4 v16, s[44:47], s24 offen offset:0  lds
    buffer_load_dwordx4 v17, s[44:47], s24 offen offset:1024  lds
    buffer_load_dwordx4 v18, s[44:47], s24 offen offset:2048  lds
    buffer_load_dwordx4 v19, s[44:47], s24 offen offset:3072  lds
    s_add_u32 m0, s18, 82048
    s_nop 0
    buffer_load_dwordx4 v20, s[56:59], s25 offen offset:0  lds
    buffer_load_dwordx4 v21, s[56:59], s25 offen offset:1024  lds
    buffer_load_dwordx4 v22, s[56:59], s25 offen offset:2080  lds
    buffer_load_dwordx4 v23, s[56:59], s25 offen offset:3104  lds
    s_waitcnt vmcnt(8)
    s_barrier
    buffer_load_dwordx2 v[36:37], off, s[72:75], 0 sc1
    s_add_u32 s26, s28, 10
    s_and_b32 s26, s26, 15
    s_lshl_b32 s24, s26, 7
    s_lshl_b32 s25, s26, 19
    s_add_u32 m0, s27, 32768
    s_nop 0
    buffer_load_dwordx4 v16, s[44:47], s24 offen offset:0  lds
    buffer_load_dwordx4 v17, s[44:47], s24 offen offset:1024  lds
    buffer_load_dwordx4 v18, s[44:47], s24 offen offset:2048  lds
    buffer_load_dwordx4 v19, s[44:47], s24 offen offset:3072  lds
    s_add_u32 m0, s18, 98560
    s_nop 0
    buffer_load_dwordx4 v20, s[56:59], s25 offen offset:0  lds
    buffer_load_dwordx4 v21, s[56:59], s25 offen offset:1024  lds
    buffer_load_dwordx4 v22, s[56:59], s25 offen offset:2080  lds
    buffer_load_dwordx4 v23, s[56:59], s25 offen offset:3104  lds
    s_waitcnt vmcnt(8)
    s_mov_b32 s20, 1048576
TG1:
    v_cmp_eq_u64 vcc, 0, v[36:37]
    s_cbranch_vccz TGOK1
    s_sub_u32 s20, s20, 1
    s_cbranch_scc1 TGOK1
    s_sleep 1
    buffer_load_dwordx2 v[36:37], off, s[72:75], 0 sc1
    s_waitcnt vmcnt(0)
    s_branch TG1
TGOK1:
    s_mov_b32 m0, 162848
    s_mov_b64 exec, 3
    buffer_load_dword v39, s[72:75], 0 offen sc1 lds
    s_mov_b64 exec, -1
    s_barrier
    s_add_u32 s26, s28, 14
    s_and_b32 s26, s26, 15
    s_lshl_b32 s24, s26, 7
    s_lshl_b32 s25, s26, 19
    s_add_u32 m0, s27, 49152
    s_nop 0
    buffer_load_dwordx4 v16, s[44:47], s24 offen offset:0  lds
    buffer_load_dwordx4 v17, s[44:47], s24 offen offset:1024  lds
    buffer_load_dwordx4 v18, s[44:47], s24 offen offset:2048  lds
    buffer_load_dwordx4 v19, s[44:47], s24 offen offset:3072  lds
    s_add_u32 m0, s18, 115072
    s_nop 0
    buffer_load_dwordx4 v20, s[56:59], s25 offen offset:0  lds
    buffer_load_dwordx4 v21, s[56:59], s25 offen offset:1024  lds
    buffer_load_dwordx4 v22, s[56:59], s25 offen offset:2080  lds
    buffer_load_dwordx4 v23, s[56:59], s25 offen offset:3104  lds
    s_waitcnt vmcnt(8)
    s_barrier
    s_add_u32 s26, s28, 5
    s_and_b32 s26, s26, 15
    s_lshl_b32 s24, s26, 7
    s_lshl_b32 s25, s26, 19
    s_add_u32 m0, s27, 0
    s_nop 0
    buffer_load_dwordx4 v16, s[44:47], s24 offen offset:0  lds
    buffer_load_dwordx4 v17, s[44:47], s24 offen offset:1024  lds
    buffer_load_dwordx4 v18, s[44:47], s24 offen offset:2048  lds
    buffer_load_dwordx4 v19, s[44:47], s24 offen offset:3072  lds
    s_add_u32 m0, s18, 65536
    s_nop 0
    buffer_load_dwordx4 v20, s[56:59], s25 offen offset:0  lds
    buffer_load_dwordx4 v21, s[56:59], s25 offen offset:1024  lds
    buffer_load_dwordx4 v22, s[56:59], s25 offen offset:2080  lds
    buffer_load_dwordx4 v23, s[56:59], s25 offen offset:3104  lds
    s_waitcnt vmcnt(8)
    s_barrier
    s_add_u32 s26, s28, 1
    s_and_b32 s26, s26, 15
    s_lshl_b32 s24, s26, 7
    s_lshl_b32 s25, s26, 19
    s_add_u32 m0, s27, 16384
    s_nop 0
    buffer_load_dwordx4 v16, s[44:47], s24 offen offset:0  lds
    buffer_load_dwordx4 v17, s[44:47], s24 offen offset:1024  lds
    buffer_load_dwordx4 v18, s[44:47], s24 offen offset:2048  lds
    buffer_load_dwordx4 v19, s[44:47], s24 offen offset:3072  lds
    s_add_u32 m0, s18, 82048
    s_nop 0
    buffer_load_dwordx4 v20, s[56:59], s25 offen offset:0  lds
    buffer_load_dwordx4 v21, s[56:59], s25 offen offset:1024  lds
    buffer_load_dwordx4 v22, s[56:59], s25 offen offset:2080  lds
    buffer_load_dwordx4 v23, s[56:59], s25 offen offset:3104  lds
    s_waitcnt vmcnt(8)
    s_barrier
    s_add_u32 s26, s28, 7
    s_and_b32 s26, s26, 15
    s_lshl_b32 s24, s26, 7
    s_lshl_b32 s25, s26, 19
    s_add_u32 m0, s27, 32768
    s_nop 0
    buffer_load_dwordx4 v16, s[44:47], s24 offen offset:0  lds
    buffer_load_dwordx4 v17, s[44:47], s24 offen offset:1024  lds
    buffer_load_dwordx4 v18, s[44:47], s24 offen offset:2048  lds
    buffer_load_dwordx4 v19, s[44:47], s24 offen offset:3072  lds
    s_add_u32 m0, s18, 98560
    s_nop 0
    buffer_load_dwordx4 v20, s[56:59], s25 offen offset:0  lds
    buffer_load_dwordx4 v21, s[56:59], s25 offen offset:1024  lds
    buffer_load_dwordx4 v22, s[56:59], s25 offen offset:2080  lds
    buffer_load_dwordx4 v23, s[56:59], s25 offen offset:3104  lds
    s_lshl_b32 s24, s7, 13
    s_add_u32 s24, s24, 128
    s_add_u32 m0, s27, 131584
    s_nop 0
    buffer_load_dwordx4 v24, s[48:51], s24 offen offset:0  lds
    buffer_load_dwordx4 v25, s[48:51], s24 offen offset:1024  lds
    buffer_load_dwordx4 v26, s[48:51], s24 offen offset:2048  lds
    buffer_load_dwordx4 v27, s[48:51], s24 offen offset:3072  lds
    s_waitcnt vmcnt(12)
    s_barrier
    s_add_u32 s26, s28, 9
    s_and_b32 s26, s26, 15
    s_lshl_b32 s24, s26, 7
    s_lshl_b32 s25, s26, 19
    s_add_u32 m0, s27, 49152
    s_nop 0
    buffer_load_dwordx4 v16, s[44:47], s24 offen offset:0  lds
    buffer_load_dwordx4 v17, s[44:47], s24 offen offset:1024  lds
    buffer_load_dwordx4 v18, s[44:47], s24 offen offset:2048  lds
    buffer_load_dwordx4 v19, s[44:47], s24 offen offset:3072  lds
    s_add_u32 m0, s18, 115072
    s_nop 0
    buffer_load_dwordx4 v20, s[56:59], s25 offen offset:0  lds
    buffer_load_dwordx4 v21, s[56:59], s25 offen offset:1024  lds
    buffer_load_dwordx4 v22, s[56:59], s25 offen offset:2080  lds
    buffer_load_dwordx4 v23, s[56:59], s25 offen offset:3104  lds
    s_waitcnt vmcnt(8)
    s_barrier
    s_add_u32 s26, s28, 13
    s_and_b32 s26, s26, 15
    s_lshl_b32 s24, s26, 7
    s_lshl_b32 s25, s26, 19
    s_add_u32 m0, s27, 0
    s_nop 0
    buffer_load_dwordx4 v16, s[44:47], s24 offen offset:0  lds
    buffer_load_dwordx4 v17, s[44:47], s24 offen offset:1024  lds
    buffer_load_dwordx4 v18, s[44:47], s24 offen offset:2048  lds
    buffer_load_dwordx4 v19, s[44:47], s24 offen offset:3072  lds
    s_add_u32 m0, s18, 65536
    s_nop 0
    buffer_load_dwordx4 v20, s[56:59], s25 offen offset:0  lds
    buffer_load_dwordx4 v21, s[56:59], s25 offen offset:1024  lds
    buffer_load_dwordx4 v22, s[56:59], s25 offen offset:2080  lds
    buffer_load_dwordx4 v23, s[56:59], s25 offen offset:3104  lds
    s_waitcnt vmcnt(8)
    s_barrier
    s_add_u32 s26, s28, 3
    s_and_b32 s26, s26, 15
    s_lshl_b32 s24, s26, 7
    s_lshl_b32 s25, s26, 19
    s_add_u32 m0, s27, 16384
    s_nop 0
    buffer_load_dwordx4 v16, s[44:47], s24 offen offset:0  lds
    buffer_load_dwordx4 v17, s[44:47], s24 offen offset:1024  lds
    buffer_load_dwordx4 v18, s[44:47], s24 offen offset:2048  lds
    buffer_load_dwordx4 v19, s[44:47], s24 offen offset:3072  lds
    s_add_u32 m0, s18, 82048
    s_nop 0
    buffer_load_dwordx4 v20, s[56:59], s25 offen offset:0  lds
    buffer_load_dwordx4 v21, s[56:59], s25 offen offset:1024  lds
    buffer_load_dwordx4 v22, s[56:59], s25 offen offset:2080  lds
    buffer_load_dwordx4 v23, s[56:59], s25 offen offset:3104  lds
    s_waitcnt vmcnt(8)
    s_barrier
    s_add_u32 s26, s28, 11
    s_and_b32 s26, s26, 15
    s_lshl_b32 s24, s26, 7
    s_lshl_b32 s25, s26, 19
    s_add_u32 m0, s27, 32768
    s_nop 0
    buffer_load_dwordx4 v16, s[44:47], s24 offen offset:0  lds
    buffer_load_dwordx4 v17, s[44:47], s24 offen offset:1024  lds
    buffer_load_dwordx4 v18, s[44:47], s24 offen offset:2048  lds
    buffer_load_dwordx4 v19, s[44:47], s24 offen offset:3072  lds
    s_add_u32 m0, s18, 98560
    s_nop 0
    buffer_load_dwordx4 v20, s[56:59], s25 offen offset:0  lds
    buffer_load_dwordx4 v21, s[56:59], s25 offen offset:1024  lds
    buffer_load_dwordx4 v22, s[56:59], s25 offen offset:2080  lds
    buffer_load_dwordx4 v23, s[56:59], s25 offen offset:3104  lds
    s_waitcnt vmcnt(8)
    s_barrier
    s_add_u32 s26, s28, 15
    s_and_b32 s26, s26, 15
    s_lshl_b32 s24, s26, 7
    s_lshl_b32 s25, s26, 19
    s_add_u32 m0, s27, 49152
    s_nop 0
    buffer_load_dwordx4 v16, s[44:47], s24 offen offset:0  lds
    buffer_load_dwordx4 v17, s[44:47], s24 offen offset:1024  lds
    buffer_load_dwordx4 v18, s[44:47], s24 offen offset:2048  lds
    buffer_load_dwordx4 v19, s[44:47], s24 offen offset:3072  lds
    s_add_u32 m0, s18, 115072
    s_nop 0
    buffer_load_dwordx4 v20, s[56:59], s25 offen offset:0  lds
    buffer_load_dwordx4 v21, s[56:59], s25 offen offset:1024  lds
    buffer_load_dwordx4 v22, s[56:59], s25 offen offset:2080  lds
    buffer_load_dwordx4 v23, s[56:59], s25 offen offset:3104  lds
    s_waitcnt vmcnt(8)
    s_barrier
    s_add_u32 s26, s15, 1
    s_and_b32 s26, s26, 7
    s_lshl_b32 s24, s26, 13
    s_lshl_b32 s25, s26, 18
    s_add_u32 m0, s27, 0
    s_nop 0
    buffer_load_dwordx4 v24, s[52:55], s24 offen offset:0  lds
    buffer_load_dwordx4 v25, s[52:55], s24 offen offset:1024  lds
    buffer_load_dwordx4 v26, s[52:55], s24 offen offset:2048  lds
    buffer_load_dwordx4 v27, s[52:55], s24 offen offset:3072  lds
    s_add_u32 m0, s18, 65536
    s_nop 0
    buffer_load_dwordx4 v28, s[60:63], s25 offen offset:0  lds
    buffer_load_dwordx4 v29, s[60:63], s25 offen offset:1024  lds
    buffer_load_dwordx4 v30, s[60:63], s25 offen offset:2080  lds
    buffer_load_dwordx4 v31, s[60:63], s25 offen offset:3104  lds
    s_waitcnt vmcnt(8)
    s_barrier
    s_add_u32 s26, s15, 1
    s_and_b32 s26, s26, 7
    s_lshl_b32 s24, s26, 13
    s_lshl_b32 s25, s26, 18
    s_add_u32 s24, s24, 128
    s_add_u32 s25, s25, 131072
    s_add_u32 m0, s27, 16384
    s_nop 0
    buffer_load_dwordx4 v24, s[52:55], s24 offen offset:0  lds
    buffer_load_dwordx4 v25, s[52:55], s24 offen offset:1024  lds
    buffer_load_dwordx4 v26, s[52:55], s24 offen offset:2048  lds
    buffer_load_dwordx4 v27, s[52:55], s24 offen offset:3072  lds
    s_add_u32 m0, s18, 82048
    s_nop 0
    buffer_load_dwordx4 v28, s[60:63], s25 offen offset:0  lds
    buffer_load_dwordx4 v29, s[60:63], s25 offen offset:1024  lds
    buffer_load_dwordx4 v30, s[60:63], s25 offen offset:2080  lds
    buffer_load_dwordx4 v31, s[60:63], s25 offen offset:3104  lds
    s_waitcnt vmcnt(8)
    s_barrier
    s_add_u32 s26, s15, 0
    s_and_b32 s26, s26, 7
    s_lshl_b32 s24, s26, 13
    s_lshl_b32 s25, s26, 18
    s_add_u32 m0, s27, 32768
    s_nop 0
    buffer_load_dwordx4 v24, s[52:55], s24 offen offset:0  lds
    buffer_load_dwordx4 v25, s[52:55], s24 offen offset:1024  lds
    buffer_load_dwordx4 v26, s[52:55], s24 offen offset:2048  lds
    buffer_load_dwordx4 v27, s[52:55], s24 offen offset:3072  lds
    s_add_u32 m0, s18, 98560
    s_nop 0
    buffer_load_dwordx4 v28, s[60:63], s25 offen offset:0  lds
    buffer_load_dwordx4 v29, s[60:63], s25 offen offset:1024  lds
    buffer_load_dwordx4 v30, s[60:63], s25 offen offset:2080  lds
    buffer_load_dwordx4 v31, s[60:63], s25 offen offset:3104  lds
    s_waitcnt vmcnt(8)
    s_barrier
    s_add_u32 s26, s15, 0
    s_and_b32 s26, s26, 7
    s_lshl_b32 s24, s26, 13
    s_lshl_b32 s25, s26, 18
    s_add_u32 s24, s24, 128
    s_add_u32 s25, s25, 131072
    s_add_u32 m0, s27, 49152
    s_nop 0
    buffer_load_dwordx4 v24, s[52:55], s24 offen offset:0  lds
    buffer_load_dwordx4 v25, s[52:55], s24 offen offset:1024  lds
    buffer_load_dwordx4 v26, s[52:55], s24 offen offset:2048  lds
    buffer_load_dwordx4 v27, s[52:55], s24 offen offset:3072  lds
    s_add_u32 m0, s18, 115072
    s_nop 0
    buffer_load_dwordx4 v28, s[60:63], s25 offen offset:0  lds
    buffer_load_dwordx4 v29, s[60:63], s25 offen offset:1024  lds
    buffer_load_dwordx4 v30, s[60:63], s25 offen offset:2080  lds
    buffer_load_dwordx4 v31, s[60:63], s25 offen offset:3104  lds
    s_waitcnt vmcnt(8)
    s_barrier
    s_add_u32 s26, s15, 2
    s_and_b32 s26, s26, 7
    s_lshl_b32 s24, s26, 13
    s_lshl_b32 s25, s26, 18
    s_add_u32 m0, s27, 0
    s_nop 0
    buffer_load_dwordx4 v24, s[52:55], s24 offen offset:0  lds
    buffer_load_dwordx4 v25, s[52:55], s24 offen offset:1024  lds
    buffer_load_dwordx4 v26, s[52:55], s24 offen offset:2048  lds
    buffer_load_dwordx4 v27, s[52:55], s24 offen offset:3072  lds
    s_add_u32 m0, s18, 65536
    s_nop 0
    buffer_load_dwordx4 v28, s[60:63], s25 offen offset:0  lds
    buffer_load_dwordx4 v29, s[60:63], s25 offen offset:1024  lds
    buffer_load_dwordx4 v30, s[60:63], s25 offen offset:2080  lds
    buffer_load_dwordx4 v31, s[60:63], s25 offen offset:3104  lds
    s_waitcnt vmcnt(8)
    s_barrier
    s_add_u32 s26, s15, 2
    s_and_b32 s26, s26, 7
    s_lshl_b32 s24, s26, 13
    s_lshl_b32 s25, s26, 18
    s_add_u32 s24, s24, 128
    s_add_u32 s25, s25, 131072
    s_add_u32 m0, s27, 16384
    s_nop 0
    buffer_load_dwordx4 v24, s[52:55], s24 offen offset:0  lds
    buffer_load_dwordx4 v25, s[52:55], s24 offen offset:1024  lds
    buffer_load_dwordx4 v26, s[52:55], s24 offen offset:2048  lds
    buffer_load_dwordx4 v27, s[52:55], s24 offen offset:3072  lds
    s_add_u32 m0, s18, 82048
    s_nop 0
    buffer_load_dwordx4 v28, s[60:63], s25 offen offset:0  lds
    buffer_load_dwordx4 v29, s[60:63], s25 offen offset:1024  lds
    buffer_load_dwordx4 v30, s[60:63], s25 offen offset:2080  lds
    buffer_load_dwordx4 v31, s[60:63], s25 offen offset:3104  lds
    s_waitcnt vmcnt(8)
    s_barrier
    s_add_u32 s26, s15, 5
    s_and_b32 s26, s26, 7
    s_lshl_b32 s24, s26, 13
    s_lshl_b32 s25, s26, 18
    s_add_u32 m0, s18, 98560
    s_nop 0
    buffer_load_dwordx4 v28, s[60:63], s25 offen offset:0  lds
    buffer_load_dwordx4 v29, s[60:63], s25 offen offset:1024  lds
    buffer_load_dwordx4 v30, s[60:63], s25 offen offset:2080  lds
    buffer_load_dwordx4 v31, s[60:63], s25 offen offset:3104  lds
    s_add_u32 m0, s27, 32768
    s_nop 0
    buffer_load_dwordx4 v24, s[52:55], s24 offen offset:0  lds
    buffer_load_dwordx4 v25, s[52:55], s24 offen offset:1024  lds
    buffer_load_dwordx4 v26, s[52:55], s24 offen offset:2048  lds
    buffer_load_dwordx4 v27, s[52:55], s24 offen offset:3072  lds
    s_waitcnt vmcnt(8)
    s_barrier
    s_add_u32 s26, s15, 5
    s_and_b32 s26, s26, 7
    s_lshl_b32 s24, s26, 13
    s_lshl_b32 s25, s26, 18
    s_add_u32 s24, s24, 128
    s_add_u32 s25, s25, 131072
    s_add_u32 m0, s18, 115072
    s_nop 0
    buffer_load_dwordx4 v28, s[60:63], s25 offen offset:0  lds
    buffer_load_dwordx4 v29, s[60:63], s25 offen offset:1024  lds
    buffer_load_dwordx4 v30, s[60:63], s25 offen offset:2080  lds
    buffer_load_dwordx4 v31, s[60:63], s25 offen offset:3104  lds
    s_add_u32 m0, s27, 49152
    s_nop 0
    buffer_load_dwordx4 v24, s[52:55], s24 offen offset:0  lds
    buffer_load_dwordx4 v25, s[52:55], s24 offen offset:1024  lds
    buffer_load_dwordx4 v26, s[52:55], s24 offen offset:2048  lds
    buffer_load_dwordx4 v27, s[52:55], s24 offen offset:3072  lds
    s_waitcnt vmcnt(8)
    s_barrier
    buffer_load_dwordx2 v[34:35], v32, s[64:67], s32 offen sc1
    s_add_u32 s26, s15, 3
    s_and_b32 s26, s26, 7
    s_lshl_b32 s24, s26, 13
    s_lshl_b32 s25, s26, 18
    s_add_u32 m0, s27, 0
    s_nop 0
    buffer_load_dwordx4 v24, s[52:55], s24 offen offset:0  lds
    buffer_load_dwordx4 v25, s[52:55], s24 offen offset:1024  lds
    buffer_load_dwordx4 v26, s[52:55], s24 offen offset:2048  lds
    buffer_load_dwordx4 v27, s[52:55], s24 offen offset:3072  lds
    s_add_u32 m0, s18, 65536
    s_nop 0
    buffer_load_dwordx4 v28, s[60:63], s25 offen offset:0  lds
    buffer_load_dwordx4 v29, s[60:63], s25 offen offset:1024  lds
    buffer_load_dwordx4 v30, s[60:63], s25 offen offset:2080  lds
    buffer_load_dwordx4 v31, s[60:63], s25 offen offset:3104  lds
    s_waitcnt vmcnt(8)
    s_barrier
    s_mov_b32 s20, 1048576
PC1:
    v_cmp_ne_u64 vcc, v[34:35], v[36:37]
    s_cbranch_vccz PG1
    s_sub_u32 s20, s20, 1
    s_cbranch_scc1 PG1
    buffer_load_dwordx2 v[34:35], v32, s[64:67], s32 offen sc1
    s_waitcnt vmcnt(0)
    s_branch PC1
PG1:
    s_add_u32 s10, s15, 0
    s_and_b32 s10, s10, 7
    s_lshl_b32 s10, s10, 11
    s_add_u32 m0, s35, 0
    s_add_u32 s10, s10, s34
    buffer_load_dwordx4 v10, s[64:67], s10 offen offset:0 sc1 lds
    buffer_load_dwordx4 v10, s[64:67], s10 offen offset:1024 sc1 lds
    s_add_u32 s10, s15, 2
    s_and_b32 s10, s10, 7
    s_lshl_b32 s10, s10, 11
    s_add_u32 m0, s35, 2048
    s_add_u32 s10, s10, s34
    buffer_load_dwordx4 v10, s[64:67], s10 offen offset:0 sc1 lds
    buffer_load_dwordx4 v10, s[64:67], s10 offen offset:1024 sc1 lds
    s_add_u32 s10, s15, 5
    s_and_b32 s10, s10, 7
    s_lshl_b32 s10, s10, 11
    s_add_u32 m0, s35, 4096
    s_add_u32 s10, s10, s34
    buffer_load_dwordx4 v10, s[64:67], s10 offen offset:0 sc1 lds
    buffer_load_dwordx4 v10, s[64:67], s10 offen offset:1024 sc1 lds
    s_add_u32 s26, s15, 3
    s_and_b32 s26, s26, 7
    s_lshl_b32 s24, s26, 13
    s_lshl_b32 s25, s26, 18
    s_add_u32 s24, s24, 128
    s_add_u32 s25, s25, 131072
    s_add_u32 m0, s27, 16384
    s_nop 0
    buffer_load_dwordx4 v24, s[52:55], s24 offen offset:0  lds
    buffer_load_dwordx4 v25, s[52:55], s24 offen offset:1024  lds
    buffer_load_dwordx4 v26, s[52:55], s24 offen offset:2048  lds
    buffer_load_dwordx4 v27, s[52:55], s24 offen offset:3072  lds
    s_add_u32 m0, s18, 82048
    s_nop 0
    buffer_load_dwordx4 v28, s[60:63], s25 offen offset:0  lds
    buffer_load_dwordx4 v29, s[60:63], s25 offen offset:1024  lds
    buffer_load_dwordx4 v30, s[60:63], s25 offen offset:2080  lds
    buffer_load_dwordx4 v31, s[60:63], s25 offen offset:3104  lds
    s_waitcnt vmcnt(8)
    s_barrier
    s_add_u32 s26, s15, 4
    s_and_b32 s26, s26, 7
    s_lshl_b32 s24, s26, 13
    s_lshl_b32 s25, s26, 18
    s_add_u32 m0, s27, 32768
    s_nop 0
    buffer_load_dwordx4 v24, s[52:55], s24 offen offset:0  lds
    buffer_load_dwordx4 v25, s[52:55], s24 offen offset:1024  lds
    buffer_load_dwordx4 v26, s[52:55], s24 offen offset:2048  lds
    buffer_load_dwordx4 v27, s[52:55], s24 offen offset:3072  lds
    s_add_u32 m0, s18, 98560
    s_nop 0
    buffer_load_dwordx4 v28, s[60:63], s25 offen offset:0  lds
    buffer_load_dwordx4 v29, s[60:63], s25 offen offset:1024  lds
    buffer_load_dwordx4 v30, s[60:63], s25 offen offset:2080  lds
    buffer_load_dwordx4 v31, s[60:63], s25 offen offset:3104  lds
    s_waitcnt vmcnt(8)
    s_barrier
    s_add_u32 s10, s15, 3
    s_and_b32 s10, s10, 7
    s_lshl_b32 s10, s10, 11
    s_add_u32 m0, s35, 0
    s_add_u32 s10, s10, s34
    buffer_load_dwordx4 v10, s[64:67], s10 offen offset:0 sc1 lds
    buffer_load_dwordx4 v10, s[64:67], s10 offen offset:1024 sc1 lds
    s_add_u32 s10, s15, 4
    s_and_b32 s10, s10, 7
    s_lshl_b32 s10, s10, 11
    s_add_u32 m0, s35, 2048
    s_add_u32 s10, s10, s34
    buffer_load_dwordx4 v10, s[64:67], s10 offen offset:0 sc1 lds
    buffer_load_dwordx4 v10, s[64:67], s10 offen offset:1024 sc1 lds
    s_add_u32 s26, s15, 4
    s_and_b32 s26, s26, 7
    s_lshl_b32 s24, s26, 13
    s_lshl_b32 s25, s26, 18
    s_add_u32 s24, s24, 128
    s_add_u32 s25, s25, 131072
    s_add_u32 m0, s27, 49152
    s_nop 0
    buffer_load_dwordx4 v24, s[52:55], s24 offen offset:0  lds
    buffer_load_dwordx4 v25, s[52:55], s24 offen offset:1024  lds
    buffer_load_dwordx4 v26, s[52:55], s24 offen offset:2048  lds
    buffer_load_dwordx4 v27, s[52:55], s24 offen offset:3072  lds
    s_add_u32 m0, s18, 115072
    s_nop 0
    buffer_load_dwordx4 v28, s[60:63], s25 offen offset:0  lds
    buffer_load_dwordx4 v29, s[60:63], s25 offen offset:1024  lds
    buffer_load_dwordx4 v30, s[60:63], s25 offen offset:2080  lds
    buffer_load_dwordx4 v31, s[60:63], s25 offen offset:3104  lds
    s_waitcnt vmcnt(12)
    s_barrier
    s_add_u32 s26, s15, 6
    s_and_b32 s26, s26, 7
    s_lshl_b32 s24, s26, 13
    s_lshl_b32 s25, s26, 18
    s_add_u32 m0, s27, 0
    s_nop 0
    buffer_load_dwordx4 v24, s[52:55], s24 offen offset:0  lds
    buffer_load_dwordx4 v25, s[52:55], s24 offen offset:1024  lds
    buffer_load_dwordx4 v26, s[52:55], s24 offen offset:2048  lds
    buffer_load_dwordx4 v27, s[52:55], s24 offen offset:3072  lds
    s_add_u32 m0, s18, 65536
    s_nop 0
    buffer_load_dwordx4 v28, s[60:63], s25 offen offset:0  lds
    buffer_load_dwordx4 v29, s[60:63], s25 offen offset:1024  lds
    buffer_load_dwordx4 v30, s[60:63], s25 offen offset:2080  lds
    buffer_load_dwordx4 v31, s[60:63], s25 offen offset:3104  lds
    s_waitcnt vmcnt(8)
    s_barrier
    s_add_u32 s10, s15, 6
    s_and_b32 s10, s10, 7
    s_lshl_b32 s10, s10, 11
    s_add_u32 m0, s35, 4096
    s_add_u32 s10, s10, s34
    buffer_load_dwordx4 v10, s[64:67], s10 offen offset:0 sc1 lds
    buffer_load_dwordx4 v10, s[64:67], s10 offen offset:1024 sc1 lds
    s_add_u32 s26, s15, 6
    s_and_b32 s26, s26, 7
    s_lshl_b32 s24, s26, 13
    s_lshl_b32 s25, s26, 18
    s_add_u32 s24, s24, 128
    s_add_u32 s25, s25, 131072
    s_add_u32 m0, s27, 16384
    s_nop 0
    buffer_load_dwordx4 v24, s[52:55], s24 offen offset:0  lds
    buffer_load_dwordx4 v25, s[52:55], s24 offen offset:1024  lds
    buffer_load_dwordx4 v26, s[52:55], s24 offen offset:2048  lds
    buffer_load_dwordx4 v27, s[52:55], s24 offen offset:3072  lds
    s_add_u32 m0, s18, 82048
    s_nop 0
    buffer_load_dwordx4 v28, s[60:63], s25 offen offset:0  lds
    buffer_load_dwordx4 v29, s[60:63], s25 offen offset:1024  lds
    buffer_load_dwordx4 v30, s[60:63], s25 offen offset:2080  lds
    buffer_load_dwordx4 v31, s[60:63], s25 offen offset:3104  lds
    s_waitcnt vmcnt(10)
    s_barrier
    s_add_u32 s26, s15, 7
    s_and_b32 s26, s26, 7
    s_lshl_b32 s24, s26, 13
    s_lshl_b32 s25, s26, 18
    s_add_u32 m0, s27, 32768
    s_nop 0
    buffer_load_dwordx4 v24, s[52:55], s24 offen offset:0  lds
    buffer_load_dwordx4 v25, s[52:55], s24 offen offset:1024  lds
    buffer_load_dwordx4 v26, s[52:55], s24 offen offset:2048  lds
    buffer_load_dwordx4 v27, s[52:55], s24 offen offset:3072  lds
    s_add_u32 m0, s18, 98560
    s_nop 0
    buffer_load_dwordx4 v28, s[60:63], s25 offen offset:0  lds
    buffer_load_dwordx4 v29, s[60:63], s25 offen offset:1024  lds
    buffer_load_dwordx4 v30, s[60:63], s25 offen offset:2080  lds
    buffer_load_dwordx4 v31, s[60:63], s25 offen offset:3104  lds
    s_waitcnt vmcnt(8)
    s_barrier
    s_add_u32 s10, s15, 7
    s_and_b32 s10, s10, 7
    s_lshl_b32 s10, s10, 11
    s_add_u32 m0, s35, 0
    s_add_u32 s10, s10, s34
    buffer_load_dwordx4 v10, s[64:67], s10 offen offset:0 sc1 lds
    buffer_load_dwordx4 v10, s[64:67], s10 offen offset:1024 sc1 lds
    s_add_u32 s26, s15, 7
    s_and_b32 s26, s26, 7
    s_lshl_b32 s24, s26, 13
    s_lshl_b32 s25, s26, 18
    s_add_u32 s24, s24, 128
    s_add_u32 s25, s25, 131072
    s_add_u32 m0, s27, 49152
    s_nop 0
    buffer_load_dwordx4 v24, s[52:55], s24 offen offset:0  lds
    buffer_load_dwordx4 v25, s[52:55], s24 offen offset:1024  lds
    buffer_load_dwordx4 v26, s[52:55], s24 offen offset:2048  lds
    buffer_load_dwordx4 v27, s[52:55], s24 offen offset:3072  lds
    s_add_u32 m0, s18, 115072
    s_nop 0
    buffer_load_dwordx4 v28, s[60:63], s25 offen offset:0  lds
    buffer_load_dwordx4 v29, s[60:63], s25 offen offset:1024  lds
    buffer_load_dwordx4 v30, s[60:63], s25 offen offset:2080  lds
    buffer_load_dwordx4 v31, s[60:63], s25 offen offset:3104  lds
    s_waitcnt vmcnt(10)
    s_barrier
    s_waitcnt vmcnt(0)
    s_barrier
    s_endpgm
LOADER2:
    s_add_u32 s26, s28, 0
    s_and_b32 s26, s26, 15
    s_lshl_b32 s24, s26, 7
    s_lshl_b32 s25, s26, 19
    s_add_u32 m0, s27, 16384
    s_nop 0
    buffer_load_dwordx4 v16, s[44:47], s24 offen offset:0  lds
    buffer_load_dwordx4 v17, s[44:47], s24 offen offset:1024  lds
    buffer_load_dwordx4 v18, s[44:47], s24 offen offset:2048  lds
    buffer_load_dwordx4 v19, s[44:47], s24 offen offset:3072  lds
    s_add_u32 m0, s18, 82048
    s_nop 0
    buffer_load_dwordx4 v20, s[56:59], s25 offen offset:0  lds
    buffer_load_dwordx4 v21, s[56:59], s25 offen offset:1024  lds
    buffer_load_dwordx4 v22, s[56:59], s25 offen offset:2080  lds
    buffer_load_dwordx4 v23, s[56:59], s25 offen offset:3104  lds
    s_waitcnt vmcnt(8)
    s_barrier
    s_add_u32 s26, s28, 4
    s_and_b32 s26, s26, 15
    s_lshl_b32 s24, s26, 7
    s_lshl_b32 s25, s26, 19
    s_add_u32 m0, s27, 32768
    s_nop 0
    buffer_load_dwordx4 v16, s[44:47], s24 offen offset:0  lds
    buffer_load_dwordx4 v17, s[44:47], s24 offen offset:1024  lds
    buffer_load_dwordx4 v18, s[44:47], s24 offen offset:2048  lds
    buffer_load_dwordx4 v19, s[44:47], s24 offen offset:3072  lds
    s_add_u32 m0, s18, 98560
    s_nop 0
    buffer_load_dwordx4 v20, s[56:59], s25 offen offset:0  lds
    buffer_load_dwordx4 v21, s[56:59], s25 offen offset:1024  lds
    buffer_load_dwordx4 v22, s[56:59], s25 offen offset:2080  lds
    buffer_load_dwordx4 v23, s[56:59], s25 offen offset:3104  lds
    s_waitcnt vmcnt(8)
    s_barrier
    s_add_u32 s26, s28, 12
    s_and_b32 s26, s26, 15
    s_lshl_b32 s24, s26, 7
    s_lshl_b32 s25, s26, 19
    s_add_u32 m0, s27, 49152
    s_nop 0
    buffer_load_dwordx4 v16, s[44:47], s24 offen offset:0  lds
    buffer_load_dwordx4 v17, s[44:47], s24 offen offset:1024  lds
    buffer_load_dwordx4 v18, s[44:47], s24 offen offset:2048  lds
    buffer_load_dwordx4 v19, s[44:47], s24 offen offset:3072  lds
    s_add_u32 m0, s18, 115072
    s_nop 0
    buffer_load_dwordx4 v20, s[56:59], s25 offen offset:0  lds
    buffer_load_dwordx4 v21, s[56:59], s25 offen offset:1024  lds
    buffer_load_dwordx4 v22, s[56:59], s25 offen offset:2080  lds
    buffer_load_dwordx4 v23, s[56:59], s25 offen offset:3104  lds
    s_waitcnt vmcnt(8)
    s_barrier
    s_add_u32 s26, s28, 10
    s_and_b32 s26, s26, 15
    s_lshl_b32 s24, s26, 7
    s_lshl_b32 s25, s26, 19
    s_add_u32 m0, s27, 0
    s_nop 0
    buffer_load_dwordx4 v16, s[44:47], s24 offen offset:0  lds
    buffer_load_dwordx4 v17, s[44:47], s24 offen offset:1024  lds
    buffer_load_dwordx4 v18, s[44:47], s24 offen offset:2048  lds
    buffer_load_dwordx4 v19, s[44:47], s24 offen offset:3072  lds
    s_add_u32 m0, s18, 65536
    s_nop 0
    buffer_load_dwordx4 v20, s[56:59], s25 offen offset:0  lds
    buffer_load_dwordx4 v21, s[56:59], s25 offen offset:1024  lds
    buffer_load_dwordx4 v22, s[56:59], s25 offen offset:2080  lds
    buffer_load_dwordx4 v23, s[56:59], s25 offen offset:3104  lds
    s_lshl_b32 s24, s7, 13
    s_add_u32 m0, s27, 131584
    s_nop 0
    buffer_load_dwordx4 v24, s[48:51], s24 offen offset:0  lds
    buffer_load_dwordx4 v25, s[48:51], s24 offen offset:1024  lds
    buffer_load_dwordx4 v26, s[48:51], s24 offen offset:2048  lds
    buffer_load_dwordx4 v27, s[48:51], s24 offen offset:3072  lds
    s_waitcnt vmcnt(12)
    s_barrier
    s_add_u32 s26, s28, 2
    s_and_b32 s26, s26, 15
    s_lshl_b32 s24, s26, 7
    s_lshl_b32 s25, s26, 19
    s_add_u32 m0, s27, 16384
    s_nop 0
    buffer_load_dwordx4 v16, s[44:47], s24 offen offset:0  lds
    buffer_load_dwordx4 v17, s[44:47], s24 offen offset:1024  lds
    buffer_load_dwordx4 v18, s[44:47], s24 offen offset:2048  lds
    buffer_load_dwordx4 v19, s[44:47], s24 offen offset:3072  lds
    s_add_u32 m0, s18, 82048
    s_nop 0
    buffer_load_dwordx4 v20, s[56:59], s25 offen offset:0  lds
    buffer_load_dwordx4 v21, s[56:59], s25 offen offset:1024  lds
    buffer_load_dwordx4 v22, s[56:59], s25 offen offset:2080  lds
    buffer_load_dwordx4 v23, s[56:59], s25 offen offset:3104  lds
    s_waitcnt vmcnt(8)
    s_barrier
    buffer_load_dwordx2 v[36:37], off, s[72:75], 0 sc1
    s_add_u32 s26, s28, 6
    s_and_b32 s26, s26, 15
    s_lshl_b32 s24, s26, 7
    s_lshl_b32 s25, s26, 19
    s_add_u32 m0, s27, 32768
    s_nop 0
    buffer_load_dwordx4 v16, s[44:47], s24 offen offset:0  lds
    buffer_load_dwordx4 v17, s[44:47], s24 offen offset:1024  lds
    buffer_load_dwordx4 v18, s[44:47], s24 offen offset:2048  lds
    buffer_load_dwordx4 v19, s[44:47], s24 offen offset:3072  lds
    s_add_u32 m0, s18, 98560
    s_nop 0
    buffer_load_dwordx4 v20, s[56:59], s25 offen offset:0  lds
    buffer_load_dwordx4 v21, s[56:59], s25 offen offset:1024  lds
    buffer_load_dwordx4 v22, s[56:59], s25 offen offset:2080  lds
    buffer_load_dwordx4 v23, s[56:59], s25 offen offset:3104  lds
    s_waitcnt vmcnt(8)
    s_mov_b32 s20, 1048576
TG2:
    v_cmp_eq_u64 vcc, 0, v[36:37]
    s_cbranch_vccz TGOK2
    s_sub_u32 s20, s20, 1
    s_cbranch_scc1 TGOK2
    s_sleep 1
    buffer_load_dwordx2 v[36:37], off, s[72:75], 0 sc1
    s_waitcnt vmcnt(0)
    s_branch TG2
TGOK2:
    s_mov_b32 m0, 162848
    s_mov_b64 exec, 3
    buffer_load_dword v39, s[72:75], 0 offen sc1 lds
    s_mov_b64 exec, -1
    s_barrier
    s_add_u32 s26, s28, 14
    s_and_b32 s26, s26, 15
    s_lshl_b32 s24, s26, 7
    s_lshl_b32 s25, s26, 19
    s_add_u32 m0, s27, 49152
    s_nop 0
    buffer_load_dwordx4 v16, s[44:47], s24 offen offset:0  lds
    buffer_load_dwordx4 v17, s[44:47], s24 offen offset:1024  lds
    buffer_load_dwordx4 v18, s[44:47], s24 offen offset:2048  lds
    buffer_load_dwordx4 v19, s[44:47], s24 offen offset:3072  lds
    s_add_u32 m0, s18, 115072
    s_nop 0
    buffer_load_dwordx4 v20, s[56:59], s25 offen offset:0  lds
    buffer_load_dwordx4 v21, s[56:59], s25 offen offset:1024  lds
    buffer_load_dwordx4 v22, s[56:59], s25 offen offset:2080  lds
    buffer_load_dwordx4 v23, s[56:59], s25 offen offset:3104  lds
    s_waitcnt vmcnt(8)
    s_barrier
    s_add_u32 s26, s28, 9
    s_and_b32 s26, s26, 15
    s_lshl_b32 s24, s26, 7
    s_lshl_b32 s25, s26, 19
    s_add_u32 m0, s27, 0
    s_nop 0
    buffer_load_dwordx4 v16, s[44:47], s24 offen offset:0  lds
    buffer_load_dwordx4 v17, s[44:47], s24 offen offset:1024  lds
    buffer_load_dwordx4 v18, s[44:47], s24 offen offset:2048  lds
    buffer_load_dwordx4 v19, s[44:47], s24 offen offset:3072  lds
    s_add_u32 m0, s18, 65536
    s_nop 0
    buffer_load_dwordx4 v20, s[56:59], s25 offen offset:0  lds
    buffer_load_dwordx4 v21, s[56:59], s25 offen offset:1024  lds
    buffer_load_dwordx4 v22, s[56:59], s25 offen offset:2080  lds
    buffer_load_dwordx4 v23, s[56:59], s25 offen offset:3104  lds
    s_waitcnt vmcnt(8)
    s_barrier
    s_add_u32 s26, s28, 1
    s_and_b32 s26, s26, 15
    s_lshl_b32 s24, s26, 7
    s_lshl_b32 s25, s26, 19
    s_add_u32 m0, s27, 16384
    s_nop 0
    buffer_load_dwordx4 v16, s[44:47], s24 offen offset:0  lds
    buffer_load_dwordx4 v17, s[44:47], s24 offen offset:1024  lds
    buffer_load_dwordx4 v18, s[44:47], s24 offen offset:2048  lds
    buffer_load_dwordx4 v19, s[44:47], s24 offen offset:3072  lds
    s_add_u32 m0, s18, 82048
    s_nop 0
    buffer_load_dwordx4 v20, s[56:59], s25 offen offset:0  lds
    buffer_load_dwordx4 v21, s[56:59], s25 offen offset:1024  lds
    buffer_load_dwordx4 v22, s[56:59], s25 offen offset:2080  lds
    buffer_load_dwordx4 v23, s[56:59], s25 offen offset:3104  lds
    s_waitcnt vmcnt(8)
    s_barrier
    s_add_u32 s26, s28, 5
    s_and_b32 s26, s26, 15
    s_lshl_b32 s24, s26, 7
    s_lshl_b32 s25, s26, 19
    s_add_u32 m0, s27, 32768
    s_nop 0
    buffer_load_dwordx4 v16, s[44:47], s24 offen offset:0  lds
    buffer_load_dwordx4 v17, s[44:47], s24 offen offset:1024  lds
    buffer_load_dwordx4 v18, s[44:47], s24 offen offset:2048  lds
    buffer_load_dwordx4 v19, s[44:47], s24 offen offset:3072  lds
    s_add_u32 m0, s18, 98560
    s_nop 0
    buffer_load_dwordx4 v20, s[56:59], s25 offen offset:0  lds
    buffer_load_dwordx4 v21, s[56:59], s25 offen offset:1024  lds
    buffer_load_dwordx4 v22, s[56:59], s25 offen offset:2080  lds
    buffer_load_dwordx4 v23, s[56:59], s25 offen offset:3104  lds
    s_waitcnt vmcnt(8)
    s_barrier
    s_add_u32 s26, s28, 11
    s_and_b32 s26, s26, 15
    s_lshl_b32 s24, s26, 7
    s_lshl_b32 s25, s26, 19
    s_add_u32 m0, s27, 49152
    s_nop 0
    buffer_load_dwordx4 v16, s[44:47], s24 offen offset:0  lds
    buffer_load_dwordx4 v17, s[44:47], s24 offen offset:1024  lds
    buffer_load_dwordx4 v18, s[44:47], s24 offen offset:2048  lds
    buffer_load_dwordx4 v19, s[44:47], s24 offen offset:3072  lds
    s_add_u32 m0, s18, 115072
    s_nop 0
    buffer_load_dwordx4 v20, s[56:59], s25 offen offset:0  lds
    buffer_load_dwordx4 v21, s[56:59], s25 offen offset:1024  lds
    buffer_load_dwordx4 v22, s[56:59], s25 offen offset:2080  lds
    buffer_load_dwordx4 v23, s[56:59], s25 offen offset:3104  lds
    s_lshl_b32 s24, s7, 13
    s_add_u32 s24, s24, 128
    s_add_u32 m0, s27, 131584
    s_nop 0
    buffer_load_dwordx4 v24, s[48:51], s24 offen offset:0  lds
    buffer_load_dwordx4 v25, s[48:51], s24 offen offset:1024  lds
    buffer_load_dwordx4 v26, s[48:51], s24 offen offset:2048  lds
    buffer_load_dwordx4 v27, s[48:51], s24 offen offset:3072  lds
    s_waitcnt vmcnt(12)
    s_barrier
    s_add_u32 s26, s28, 13
    s_and_b32 s26, s26, 15
    s_lshl_b32 s24, s26, 7
    s_lshl_b32 s25, s26, 19
    s_add_u32 m0, s27, 0
    s_nop 0
    buffer_load_dwordx4 v16, s[44:47], s24 offen offset:0  lds
    buffer_load_dwordx4 v17, s[44:47], s24 offen offset:1024  lds
    buffer_load_dwordx4 v18, s[44:47], s24 offen offset:2048  lds
    buffer_load_dwordx4 v19, s[44:47], s24 offen offset:3072  lds
    s_add_u32 m0, s18, 65536
    s_nop 0
    buffer_load_dwordx4 v20, s[56:59], s25 offen offset:0  lds
    buffer_load_dwordx4 v21, s[56:59], s25 offen offset:1024  lds
    buffer_load_dwordx4 v22, s[56:59], s25 offen offset:2080  lds
    buffer_load_dwordx4 v23, s[56:59], s25 offen offset:3104  lds
    s_waitcnt vmcnt(8)
    s_barrier
    s_add_u32 s26, s28, 3
    s_and_b32 s26, s26, 15
    s_lshl_b32 s24, s26, 7
    s_lshl_b32 s25, s26, 19
    s_add_u32 m0, s27, 16384
    s_nop 0
    buffer_load_dwordx4 v16, s[44:47], s24 offen offset:0  lds
    buffer_load_dwordx4 v17, s[44:47], s24 offen offset:1024  lds
    buffer_load_dwordx4 v18, s[44:47], s24 offen offset:2048  lds
    buffer_load_dwordx4 v19, s[44:47], s24 offen offset:3072  lds
    s_add_u32 m0, s18, 82048
    s_nop 0
    buffer_load_dwordx4 v20, s[56:59], s25 offen offset:0  lds
    buffer_load_dwordx4 v21, s[56:59], s25 offen offset:1024  lds
    buffer_load_dwordx4 v22, s[56:59], s25 offen offset:2080  lds
    buffer_load_dwordx4 v23, s[56:59], s25 offen offset:3104  lds
    s_waitcnt vmcnt(8)
    s_barrier
    s_add_u32 s26, s28, 7
    s_and_b32 s26, s26, 15
    s_lshl_b32 s24, s26, 7
    s_lshl_b32 s25, s26, 19
    s_add_u32 m0, s27, 32768
    s_nop 0
    buffer_load_dwordx4 v16, s[44:47], s24 offen offset:0  lds
    buffer_load_dwordx4 v17, s[44:47], s24 offen offset:1024  lds
    buffer_load_dwordx4 v18, s[44:47], s24 offen offset:2048  lds
    buffer_load_dwordx4 v19, s[44:47], s24 offen offset:3072  lds
    s_add_u32 m0, s18, 98560
    s_nop 0
    buffer_load_dwordx4 v20, s[56:59], s25 offen offset:0  lds
    buffer_load_dwordx4 v21, s[56:59], s25 offen offset:1024  lds
    buffer_load_dwordx4 v22, s[56:59], s25 offen offset:2080  lds
    buffer_load_dwordx4 v23, s[56:59], s25 offen offset:3104  lds
    s_waitcnt vmcnt(8)
    s_barrier
    s_add_u32 s26, s28, 15
    s_and_b32 s26, s26, 15
    s_lshl_b32 s24, s26, 7
    s_lshl_b32 s25, s26, 19
    s_add_u32 m0, s27, 49152
    s_nop 0
    buffer_load_dwordx4 v16, s[44:47], s24 offen offset:0  lds
    buffer_load_dwordx4 v17, s[44:47], s24 offen offset:1024  lds
    buffer_load_dwordx4 v18, s[44:47], s24 offen offset:2048  lds
    buffer_load_dwordx4 v19, s[44:47], s24 offen offset:3072  lds
    s_add_u32 m0, s18, 115072
    s_nop 0
    buffer_load_dwordx4 v20, s[56:59], s25 offen offset:0  lds
    buffer_load_dwordx4 v21, s[56:59], s25 offen offset:1024  lds
    buffer_load_dwordx4 v22, s[56:59], s25 offen offset:2080  lds
    buffer_load_dwordx4 v23, s[56:59], s25 offen offset:3104  lds
    s_waitcnt vmcnt(8)
    s_barrier
    s_add_u32 s26, s15, 2
    s_and_b32 s26, s26, 7
    s_lshl_b32 s24, s26, 13
    s_lshl_b32 s25, s26, 18
    s_add_u32 m0, s27, 0
    s_nop 0
    buffer_load_dwordx4 v24, s[52:55], s24 offen offset:0  lds
    buffer_load_dwordx4 v25, s[52:55], s24 offen offset:1024  lds
    buffer_load_dwordx4 v26, s[52:55], s24 offen offset:2048  lds
    buffer_load_dwordx4 v27, s[52:55], s24 offen offset:3072  lds
    s_add_u32 m0, s18, 65536
    s_nop 0
    buffer_load_dwordx4 v28, s[60:63], s25 offen offset:0  lds
    buffer_load_dwordx4 v29, s[60:63], s25 offen offset:1024  lds
    buffer_load_dwordx4 v30, s[60:63], s25 offen offset:2080  lds
    buffer_load_dwordx4 v31, s[60:63], s25 offen offset:3104  lds
    s_waitcnt vmcnt(8)
    s_barrier
    s_add_u32 s26, s15, 2
    s_and_b32 s26, s26, 7
    s_lshl_b32 s24, s26, 13
    s_lshl_b32 s25, s26, 18
    s_add_u32 s24, s24, 128
    s_add_u32 s25, s25, 131072
    s_add_u32 m0, s27, 16384
    s_nop 0
    buffer_load_dwordx4 v24, s[52:55], s24 offen offset:0  lds
    buffer_load_dwordx4 v25, s[52:55], s24 offen offset:1024  lds
    buffer_load_dwordx4 v26, s[52:55], s24 offen offset:2048  lds
    buffer_load_dwordx4 v27, s[52:55], s24 offen offset:3072  lds
    s_add_u32 m0, s18, 82048
    s_nop 0
    buffer_load_dwordx4 v28, s[60:63], s25 offen offset:0  lds
    buffer_load_dwordx4 v29, s[60:63], s25 offen offset:1024  lds
    buffer_load_dwordx4 v30, s[60:63], s25 offen offset:2080  lds
    buffer_load_dwordx4 v31, s[60:63], s25 offen offset:3104  lds
    s_waitcnt vmcnt(8)
    s_barrier
    s_add_u32 s26, s15, 0
    s_and_b32 s26, s26, 7
    s_lshl_b32 s24, s26, 13
    s_lshl_b32 s25, s26, 18
    s_add_u32 m0, s27, 32768
    s_nop 0
    buffer_load_dwordx4 v24, s[52:55], s24 offen offset:0  lds
    buffer_load_dwordx4 v25, s[52:55], s24 offen offset:1024  lds
    buffer_load_dwordx4 v26, s[52:55], s24 offen offset:2048  lds
    buffer_load_dwordx4 v27, s[52:55], s24 offen offset:3072  lds
    s_add_u32 m0, s18, 98560
    s_nop 0
    buffer_load_dwordx4 v28, s[60:63], s25 offen offset:0  lds
    buffer_load_dwordx4 v29, s[60:63], s25 offen offset:1024  lds
    buffer_load_dwordx4 v30, s[60:63], s25 offen offset:2080  lds
    buffer_load_dwordx4 v31, s[60:63], s25 offen offset:3104  lds
    s_waitcnt vmcnt(8)
    s_barrier
    s_add_u32 s26, s15, 0
    s_and_b32 s26, s26, 7
    s_lshl_b32 s24, s26, 13
    s_lshl_b32 s25, s26, 18
    s_add_u32 s24, s24, 128
    s_add_u32 s25, s25, 131072
    s_add_u32 m0, s27, 49152
    s_nop 0
    buffer_load_dwordx4 v24, s[52:55], s24 offen offset:0  lds
    buffer_load_dwordx4 v25, s[52:55], s24 offen offset:1024  lds
    buffer_load_dwordx4 v26, s[52:55], s24 offen offset:2048  lds
    buffer_load_dwordx4 v27, s[52:55], s24 offen offset:3072  lds
    s_add_u32 m0, s18, 115072
    s_nop 0
    buffer_load_dwordx4 v28, s[60:63], s25 offen offset:0  lds
    buffer_load_dwordx4 v29, s[60:63], s25 offen offset:1024  lds
    buffer_load_dwordx4 v30, s[60:63], s25 offen offset:2080  lds
    buffer_load_dwordx4 v31, s[60:63], s25 offen offset:3104  lds
    s_waitcnt vmcnt(8)
    s_barrier
    s_add_u32 s26, s15, 1
    s_and_b32 s26, s26, 7
    s_lshl_b32 s24, s26, 13
    s_lshl_b32 s25, s26, 18
    s_add_u32 m0, s27, 0
    s_nop 0
    buffer_load_dwordx4 v24, s[52:55], s24 offen offset:0  lds
    buffer_load_dwordx4 v25, s[52:55], s24 offen offset:1024  lds
    buffer_load_dwordx4 v26, s[52:55], s24 offen offset:2048  lds
    buffer_load_dwordx4 v27, s[52:55], s24 offen offset:3072  lds
    s_add_u32 m0, s18, 65536
    s_nop 0
    buffer_load_dwordx4 v28, s[60:63], s25 offen offset:0  lds
    buffer_load_dwordx4 v29, s[60:63], s25 offen offset:1024  lds
    buffer_load_dwordx4 v30, s[60:63], s25 offen offset:2080  lds
    buffer_load_dwordx4 v31, s[60:63], s25 offen offset:3104  lds
    s_waitcnt vmcnt(8)
    s_barrier
    s_add_u32 s26, s15, 1
    s_and_b32 s26, s26, 7
    s_lshl_b32 s24, s26, 13
    s_lshl_b32 s25, s26, 18
    s_add_u32 s24, s24, 128
    s_add_u32 s25, s25, 131072
    s_add_u32 m0, s27, 16384
    s_nop 0
    buffer_load_dwordx4 v24, s[52:55], s24 offen offset:0  lds
    buffer_load_dwordx4 v25, s[52:55], s24 offen offset:1024  lds
    buffer_load_dwordx4 v26, s[52:55], s24 offen offset:2048  lds
    buffer_load_dwordx4 v27, s[52:55], s24 offen offset:3072  lds
    s_add_u32 m0, s18, 82048
    s_nop 0
    buffer_load_dwordx4 v28, s[60:63], s25 offen offset:0  lds
    buffer_load_dwordx4 v29, s[60:63], s25 offen offset:1024  lds
    buffer_load_dwordx4 v30, s[60:63], s25 offen offset:2080  lds
    buffer_load_dwordx4 v31, s[60:63], s25 offen offset:3104  lds
    s_waitcnt vmcnt(8)
    s_barrier
    s_add_u32 s26, s15, 3
    s_and_b32 s26, s26, 7
    s_lshl_b32 s24, s26, 13
    s_lshl_b32 s25, s26, 18
    s_add_u32 m0, s27, 32768
    s_nop 0
    buffer_load_dwordx4 v24, s[52:55], s24 offen offset:0  lds
    buffer_load_dwordx4 v25, s[52:55], s24 offen offset:1024  lds
    buffer_load_dwordx4 v26, s[52:55], s24 offen offset:2048  lds
    buffer_load_dwordx4 v27, s[52:55], s24 offen offset:3072  lds
    s_add_u32 m0, s18, 98560
    s_nop 0
    buffer_load_dwordx4 v28, s[60:63], s25 offen offset:0  lds
    buffer_load_dwordx4 v29, s[60:63], s25 offen offset:1024  lds
    buffer_load_dwordx4 v30, s[60:63], s25 offen offset:2080  lds
    buffer_load_dwordx4 v31, s[60:63], s25 offen offset:3104  lds
    s_waitcnt vmcnt(8)
    s_barrier
    s_add_u32 s26, s15, 3
    s_and_b32 s26, s26, 7
    s_lshl_b32 s24, s26, 13
    s_lshl_b32 s25, s26, 18
    s_add_u32 s24, s24, 128
    s_add_u32 s25, s25, 131072
    s_add_u32 m0, s27, 49152
    s_nop 0
    buffer_load_dwordx4 v24, s[52:55], s24 offen offset:0  lds
    buffer_load_dwordx4 v25, s[52:55], s24 offen offset:1024  lds
    buffer_load_dwordx4 v26, s[52:55], s24 offen offset:2048  lds
    buffer_load_dwordx4 v27, s[52:55], s24 offen offset:3072  lds
    s_add_u32 m0, s18, 115072
    s_nop 0
    buffer_load_dwordx4 v28, s[60:63], s25 offen offset:0  lds
    buffer_load_dwordx4 v29, s[60:63], s25 offen offset:1024  lds
    buffer_load_dwordx4 v30, s[60:63], s25 offen offset:2080  lds
    buffer_load_dwordx4 v31, s[60:63], s25 offen offset:3104  lds
    s_waitcnt vmcnt(8)
    s_barrier
    buffer_load_dwordx2 v[34:35], v32, s[64:67], s32 offen sc1
    s_add_u32 s26, s15, 6
    s_and_b32 s26, s26, 7
    s_lshl_b32 s24, s26, 13
    s_lshl_b32 s25, s26, 18
    s_add_u32 m0, s18, 65536
    s_nop 0
    buffer_load_dwordx4 v28, s[60:63], s25 offen offset:0  lds
    buffer_load_dwordx4 v29, s[60:63], s25 offen offset:1024  lds
    buffer_load_dwordx4 v30, s[60:63], s25 offen offset:2080  lds
    buffer_load_dwordx4 v31, s[60:63], s25 offen offset:3104  lds
    s_add_u32 m0, s27, 0
    s_nop 0
    buffer_load_dwordx4 v24, s[52:55], s24 offen offset:0  lds
    buffer_load_dwordx4 v25, s[52:55], s24 offen offset:1024  lds
    buffer_load_dwordx4 v26, s[52:55], s24 offen offset:2048  lds
    buffer_load_dwordx4 v27, s[52:55], s24 offen offset:3072  lds
    s_waitcnt vmcnt(8)
    s_barrier
    s_mov_b32 s20, 1048576
PC2:
    v_cmp_ne_u64 vcc, v[34:35], v[36:37]
    s_cbranch_vccz PG2
    s_sub_u32 s20, s20, 1
    s_cbranch_scc1 PG2
    buffer_load_dwordx2 v[34:35], v32, s[64:67], s32 offen sc1
    s_waitcnt vmcnt(0)
    s_branch PC2
PG2:
    s_add_u32 s10, s15, 0
    s_and_b32 s10, s10, 7
    s_lshl_b32 s10, s10, 11
    s_add_u32 m0, s35, 0
    s_add_u32 s10, s10, s34
    buffer_load_dwordx4 v10, s[64:67], s10 offen offset:0 sc1 lds
    buffer_load_dwordx4 v10, s[64:67], s10 offen offset:1024 sc1 lds
    s_add_u32 s10, s15, 1
    s_and_b32 s10, s10, 7
    s_lshl_b32 s10, s10, 11
    s_add_u32 m0, s35, 2048
    s_add_u32 s10, s10, s34
    buffer_load_dwordx4 v10, s[64:67], s10 offen offset:0 sc1 lds
    buffer_load_dwordx4 v10, s[64:67], s10 offen offset:1024 sc1 lds
    s_add_u32 s10, s15, 3
    s_and_b32 s10, s10, 7
    s_lshl_b32 s10, s10, 11
    s_add_u32 m0, s35, 4096
    s_add_u32 s10, s10, s34
    buffer_load_dwordx4 v10, s[64:67], s10 offen offset:0 sc1 lds
    buffer_load_dwordx4 v10, s[64:67], s10 offen offset:1024 sc1 lds
    s_add_u32 s26, s15, 6
    s_and_b32 s26, s26, 7
    s_lshl_b32 s24, s26, 13
    s_lshl_b32 s25, s26, 18
    s_add_u32 s24, s24, 128
    s_add_u32 s25, s25, 131072
    s_add_u32 m0, s18, 82048
    s_nop 0
    buffer_load_dwordx4 v28, s[60:63], s25 offen offset:0  lds
    buffer_load_dwordx4 v29, s[60:63], s25 offen offset:1024  lds
    buffer_load_dwordx4 v30, s[60:63], s25 offen offset:2080  lds
    buffer_load_dwordx4 v31, s[60:63], s25 offen offset:3104  lds
    s_add_u32 m0, s27, 16384
    s_nop 0
    buffer_load_dwordx4 v24, s[52:55], s24 offen offset:0  lds
    buffer_load_dwordx4 v25, s[52:55], s24 offen offset:1024  lds
    buffer_load_dwordx4 v26, s[52:55], s24 offen offset:2048  lds
    buffer_load_dwordx4 v27, s[52:55], s24 offen offset:3072  lds
    s_waitcnt vmcnt(8)
    s_barrier
    s_add_u32 s26, s15, 4
    s_and_b32 s26, s26, 7
    s_lshl_b32 s24, s26, 13
    s_lshl_b32 s25, s26, 18
    s_add_u32 m0, s27, 32768
    s_nop 0
    buffer_load_dwordx4 v24, s[52:55], s24 offen offset:0  lds
    buffer_load_dwordx4 v25, s[52:55], s24 offen offset:1024  lds
    buffer_load_dwordx4 v26, s[52:55], s24 offen offset:2048  lds
    buffer_load_dwordx4 v27, s[52:55], s24 offen offset:3072  lds
    s_add_u32 m0, s18, 98560
    s_nop 0
    buffer_load_dwordx4 v28, s[60:63], s25 offen offset:0  lds
    buffer_load_dwordx4 v29, s[60:63], s25 offen offset:1024  lds
    buffer_load_dwordx4 v30, s[60:63], s25 offen offset:2080  lds
    buffer_load_dwordx4 v31, s[60:63], s25 offen offset:3104  lds
    s_waitcnt vmcnt(8)
    s_barrier
    s_add_u32 s10, s15, 6
    s_and_b32 s10, s10, 7
    s_lshl_b32 s10, s10, 11
    s_add_u32 m0, s35, 0
    s_add_u32 s10, s10, s34
    buffer_load_dwordx4 v10, s[64:67], s10 offen offset:0 sc1 lds
    buffer_load_dwordx4 v10, s[64:67], s10 offen offset:1024 sc1 lds
    s_add_u32 s10, s15, 4
    s_and_b32 s10, s10, 7
    s_lshl_b32 s10, s10, 11
    s_add_u32 m0, s35, 2048
    s_add_u32 s10, s10, s34
    buffer_load_dwordx4 v10, s[64:67], s10 offen offset:0 sc1 lds
    buffer_load_dwordx4 v10, s[64:67], s10 offen offset:1024 sc1 lds
    s_add_u32 s26, s15, 4
    s_and_b32 s26, s26, 7
    s_lshl_b32 s24, s26, 13
    s_lshl_b32 s25, s26, 18
    s_add_u32 s24, s24, 128
    s_add_u32 s25, s25, 131072
    s_add_u32 m0, s27, 49152
    s_nop 0
    buffer_load_dwordx4 v24, s[52:55], s24 offen offset:0  lds
    buffer_load_dwordx4 v25, s[52:55], s24 offen offset:1024  lds
    buffer_load_dwordx4 v26, s[52:55], s24 offen offset:2048  lds
    buffer_load_dwordx4 v27, s[52:55], s24 offen offset:3072  lds
    s_add_u32 m0, s18, 115072
    s_nop 0
    buffer_load_dwordx4 v28, s[60:63], s25 offen offset:0  lds
    buffer_load_dwordx4 v29, s[60:63], s25 offen offset:1024  lds
    buffer_load_dwordx4 v30, s[60:63], s25 offen offset:2080  lds
    buffer_load_dwordx4 v31, s[60:63], s25 offen offset:3104  lds
    s_waitcnt vmcnt(12)
    s_barrier
    s_add_u32 s26, s15, 5
    s_and_b32 s26, s26, 7
    s_lshl_b32 s24, s26, 13
    s_lshl_b32 s25, s26, 18
    s_add_u32 m0, s27, 0
    s_nop 0
    buffer_load_dwordx4 v24, s[52:55], s24 offen offset:0  lds
    buffer_load_dwordx4 v25, s[52:55], s24 offen offset:1024  lds
    buffer_load_dwordx4 v26, s[52:55], s24 offen offset:2048  lds
    buffer_load_dwordx4 v27, s[52:55], s24 offen offset:3072  lds
    s_add_u32 m0, s18, 65536
    s_nop 0
    buffer_load_dwordx4 v28, s[60:63], s25 offen offset:0  lds
    buffer_load_dwordx4 v29, s[60:63], s25 offen offset:1024  lds
    buffer_load_dwordx4 v30, s[60:63], s25 offen offset:2080  lds
    buffer_load_dwordx4 v31, s[60:63], s25 offen offset:3104  lds
    s_waitcnt vmcnt(8)
    s_barrier
    s_add_u32 s10, s15, 5
    s_and_b32 s10, s10, 7
    s_lshl_b32 s10, s10, 11
    s_add_u32 m0, s35, 4096
    s_add_u32 s10, s10, s34
    buffer_load_dwordx4 v10, s[64:67], s10 offen offset:0 sc1 lds
    buffer_load_dwordx4 v10, s[64:67], s10 offen offset:1024 sc1 lds
    s_add_u32 s26, s15, 5
    s_and_b32 s26, s26, 7
    s_lshl_b32 s24, s26, 13
    s_lshl_b32 s25, s26, 18
    s_add_u32 s24, s24, 128
    s_add_u32 s25, s25, 131072
    s_add_u32 m0, s27, 16384
    s_nop 0
    buffer_load_dwordx4 v24, s[52:55], s24 offen offset:0  lds
    buffer_load_dwordx4 v25, s[52:55], s24 offen offset:1024  lds
    buffer_load_dwordx4 v26, s[52:55], s24 offen offset:2048  lds
    buffer_load_dwordx4 v27, s[52:55], s24 offen offset:3072  lds
    s_add_u32 m0, s18, 82048
    s_nop 0
    buffer_load_dwordx4 v28, s[60:63], s25 offen offset:0  lds
    buffer_load_dwordx4 v29, s[60:63], s25 offen offset:1024  lds
    buffer_load_dwordx4 v30, s[60:63], s25 offen offset:2080  lds
    buffer_load_dwordx4 v31, s[60:63], s25 offen offset:3104  lds
    s_waitcnt vmcnt(10)
    s_barrier
    s_add_u32 s26, s15, 7
    s_and_b32 s26, s26, 7
    s_lshl_b32 s24, s26, 13
    s_lshl_b32 s25, s26, 18
    s_add_u32 m0, s27, 32768
    s_nop 0
    buffer_load_dwordx4 v24, s[52:55], s24 offen offset:0  lds
    buffer_load_dwordx4 v25, s[52:55], s24 offen offset:1024  lds
    buffer_load_dwordx4 v26, s[52:55], s24 offen offset:2048  lds
    buffer_load_dwordx4 v27, s[52:55], s24 offen offset:3072  lds
    s_add_u32 m0, s18, 98560
    s_nop 0
    buffer_load_dwordx4 v28, s[60:63], s25 offen offset:0  lds
    buffer_load_dwordx4 v29, s[60:63], s25 offen offset:1024  lds
    buffer_load_dwordx4 v30, s[60:63], s25 offen offset:2080  lds
    buffer_load_dwordx4 v31, s[60:63], s25 offen offset:3104  lds
    s_waitcnt vmcnt(8)
    s_barrier
    s_add_u32 s10, s15, 7
    s_and_b32 s10, s10, 7
    s_lshl_b32 s10, s10, 11
    s_add_u32 m0, s35, 0
    s_add_u32 s10, s10, s34
    buffer_load_dwordx4 v10, s[64:67], s10 offen offset:0 sc1 lds
    buffer_load_dwordx4 v10, s[64:67], s10 offen offset:1024 sc1 lds
    s_add_u32 s26, s15, 7
    s_and_b32 s26, s26, 7
    s_lshl_b32 s24, s26, 13
    s_lshl_b32 s25, s26, 18
    s_add_u32 s24, s24, 128
    s_add_u32 s25, s25, 131072
    s_add_u32 m0, s27, 49152
    s_nop 0
    buffer_load_dwordx4 v24, s[52:55], s24 offen offset:0  lds
    buffer_load_dwordx4 v25, s[52:55], s24 offen offset:1024  lds
    buffer_load_dwordx4 v26, s[52:55], s24 offen offset:2048  lds
    buffer_load_dwordx4 v27, s[52:55], s24 offen offset:3072  lds
    s_add_u32 m0, s18, 115072
    s_nop 0
    buffer_load_dwordx4 v28, s[60:63], s25 offen offset:0  lds
    buffer_load_dwordx4 v29, s[60:63], s25 offen offset:1024  lds
    buffer_load_dwordx4 v30, s[60:63], s25 offen offset:2080  lds
    buffer_load_dwordx4 v31, s[60:63], s25 offen offset:3104  lds
    s_waitcnt vmcnt(10)
    s_barrier
    s_waitcnt vmcnt(0)
    s_barrier
    s_endpgm
LOADER3:
    s_add_u32 s26, s28, 0
    s_and_b32 s26, s26, 15
    s_lshl_b32 s24, s26, 7
    s_lshl_b32 s25, s26, 19
    s_add_u32 m0, s27, 16384
    s_nop 0
    buffer_load_dwordx4 v16, s[44:47], s24 offen offset:0  lds
    buffer_load_dwordx4 v17, s[44:47], s24 offen offset:1024  lds
    buffer_load_dwordx4 v18, s[44:47], s24 offen offset:2048  lds
    buffer_load_dwordx4 v19, s[44:47], s24 offen offset:3072  lds
    s_add_u32 m0, s18, 82048
    s_nop 0
    buffer_load_dwordx4 v20, s[56:59], s25 offen offset:0  lds
    buffer_load_dwordx4 v21, s[56:59], s25 offen offset:1024  lds
    buffer_load_dwordx4 v22, s[56:59], s25 offen offset:2080  lds
    buffer_load_dwordx4 v23, s[56:59], s25 offen offset:3104  lds
    s_waitcnt vmcnt(8)
    s_barrier
    s_add_u32 s26, s28, 4
    s_and_b32 s26, s26, 15
    s_lshl_b32 s24, s26, 7
    s_lshl_b32 s25, s26, 19
    s_add_u32 m0, s27, 32768
    s_nop 0
    buffer_load_dwordx4 v16, s[44:47], s24 offen offset:0  lds
    buffer_load_dwordx4 v17, s[44:47], s24 offen offset:1024  lds
    buffer_load_dwordx4 v18, s[44:47], s24 offen offset:2048  lds
    buffer_load_dwordx4 v19, s[44:47], s24 offen offset:3072  lds
    s_add_u32 m0, s18, 98560
    s_nop 0
    buffer_load_dwordx4 v20, s[56:59], s25 offen offset:0  lds
    buffer_load_dwordx4 v21, s[56:59], s25 offen offset:1024  lds
    buffer_load_dwordx4 v22, s[56:59], s25 offen offset:2080  lds
    buffer_load_dwordx4 v23, s[56:59], s25 offen offset:3104  lds
    s_waitcnt vmcnt(8)
    s_barrier
    s_add_u32 s26, s28, 8
    s_and_b32 s26, s26, 15
    s_lshl_b32 s24, s26, 7
    s_lshl_b32 s25, s26, 19
    s_add_u32 m0, s27, 49152
    s_nop 0
    buffer_load_dwordx4 v16, s[44:47], s24 offen offset:0  lds
    buffer_load_dwordx4 v17, s[44:47], s24 offen offset:1024  lds
    buffer_load_dwordx4 v18, s[44:47], s24 offen offset:2048  lds
    buffer_load_dwordx4 v19, s[44:47], s24 offen offset:3072  lds
    s_add_u32 m0, s18, 115072
    s_nop 0
    buffer_load_dwordx4 v20, s[56:59], s25 offen offset:0  lds
    buffer_load_dwordx4 v21, s[56:59], s25 offen offset:1024  lds
    buffer_load_dwordx4 v22, s[56:59], s25 offen offset:2080  lds
    buffer_load_dwordx4 v23, s[56:59], s25 offen offset:3104  lds
    s_waitcnt vmcnt(8)
    s_barrier
    s_add_u32 s26, s28, 14
    s_and_b32 s26, s26, 15
    s_lshl_b32 s24, s26, 7
    s_lshl_b32 s25, s26, 19
    s_add_u32 m0, s27, 0
    s_nop 0
    buffer_load_dwordx4 v16, s[44:47], s24 offen offset:0  lds
    buffer_load_dwordx4 v17, s[44:47], s24 offen offset:1024  lds
    buffer_load_dwordx4 v18, s[44:47], s24 offen offset:2048  lds
    buffer_load_dwordx4 v19, s[44:47], s24 offen offset:3072  lds
    s_add_u32 m0, s18, 65536
    s_nop 0
    buffer_load_dwordx4 v20, s[56:59], s25 offen offset:0  lds
    buffer_load_dwordx4 v21, s[56:59], s25 offen offset:1024  lds
    buffer_load_dwordx4 v22, s[56:59], s25 offen offset:2080  lds
    buffer_load_dwordx4 v23, s[56:59], s25 offen offset:3104  lds
    s_lshl_b32 s24, s7, 13
    s_add_u32 m0, s27, 131584
    s_nop 0
    buffer_load_dwordx4 v24, s[48:51], s24 offen offset:0  lds
    buffer_load_dwordx4 v25, s[48:51], s24 offen offset:1024  lds
    buffer_load_dwordx4 v26, s[48:51], s24 offen offset:2048  lds
    buffer_load_dwordx4 v27, s[48:51], s24 offen offset:3072  lds
    s_waitcnt vmcnt(12)
    s_barrier
    s_add_u32 s26, s28, 2
    s_and_b32 s26, s26, 15
    s_lshl_b32 s24, s26, 7
    s_lshl_b32 s25, s26, 19
    s_add_u32 m0, s27, 16384
    s_nop 0
    buffer_load_dwordx4 v16, s[44:47], s24 offen offset:0  lds
    buffer_load_dwordx4 v17, s[44:47], s24 offen offset:1024  lds
    buffer_load_dwordx4 v18, s[44:47], s24 offen offset:2048  lds
    buffer_load_dwordx4 v19, s[44:47], s24 offen offset:3072  lds
    s_add_u32 m0, s18, 82048
    s_nop 0
    buffer_load_dwordx4 v20, s[56:59], s25 offen offset:0  lds
    buffer_load_dwordx4 v21, s[56:59], s25 offen offset:1024  lds
    buffer_load_dwordx4 v22, s[56:59], s25 offen offset:2080  lds
    buffer_load_dwordx4 v23, s[56:59], s25 offen offset:3104  lds
    s_waitcnt vmcnt(8)
    s_barrier
    buffer_load_dwordx2 v[36:37], off, s[72:75], 0 sc1
    s_add_u32 s26, s28, 6
    s_and_b32 s26, s26, 15
    s_lshl_b32 s24, s26, 7
    s_lshl_b32 s25, s26, 19
    s_add_u32 m0, s27, 32768
    s_nop 0
    buffer_load_dwordx4 v16, s[44:47], s24 offen offset:0  lds
    buffer_load_dwordx4 v17, s[44:47], s24 offen offset:1024  lds
    buffer_load_dwordx4 v18, s[44:47], s24 offen offset:2048  lds
    buffer_load_dwordx4 v19, s[44:47], s24 offen offset:3072  lds
    s_add_u32 m0, s18, 98560
    s_nop 0
    buffer_load_dwordx4 v20, s[56:59], s25 offen offset:0  lds
    buffer_load_dwordx4 v21, s[56:59], s25 offen offset:1024  lds
    buffer_load_dwordx4 v22, s[56:59], s25 offen offset:2080  lds
    buffer_load_dwordx4 v23, s[56:59], s25 offen offset:3104  lds
    s_waitcnt vmcnt(8)
    s_mov_b32 s20, 1048576
TG3:
    v_cmp_eq_u64 vcc, 0, v[36:37]
    s_cbranch_vccz TGOK3
    s_sub_u32 s20, s20, 1
    s_cbranch_scc1 TGOK3
    s_sleep 1
    buffer_load_dwordx2 v[36:37], off, s[72:75], 0 sc1
    s_waitcnt vmcnt(0)
    s_branch TG3
TGOK3:
    s_mov_b32 m0, 162848
    s_mov_b64 exec, 3
    buffer_load_dword v39, s[72:75], 0 offen sc1 lds
    s_mov_b64 exec, -1
    s_barrier
    s_add_u32 s26, s28, 10
    s_and_b32 s26, s26, 15
    s_lshl_b32 s24, s26, 7
    s_lshl_b32 s25, s26, 19
    s_add_u32 m0, s27, 49152
    s_nop 0
    buffer_load_dwordx4 v16, s[44:47], s24 offen offset:0  lds
    buffer_load_dwordx4 v17, s[44:47], s24 offen offset:1024  lds
    buffer_load_dwordx4 v18, s[44:47], s24 offen offset:2048  lds
    buffer_load_dwordx4 v19, s[44:47], s24 offen offset:3072  lds
    s_add_u32 m0, s18, 115072
    s_nop 0
    buffer_load_dwordx4 v20, s[56:59], s25 offen offset:0  lds
    buffer_load_dwordx4 v21, s[56:59], s25 offen offset:1024  lds
    buffer_load_dwordx4 v22, s[56:59], s25 offen offset:2080  lds
    buffer_load_dwordx4 v23, s[56:59], s25 offen offset:3104  lds
    s_waitcnt vmcnt(8)
    s_barrier
    s_add_u32 s26, s28, 13
    s_and_b32 s26, s26, 15
    s_lshl_b32 s24, s26, 7
    s_lshl_b32 s25, s26, 19
    s_add_u32 m0, s27, 0
    s_nop 0
    buffer_load_dwordx4 v16, s[44:47], s24 offen offset:0  lds
    buffer_load_dwordx4 v17, s[44:47], s24 offen offset:1024  lds
    buffer_load_dwordx4 v18, s[44:47], s24 offen offset:2048  lds
    buffer_load_dwordx4 v19, s[44:47], s24 offen offset:3072  lds
    s_add_u32 m0, s18, 65536
    s_nop 0
    buffer_load_dwordx4 v20, s[56:59], s25 offen offset:0  lds
    buffer_load_dwordx4 v21, s[56:59], s25 offen offset:1024  lds
    buffer_load_dwordx4 v22, s[56:59], s25 offen offset:2080  lds
    buffer_load_dwordx4 v23, s[56:59], s25 offen offset:3104  lds
    s_waitcnt vmcnt(8)
    s_barrier
    s_add_u32 s26, s28, 1
    s_and_b32 s26, s26, 15
    s_lshl_b32 s24, s26, 7
    s_lshl_b32 s25, s26, 19
    s_add_u32 m0, s27, 16384
    s_nop 0
    buffer_load_dwordx4 v16, s[44:47], s24 offen offset:0  lds
    buffer_load_dwordx4 v17, s[44:47], s24 offen offset:1024  lds
    buffer_load_dwordx4 v18, s[44:47], s24 offen offset:2048  lds
    buffer_load_dwordx4 v19, s[44:47], s24 offen offset:3072  lds
    s_add_u32 m0, s18, 82048
    s_nop 0
    buffer_load_dwordx4 v20, s[56:59], s25 offen offset:0  lds
    buffer_load_dwordx4 v21, s[56:59], s25 offen offset:1024  lds
    buffer_load_dwordx4 v22, s[56:59], s25 offen offset:2080  lds
    buffer_load_dwordx4 v23, s[56:59], s25 offen offset:3104  lds
    s_waitcnt vmcnt(8)
    s_barrier
    s_add_u32 s26, s28, 5
    s_and_b32 s26, s26, 15
    s_lshl_b32 s24, s26, 7
    s_lshl_b32 s25, s26, 19
    s_add_u32 m0, s27, 32768
    s_nop 0
    buffer_load_dwordx4 v16, s[44:47], s24 offen offset:0  lds
    buffer_load_dwordx4 v17, s[44:47], s24 offen offset:1024  lds
    buffer_load_dwordx4 v18, s[44:47], s24 offen offset:2048  lds
    buffer_load_dwordx4 v19, s[44:47], s24 offen offset:3072  lds
    s_add_u32 m0, s18, 98560
    s_nop 0
    buffer_load_dwordx4 v20, s[56:59], s25 offen offset:0  lds
    buffer_load_dwordx4 v21, s[56:59], s25 offen offset:1024  lds
    buffer_load_dwordx4 v22, s[56:59], s25 offen offset:2080  lds
    buffer_load_dwordx4 v23, s[56:59], s25 offen offset:3104  lds
    s_waitcnt vmcnt(8)
    s_barrier
    s_add_u32 s26, s28, 9
    s_and_b32 s26, s26, 15
    s_lshl_b32 s24, s26, 7
    s_lshl_b32 s25, s26, 19
    s_add_u32 m0, s27, 49152
    s_nop 0
    buffer_load_dwordx4 v16, s[44:47], s24 offen offset:0  lds
    buffer_load_dwordx4 v17, s[44:47], s24 offen offset:1024  lds
    buffer_load_dwordx4 v18, s[44:47], s24 offen offset:2048  lds
    buffer_load_dwordx4 v19, s[44:47], s24 offen offset:3072  lds
    s_add_u32 m0, s18, 115072
    s_nop 0
    buffer_load_dwordx4 v20, s[56:59], s25 offen offset:0  lds
    buffer_load_dwordx4 v21, s[56:59], s25 offen offset:1024  lds
    buffer_load_dwordx4 v22, s[56:59], s25 offen offset:2080  lds
    buffer_load_dwordx4 v23, s[56:59], s25 offen offset:3104  lds
    s_waitcnt vmcnt(8)
    s_barrier
    s_add_u32 s26, s28, 15
    s_and_b32 s26, s26, 15
    s_lshl_b32 s24, s26, 7
    s_lshl_b32 s25, s26, 19
    s_add_u32 m0, s27, 0
    s_nop 0
    buffer_load_dwordx4 v16, s[44:47], s24 offen offset:0  lds
    buffer_load_dwordx4 v17, s[44:47], s24 offen offset:1024  lds
    buffer_load_dwordx4 v18, s[44:47], s24 offen offset:2048  lds
    buffer_load_dwordx4 v19, s[44:47], s24 offen offset:3072  lds
    s_add_u32 m0, s18, 65536
    s_nop 0
    buffer_load_dwordx4 v20, s[56:59], s25 offen offset:0  lds
    buffer_load_dwordx4 v21, s[56:59], s25 offen offset:1024  lds
    buffer_load_dwordx4 v22, s[56:59], s25 offen offset:2080  lds
    buffer_load_dwordx4 v23, s[56:59], s25 offen offset:3104  lds
    s_lshl_b32 s24, s7, 13
    s_add_u32 s24, s24, 128
    s_add_u32 m0, s27, 131584
    s_nop 0
    buffer_load_dwordx4 v24, s[48:51], s24 offen offset:0  lds
    buffer_load_dwordx4 v25, s[48:51], s24 offen offset:1024  lds
    buffer_load_dwordx4 v26, s[48:51], s24 offen offset:2048  lds
    buffer_load_dwordx4 v27, s[48:51], s24 offen offset:3072  lds
    s_waitcnt vmcnt(12)
    s_barrier
    s_add_u32 s26, s28, 3
    s_and_b32 s26, s26, 15
    s_lshl_b32 s24, s26, 7
    s_lshl_b32 s25, s26, 19
    s_add_u32 m0, s27, 16384
    s_nop 0
    buffer_load_dwordx4 v16, s[44:47], s24 offen offset:0  lds
    buffer_load_dwordx4 v17, s[44:47], s24 offen offset:1024  lds
    buffer_load_dwordx4 v18, s[44:47], s24 offen offset:2048  lds
    buffer_load_dwordx4 v19, s[44:47], s24 offen offset:3072  lds
    s_add_u32 m0, s18, 82048
    s_nop 0
    buffer_load_dwordx4 v20, s[56:59], s25 offen offset:0  lds
    buffer_load_dwordx4 v21, s[56:59], s25 offen offset:1024  lds
    buffer_load_dwordx4 v22, s[56:59], s25 offen offset:2080  lds
    buffer_load_dwordx4 v23, s[56:59], s25 offen offset:3104  lds
    s_waitcnt vmcnt(8)
    s_barrier
    s_add_u32 s26, s28, 7
    s_and_b32 s26, s26, 15
    s_lshl_b32 s24, s26, 7
    s_lshl_b32 s25, s26, 19
    s_add_u32 m0, s27, 32768
    s_nop 0
    buffer_load_dwordx4 v16, s[44:47], s24 offen offset:0  lds
    buffer_load_dwordx4 v17, s[44:47], s24 offen offset:1024  lds
    buffer_load_dwordx4 v18, s[44:47], s24 offen offset:2048  lds
    buffer_load_dwordx4 v19, s[44:47], s24 offen offset:3072  lds
    s_add_u32 m0, s18, 98560
    s_nop 0
    buffer_load_dwordx4 v20, s[56:59], s25 offen offset:0  lds
    buffer_load_dwordx4 v21, s[56:59], s25 offen offset:1024  lds
    buffer_load_dwordx4 v22, s[56:59], s25 offen offset:2080  lds
    buffer_load_dwordx4 v23, s[56:59], s25 offen offset:3104  lds
    s_waitcnt vmcnt(8)
    s_barrier
    s_add_u32 s26, s28, 11
    s_and_b32 s26, s26, 15
    s_lshl_b32 s24, s26, 7
    s_lshl_b32 s25, s26, 19
    s_add_u32 m0, s27, 49152
    s_nop 0
    buffer_load_dwordx4 v16, s[44:47], s24 offen offset:0  lds
    buffer_load_dwordx4 v17, s[44:47], s24 offen offset:1024  lds
    buffer_load_dwordx4 v18, s[44:47], s24 offen offset:2048  lds
    buffer_load_dwordx4 v19, s[44:47], s24 offen offset:3072  lds
    s_add_u32 m0, s18, 115072
    s_nop 0
    buffer_load_dwordx4 v20, s[56:59], s25 offen offset:0  lds
    buffer_load_dwordx4 v21, s[56:59], s25 offen offset:1024  lds
    buffer_load_dwordx4 v22, s[56:59], s25 offen offset:2080  lds
    buffer_load_dwordx4 v23, s[56:59], s25 offen offset:3104  lds
    s_waitcnt vmcnt(8)
    s_barrier
    s_add_u32 s26, s15, 3
    s_and_b32 s26, s26, 7
    s_lshl_b32 s24, s26, 13
    s_lshl_b32 s25, s26, 18
    s_add_u32 m0, s27, 0
    s_nop 0
    buffer_load_dwordx4 v24, s[52:55], s24 offen offset:0  lds
    buffer_load_dwordx4 v25, s[52:55], s24 offen offset:1024  lds
    buffer_load_dwordx4 v26, s[52:55], s24 offen offset:2048  lds
    buffer_load_dwordx4 v27, s[52:55], s24 offen offset:3072  lds
    s_add_u32 m0, s18, 65536
    s_nop 0
    buffer_load_dwordx4 v28, s[60:63], s25 offen offset:0  lds
    buffer_load_dwordx4 v29, s[60:63], s25 offen offset:1024  lds
    buffer_load_dwordx4 v30, s[60:63], s25 offen offset:2080  lds
    buffer_load_dwordx4 v31, s[60:63], s25 offen offset:3104  lds
    s_waitcnt vmcnt(8)
    s_barrier
    s_add_u32 s26, s15, 3
    s_and_b32 s26, s26, 7
    s_lshl_b32 s24, s26, 13
    s_lshl_b32 s25, s26, 18
    s_add_u32 s24, s24, 128
    s_add_u32 s25, s25, 131072
    s_add_u32 m0, s27, 16384
    s_nop 0
    buffer_load_dwordx4 v24, s[52:55], s24 offen offset:0  lds
    buffer_load_dwordx4 v25, s[52:55], s24 offen offset:1024  lds
    buffer_load_dwordx4 v26, s[52:55], s24 offen offset:2048  lds
    buffer_load_dwordx4 v27, s[52:55], s24 offen offset:3072  lds
    s_add_u32 m0, s18, 82048
    s_nop 0
    buffer_load_dwordx4 v28, s[60:63], s25 offen offset:0  lds
    buffer_load_dwordx4 v29, s[60:63], s25 offen offset:1024  lds
    buffer_load_dwordx4 v30, s[60:63], s25 offen offset:2080  lds
    buffer_load_dwordx4 v31, s[60:63], s25 offen offset:3104  lds
    s_waitcnt vmcnt(8)
    s_barrier
    s_add_u32 s26, s15, 0
    s_and_b32 s26, s26, 7
    s_lshl_b32 s24, s26, 13
    s_lshl_b32 s25, s26, 18
    s_add_u32 m0, s27, 32768
    s_nop 0
    buffer_load_dwordx4 v24, s[52:55], s24 offen offset:0  lds
    buffer_load_dwordx4 v25, s[52:55], s24 offen offset:1024  lds
    buffer_load_dwordx4 v26, s[52:55], s24 offen offset:2048  lds
    buffer_load_dwordx4 v27, s[52:55], s24 offen offset:3072  lds
    s_add_u32 m0, s18, 98560
    s_nop 0
    buffer_load_dwordx4 v28, s[60:63], s25 offen offset:0  lds
    buffer_load_dwordx4 v29, s[60:63], s25 offen offset:1024  lds
    buffer_load_dwordx4 v30, s[60:63], s25 offen offset:2080  lds
    buffer_load_dwordx4 v31, s[60:63], s25 offen offset:3104  lds
    s_waitcnt vmcnt(8)
    s_barrier
    s_add_u32 s26, s15, 0
    s_and_b32 s26, s26, 7
    s_lshl_b32 s24, s26, 13
    s_lshl_b32 s25, s26, 18
    s_add_u32 s24, s24, 128
    s_add_u32 s25, s25, 131072
    s_add_u32 m0, s27, 49152
    s_nop 0
    buffer_load_dwordx4 v24, s[52:55], s24 offen offset:0  lds
    buffer_load_dwordx4 v25, s[52:55], s24 offen offset:1024  lds
    buffer_load_dwordx4 v26, s[52:55], s24 offen offset:2048  lds
    buffer_load_dwordx4 v27, s[52:55], s24 offen offset:3072  lds
    s_add_u32 m0, s18, 115072
    s_nop 0
    buffer_load_dwordx4 v28, s[60:63], s25 offen offset:0  lds
    buffer_load_dwordx4 v29, s[60:63], s25 offen offset:1024  lds
    buffer_load_dwordx4 v30, s[60:63], s25 offen offset:2080  lds
    buffer_load_dwordx4 v31, s[60:63], s25 offen offset:3104  lds
    s_waitcnt vmcnt(8)
    s_barrier
    s_add_u32 s26, s15, 1
    s_and_b32 s26, s26, 7
    s_lshl_b32 s24, s26, 13
    s_lshl_b32 s25, s26, 18
    s_add_u32 m0, s27, 0
    s_nop 0
    buffer_load_dwordx4 v24, s[52:55], s24 offen offset:0  lds
    buffer_load_dwordx4 v25, s[52:55], s24 offen offset:1024  lds
    buffer_load_dwordx4 v26, s[52:55], s24 offen offset:2048  lds
    buffer_load_dwordx4 v27, s[52:55], s24 offen offset:3072  lds
    s_add_u32 m0, s18, 65536
    s_nop 0
    buffer_load_dwordx4 v28, s[60:63], s25 offen offset:0  lds
    buffer_load_dwordx4 v29, s[60:63], s25 offen offset:1024  lds
    buffer_load_dwordx4 v30, s[60:63], s25 offen offset:2080  lds
    buffer_load_dwordx4 v31, s[60:63], s25 offen offset:3104  lds
    s_waitcnt vmcnt(8)
    s_barrier
    s_add_u32 s26, s15, 1
    s_and_b32 s26, s26, 7
    s_lshl_b32 s24, s26, 13
    s_lshl_b32 s25, s26, 18
    s_add_u32 s24, s24, 128
    s_add_u32 s25, s25, 131072
    s_add_u32 m0, s27, 16384
    s_nop 0
    buffer_load_dwordx4 v24, s[52:55], s24 offen offset:0  lds
    buffer_load_dwordx4 v25, s[52:55], s24 offen offset:1024  lds
    buffer_load_dwordx4 v26, s[52:55], s24 offen offset:2048  lds
    buffer_load_dwordx4 v27, s[52:55], s24 offen offset:3072  lds
    s_add_u32 m0, s18, 82048
    s_nop 0
    buffer_load_dwordx4 v28, s[60:63], s25 offen offset:0  lds
    buffer_load_dwordx4 v29, s[60:63], s25 offen offset:1024  lds
    buffer_load_dwordx4 v30, s[60:63], s25 offen offset:2080  lds
    buffer_load_dwordx4 v31, s[60:63], s25 offen offset:3104  lds
    s_waitcnt vmcnt(8)
    s_barrier
    s_add_u32 s26, s15, 2
    s_and_b32 s26, s26, 7
    s_lshl_b32 s24, s26, 13
    s_lshl_b32 s25, s26, 18
    s_add_u32 m0, s27, 32768
    s_nop 0
    buffer_load_dwordx4 v24, s[52:55], s24 offen offset:0  lds
    buffer_load_dwordx4 v25, s[52:55], s24 offen offset:1024  lds
    buffer_load_dwordx4 v26, s[52:55], s24 offen offset:2048  lds
    buffer_load_dwordx4 v27, s[52:55], s24 offen offset:3072  lds
    s_add_u32 m0, s18, 98560
    s_nop 0
    buffer_load_dwordx4 v28, s[60:63], s25 offen offset:0  lds
    buffer_load_dwordx4 v29, s[60:63], s25 offen offset:1024  lds
    buffer_load_dwordx4 v30, s[60:63], s25 offen offset:2080  lds
    buffer_load_dwordx4 v31, s[60:63], s25 offen offset:3104  lds
    s_waitcnt vmcnt(8)
    s_barrier
    s_add_u32 s26, s15, 2
    s_and_b32 s26, s26, 7
    s_lshl_b32 s24, s26, 13
    s_lshl_b32 s25, s26, 18
    s_add_u32 s24, s24, 128
    s_add_u32 s25, s25, 131072
    s_add_u32 m0, s27, 49152
    s_nop 0
    buffer_load_dwordx4 v24, s[52:55], s24 offen offset:0  lds
    buffer_load_dwordx4 v25, s[52:55], s24 offen offset:1024  lds
    buffer_load_dwordx4 v26, s[52:55], s24 offen offset:2048  lds
    buffer_load_dwordx4 v27, s[52:55], s24 offen offset:3072  lds
    s_add_u32 m0, s18, 115072
    s_nop 0
    buffer_load_dwordx4 v28, s[60:63], s25 offen offset:0  lds
    buffer_load_dwordx4 v29, s[60:63], s25 offen offset:1024  lds
    buffer_load_dwordx4 v30, s[60:63], s25 offen offset:2080  lds
    buffer_load_dwordx4 v31, s[60:63], s25 offen offset:3104  lds
    s_waitcnt vmcnt(8)
    s_barrier
    buffer_load_dwordx2 v[34:35], v32, s[64:67], s32 offen sc1
    s_add_u32 s26, s15, 7
    s_and_b32 s26, s26, 7
    s_lshl_b32 s24, s26, 13
    s_lshl_b32 s25, s26, 18
    s_add_u32 m0, s18, 65536
    s_nop 0
    buffer_load_dwordx4 v28, s[60:63], s25 offen offset:0  lds
    buffer_load_dwordx4 v29, s[60:63], s25 offen offset:1024  lds
    buffer_load_dwordx4 v30, s[60:63], s25 offen offset:2080  lds
    buffer_load_dwordx4 v31, s[60:63], s25 offen offset:3104  lds
    s_add_u32 m0, s27, 0
    s_nop 0
    buffer_load_dwordx4 v24, s[52:55], s24 offen offset:0  lds
    buffer_load_dwordx4 v25, s[52:55], s24 offen offset:1024  lds
    buffer_load_dwordx4 v26, s[52:55], s24 offen offset:2048  lds
    buffer_load_dwordx4 v27, s[52:55], s24 offen offset:3072  lds
    s_waitcnt vmcnt(8)
    s_barrier
    s_mov_b32 s20, 1048576
PC3:
    v_cmp_ne_u64 vcc, v[34:35], v[36:37]
    s_cbranch_vccz PG3
    s_sub_u32 s20, s20, 1
    s_cbranch_scc1 PG3
    buffer_load_dwordx2 v[34:35], v32, s[64:67], s32 offen sc1
    s_waitcnt vmcnt(0)
    s_branch PC3
PG3:
    s_add_u32 s10, s15, 0
    s_and_b32 s10, s10, 7
    s_lshl_b32 s10, s10, 11
    s_add_u32 m0, s35, 0
    s_add_u32 s10, s10, s34
    buffer_load_dwordx4 v10, s[64:67], s10 offen offset:0 sc1 lds
    buffer_load_dwordx4 v10, s[64:67], s10 offen offset:1024 sc1 lds
    s_add_u32 s10, s15, 1
    s_and_b32 s10, s10, 7
    s_lshl_b32 s10, s10, 11
    s_add_u32 m0, s35, 2048
    s_add_u32 s10, s10, s34
    buffer_load_dwordx4 v10, s[64:67], s10 offen offset:0 sc1 lds
    buffer_load_dwordx4 v10, s[64:67], s10 offen offset:1024 sc1 lds
    s_add_u32 s10, s15, 2
    s_and_b32 s10, s10, 7
    s_lshl_b32 s10, s10, 11
    s_add_u32 m0, s35, 4096
    s_add_u32 s10, s10, s34
    buffer_load_dwordx4 v10, s[64:67], s10 offen offset:0 sc1 lds
    buffer_load_dwordx4 v10, s[64:67], s10 offen offset:1024 sc1 lds
    s_add_u32 s26, s15, 7
    s_and_b32 s26, s26, 7
    s_lshl_b32 s24, s26, 13
    s_lshl_b32 s25, s26, 18
    s_add_u32 s24, s24, 128
    s_add_u32 s25, s25, 131072
    s_add_u32 m0, s18, 82048
    s_nop 0
    buffer_load_dwordx4 v28, s[60:63], s25 offen offset:0  lds
    buffer_load_dwordx4 v29, s[60:63], s25 offen offset:1024  lds
    buffer_load_dwordx4 v30, s[60:63], s25 offen offset:2080  lds
    buffer_load_dwordx4 v31, s[60:63], s25 offen offset:3104  lds
    s_add_u32 m0, s27, 16384
    s_nop 0
    buffer_load_dwordx4 v24, s[52:55], s24 offen offset:0  lds
    buffer_load_dwordx4 v25, s[52:55], s24 offen offset:1024  lds
    buffer_load_dwordx4 v26, s[52:55], s24 offen offset:2048  lds
    buffer_load_dwordx4 v27, s[52:55], s24 offen offset:3072  lds
    s_waitcnt vmcnt(8)
    s_barrier
    s_add_u32 s26, s15, 4
    s_and_b32 s26, s26, 7
    s_lshl_b32 s24, s26, 13
    s_lshl_b32 s25, s26, 18
    s_add_u32 m0, s27, 32768
    s_nop 0
    buffer_load_dwordx4 v24, s[52:55], s24 offen offset:0  lds
    buffer_load_dwordx4 v25, s[52:55], s24 offen offset:1024  lds
    buffer_load_dwordx4 v26, s[52:55], s24 offen offset:2048  lds
    buffer_load_dwordx4 v27, s[52:55], s24 offen offset:3072  lds
    s_add_u32 m0, s18, 98560
    s_nop 0
    buffer_load_dwordx4 v28, s[60:63], s25 offen offset:0  lds
    buffer_load_dwordx4 v29, s[60:63], s25 offen offset:1024  lds
    buffer_load_dwordx4 v30, s[60:63], s25 offen offset:2080  lds
    buffer_load_dwordx4 v31, s[60:63], s25 offen offset:3104  lds
    s_waitcnt vmcnt(8)
    s_barrier
    s_add_u32 s10, s15, 7
    s_and_b32 s10, s10, 7
    s_lshl_b32 s10, s10, 11
    s_add_u32 m0, s35, 0
    s_add_u32 s10, s10, s34
    buffer_load_dwordx4 v10, s[64:67], s10 offen offset:0 sc1 lds
    buffer_load_dwordx4 v10, s[64:67], s10 offen offset:1024 sc1 lds
    s_add_u32 s10, s15, 4
    s_and_b32 s10, s10, 7
    s_lshl_b32 s10, s10, 11
    s_add_u32 m0, s35, 2048
    s_add_u32 s10, s10, s34
    buffer_load_dwordx4 v10, s[64:67], s10 offen offset:0 sc1 lds
    buffer_load_dwordx4 v10, s[64:67], s10 offen offset:1024 sc1 lds
    s_add_u32 s26, s15, 4
    s_and_b32 s26, s26, 7
    s_lshl_b32 s24, s26, 13
    s_lshl_b32 s25, s26, 18
    s_add_u32 s24, s24, 128
    s_add_u32 s25, s25, 131072
    s_add_u32 m0, s27, 49152
    s_nop 0
    buffer_load_dwordx4 v24, s[52:55], s24 offen offset:0  lds
    buffer_load_dwordx4 v25, s[52:55], s24 offen offset:1024  lds
    buffer_load_dwordx4 v26, s[52:55], s24 offen offset:2048  lds
    buffer_load_dwordx4 v27, s[52:55], s24 offen offset:3072  lds
    s_add_u32 m0, s18, 115072
    s_nop 0
    buffer_load_dwordx4 v28, s[60:63], s25 offen offset:0  lds
    buffer_load_dwordx4 v29, s[60:63], s25 offen offset:1024  lds
    buffer_load_dwordx4 v30, s[60:63], s25 offen offset:2080  lds
    buffer_load_dwordx4 v31, s[60:63], s25 offen offset:3104  lds
    s_waitcnt vmcnt(12)
    s_barrier
    s_add_u32 s26, s15, 5
    s_and_b32 s26, s26, 7
    s_lshl_b32 s24, s26, 13
    s_lshl_b32 s25, s26, 18
    s_add_u32 m0, s27, 0
    s_nop 0
    buffer_load_dwordx4 v24, s[52:55], s24 offen offset:0  lds
    buffer_load_dwordx4 v25, s[52:55], s24 offen offset:1024  lds
    buffer_load_dwordx4 v26, s[52:55], s24 offen offset:2048  lds
    buffer_load_dwordx4 v27, s[52:55], s24 offen offset:3072  lds
    s_add_u32 m0, s18, 65536
    s_nop 0
    buffer_load_dwordx4 v28, s[60:63], s25 offen offset:0  lds
    buffer_load_dwordx4 v29, s[60:63], s25 offen offset:1024  lds
    buffer_load_dwordx4 v30, s[60:63], s25 offen offset:2080  lds
    buffer_load_dwordx4 v31, s[60:63], s25 offen offset:3104  lds
    s_waitcnt vmcnt(8)
    s_barrier
    s_add_u32 s10, s15, 5
    s_and_b32 s10, s10, 7
    s_lshl_b32 s10, s10, 11
    s_add_u32 m0, s35, 4096
    s_add_u32 s10, s10, s34
    buffer_load_dwordx4 v10, s[64:67], s10 offen offset:0 sc1 lds
    buffer_load_dwordx4 v10, s[64:67], s10 offen offset:1024 sc1 lds
    s_add_u32 s26, s15, 5
    s_and_b32 s26, s26, 7
    s_lshl_b32 s24, s26, 13
    s_lshl_b32 s25, s26, 18
    s_add_u32 s24, s24, 128
    s_add_u32 s25, s25, 131072
    s_add_u32 m0, s27, 16384
    s_nop 0
    buffer_load_dwordx4 v24, s[52:55], s24 offen offset:0  lds
    buffer_load_dwordx4 v25, s[52:55], s24 offen offset:1024  lds
    buffer_load_dwordx4 v26, s[52:55], s24 offen offset:2048  lds
    buffer_load_dwordx4 v27, s[52:55], s24 offen offset:3072  lds
    s_add_u32 m0, s18, 82048
    s_nop 0
    buffer_load_dwordx4 v28, s[60:63], s25 offen offset:0  lds
    buffer_load_dwordx4 v29, s[60:63], s25 offen offset:1024  lds
    buffer_load_dwordx4 v30, s[60:63], s25 offen offset:2080  lds
    buffer_load_dwordx4 v31, s[60:63], s25 offen offset:3104  lds
    s_waitcnt vmcnt(10)
    s_barrier
    s_add_u32 s26, s15, 6
    s_and_b32 s26, s26, 7
    s_lshl_b32 s24, s26, 13
    s_lshl_b32 s25, s26, 18
    s_add_u32 m0, s27, 32768
    s_nop 0
    buffer_load_dwordx4 v24, s[52:55], s24 offen offset:0  lds
    buffer_load_dwordx4 v25, s[52:55], s24 offen offset:1024  lds
    buffer_load_dwordx4 v26, s[52:55], s24 offen offset:2048  lds
    buffer_load_dwordx4 v27, s[52:55], s24 offen offset:3072  lds
    s_add_u32 m0, s18, 98560
    s_nop 0
    buffer_load_dwordx4 v28, s[60:63], s25 offen offset:0  lds
    buffer_load_dwordx4 v29, s[60:63], s25 offen offset:1024  lds
    buffer_load_dwordx4 v30, s[60:63], s25 offen offset:2080  lds
    buffer_load_dwordx4 v31, s[60:63], s25 offen offset:3104  lds
    s_waitcnt vmcnt(8)
    s_barrier
    s_add_u32 s10, s15, 6
    s_and_b32 s10, s10, 7
    s_lshl_b32 s10, s10, 11
    s_add_u32 m0, s35, 0
    s_add_u32 s10, s10, s34
    buffer_load_dwordx4 v10, s[64:67], s10 offen offset:0 sc1 lds
    buffer_load_dwordx4 v10, s[64:67], s10 offen offset:1024 sc1 lds
    s_add_u32 s26, s15, 6
    s_and_b32 s26, s26, 7
    s_lshl_b32 s24, s26, 13
    s_lshl_b32 s25, s26, 18
    s_add_u32 s24, s24, 128
    s_add_u32 s25, s25, 131072
    s_add_u32 m0, s27, 49152
    s_nop 0
    buffer_load_dwordx4 v24, s[52:55], s24 offen offset:0  lds
    buffer_load_dwordx4 v25, s[52:55], s24 offen offset:1024  lds
    buffer_load_dwordx4 v26, s[52:55], s24 offen offset:2048  lds
    buffer_load_dwordx4 v27, s[52:55], s24 offen offset:3072  lds
    s_add_u32 m0, s18, 115072
    s_nop 0
    buffer_load_dwordx4 v28, s[60:63], s25 offen offset:0  lds
    buffer_load_dwordx4 v29, s[60:63], s25 offen offset:1024  lds
    buffer_load_dwordx4 v30, s[60:63], s25 offen offset:2080  lds
    buffer_load_dwordx4 v31, s[60:63], s25 offen offset:3104  lds
    s_waitcnt vmcnt(10)
    s_barrier
    s_waitcnt vmcnt(0)
    s_barrier
    s_endpgm
COMPUTE:
    s_memrealtime s[42:43]
    s_setprio 1
    s_mov_b32 s8, s14
    s_lshl_b32 s9, s4, 2
    s_add_u32 s9, s9, s8
    s_waitcnt lgkmcnt(0)
    s_lshl_b32 s27, s8, 12
    v_and_b32 v12, 15, v2
    v_lshrrev_b32 v13, 4, v2
    v_lshrrev_b32 v14, 1, v12
    v_lshlrev_b32 v15, 7, v12
    v_add_u32 v15, s27, v15
    v_xor_b32 v16, v14, v13
    v_lshl_add_u32 v4, v16, 4, v15
    v_xor_b32 v5, 64, v4
    v_lshrrev_b32 v16, 1, v13
    v_xor_b32 v16, v16, v14
    v_lshl_add_u32 v16, v16, 4, v15
    v_and_b32 v17, 1, v13
    v_lshl_add_u32 v16, v17, 3, v16
    v_add_u32 v11, 131584, v16
    v_bfe_u32 v12, v2, 2, 2
    v_bfe_u32 v13, v2, 4, 1
    v_lshrrev_b32 v14, 5, v2
    v_and_b32 v15, 3, v2
    v_mul_u32_u24 v13, 2080, v13
    v_mul_u32_u24 v14, 4128, v14
    v_add3_u32 v16, v13, v14, 0
    v_lshl_add_u32 v16, v12, 8, v16
    v_lshl_add_u32 v16, v15, 3, v16
    v_add_u32 v16, 65536, v16
    v_xor_b32 v17, 0, v12
    v_lshl_add_u32 v6, v17, 6, v16
    v_xor_b32 v17, 1, v12
    v_lshl_add_u32 v7, v17, 6, v16
    v_xor_b32 v17, 2, v12
    v_lshl_add_u32 v8, v17, 6, v16
    v_xor_b32 v17, 3, v12
    v_lshl_add_u32 v9, v17, 6, v16
    s_mov_b32 s64, s40
    s_mov_b32 s65, s41
    s_mov_b32 s66, 0x1000000
    s_mov_b32 s67, 0x00020000
    s_mov_b32 s68, s36
    s_mov_b32 s69, s37
    s_mov_b32 s70, 0x200000
    s_mov_b32 s71, 0x00020000
    s_mov_b32 s72, s38
    s_mov_b32 s73, s39
    s_mov_b32 s74, 0x100
    s_mov_b32 s75, 0x00020000
    s_or_b32 s13, s2, s8
    s_cmp_lg_u32 s13, 0
    s_cbranch_scc1 NOTAG
    v_mov_b32 v12, s42
    v_mov_b32 v13, s43
    buffer_store_dwordx2 v[12:13], off, s[72:75], 0 sc0 sc1
NOTAG:
    s_mov_b32 s34, 0x3e0293ee
    s_lshl_b32 s30, s5, 4
    s_add_u32 s30, s30, s9
    s_lshl_b32 s31, s30, 2
    s_add_u32 s31, s31, s6
    s_lshl_b32 s31, s31, 4
    s_add_u32 s31, s31, s7
    s_lshl_b32 s31, s31, 3
    s_add_u32 s31, s31, 2097152
    s_lshl_b32 s30, s30, 5
    s_add_u32 s30, s30, s12
    s_lshl_b32 s30, s30, 11
    s_mul_i32 s32, s8, 6144
    s_add_u32 s32, s32, 131584
    s_lshl_b32 s19, s5, 2
    s_add_u32 s19, s19, s4
    s_lshl_b32 s19, s19, 3
    s_add_u32 s19, s19, s15
    s_mul_i32 s19, s19, 196608
    s_add_u32 s19, s19, s27
    s_add_u32 s19, s19, 4194304
    s_xor_b32 s22, s6, 1
    s_mul_i32 s22, s22, 49152
    s_add_u32 s22, s22, s19
    s_add_u32 s22, s22, 0
    s_xor_b32 s23, s6, 2
    s_mul_i32 s23, s23, 49152
    s_add_u32 s23, s23, s19
    s_add_u32 s23, s23, 16384
    s_xor_b32 s24, s6, 3
    s_mul_i32 s24, s24, 49152
    s_add_u32 s24, s24, s19
    s_add_u32 s24, s24, 32768
    s_mul_i32 s25, s6, 49152
    s_add_u32 s25, s25, s19
    s_add_u32 s26, s25, 16384
    s_add_u32 s28, s25, 32768
    s_lshl_b32 s29, s9, 17
    s_lshl_b32 s11, s5, 11
    s_add_u32 s29, s29, s11
    s_lshl_b32 s11, s15, 8
    s_add_u32 s29, s29, s11
    s_lshl_b32 s11, s6, 6
    s_add_u32 s29, s29, s11
    s_barrier
    ds_read_b128 a[32:35], v4 offset:0
    ds_read_b64_tr_b16 a[0:1], v6 offset:0
    ds_read_b64_tr_b16 a[2:3], v6 offset:1024
    ds_read_b64_tr_b16 a[4:5], v6 offset:32
    ds_read_b64_tr_b16 a[6:7], v6 offset:1056
    ds_read_b64_tr_b16 a[8:9], v7 offset:0
    ds_read_b64_tr_b16 a[10:11], v7 offset:1024
    ds_read_b64_tr_b16 a[12:13], v7 offset:32
    ds_read_b64_tr_b16 a[14:15], v7 offset:1056
    ds_read_b128 a[36:39], v4 offset:2048
    ds_read_b64_tr_b16 a[16:17], v8 offset:0
    ds_read_b64_tr_b16 a[18:19], v8 offset:1024
    ds_read_b64_tr_b16 a[20:21], v8 offset:32
    ds_read_b64_tr_b16 a[22:23], v8 offset:1056
    ds_read_b64_tr_b16 a[24:25], v9 offset:0
    ds_read_b64_tr_b16 a[26:27], v9 offset:1024
    ds_read_b64_tr_b16 a[28:29], v9 offset:32
    ds_read_b64_tr_b16 a[30:31], v9 offset:1056
    s_waitcnt lgkmcnt(14)
    v_mfma_f32_16x16x32_bf16 v[12:15], a[0:3], a[32:35], 0
    s_waitcnt lgkmcnt(13)
    v_mfma_f32_16x16x32_bf16 v[20:23], a[4:7], a[32:35], 0
    s_waitcnt lgkmcnt(11)
    v_mfma_f32_16x16x32_bf16 v[28:31], a[8:11], a[32:35], 0
    s_waitcnt lgkmcnt(9)
    v_mfma_f32_16x16x32_bf16 v[36:39], a[12:15], a[32:35], 0
    ds_read_b128 a[40:43], v5 offset:0
    s_waitcnt lgkmcnt(9)
    v_mfma_f32_16x16x32_bf16 v[16:19], a[0:3], a[36:39], 0
    ds_read_b64_tr_b16 a[0:1], v6 offset:8256
    ds_read_b64_tr_b16 a[2:3], v6 offset:9280
    v_mfma_f32_16x16x32_bf16 v[24:27], a[4:7], a[36:39], 0
    ds_read_b64_tr_b16 a[4:5], v6 offset:8288
    ds_read_b64_tr_b16 a[6:7], v6 offset:9312
    v_mfma_f32_16x16x32_bf16 v[32:35], a[8:11], a[36:39], 0
    ds_read_b64_tr_b16 a[8:9], v7 offset:8256
    ds_read_b64_tr_b16 a[10:11], v7 offset:9280
    v_mfma_f32_16x16x32_bf16 v[40:43], a[12:15], a[36:39], 0
    ds_read_b64_tr_b16 a[12:13], v7 offset:8288
    ds_read_b64_tr_b16 a[14:15], v7 offset:9312
    s_waitcnt lgkmcnt(9)
    v_mfma_f32_16x16x32_bf16 v[44:47], a[16:19], a[32:35], 0
    v_mfma_f32_16x16x32_bf16 v[52:55], a[20:23], a[32:35], 0
    v_mfma_f32_16x16x32_bf16 v[60:63], a[24:27], a[32:35], 0
    v_mfma_f32_16x16x32_bf16 v[68:71], a[28:31], a[32:35], 0
    ds_read_b128 a[32:35], v5 offset:2048
    v_mfma_f32_16x16x32_bf16 v[48:51], a[16:19], a[36:39], 0
    ds_read_b64_tr_b16 a[16:17], v8 offset:8256
    ds_read_b64_tr_b16 a[18:19], v8 offset:9280
    v_mfma_f32_16x16x32_bf16 v[56:59], a[20:23], a[36:39], 0
    ds_read_b64_tr_b16 a[20:21], v8 offset:8288
    ds_read_b64_tr_b16 a[22:23], v8 offset:9312
    v_mfma_f32_16x16x32_bf16 v[64:67], a[24:27], a[36:39], 0
    ds_read_b64_tr_b16 a[24:25], v9 offset:8256
    ds_read_b64_tr_b16 a[26:27], v9 offset:9280
    v_mfma_f32_16x16x32_bf16 v[72:75], a[28:31], a[36:39], 0
    ds_read_b64_tr_b16 a[28:29], v9 offset:8288
    ds_read_b64_tr_b16 a[30:31], v9 offset:9312
    s_waitcnt lgkmcnt(9)
    v_mfma_f32_16x16x32_bf16 v[12:15], a[0:3], a[40:43], v[12:15]
    v_mfma_f32_16x16x32_bf16 v[20:23], a[4:7], a[40:43], v[20:23]
    v_mfma_f32_16x16x32_bf16 v[28:31], a[8:11], a[40:43], v[28:31]
    v_mfma_f32_16x16x32_bf16 v[36:39], a[12:15], a[40:43], v[36:39]
    s_barrier
    ds_read_b128 a[36:39], v4 offset:16384
    s_waitcnt lgkmcnt(3)
    v_mfma_f32_16x16x32_bf16 v[16:19], a[0:3], a[32:35], v[16:19]
    ds_read_b64_tr_b16 a[0:1], v6 offset:16512
    ds_read_b64_tr_b16 a[2:3], v6 offset:17536
    v_mfma_f32_16x16x32_bf16 v[24:27], a[4:7], a[32:35], v[24:27]
    ds_read_b64_tr_b16 a[4:5], v6 offset:16544
    ds_read_b64_tr_b16 a[6:7], v6 offset:17568
    v_mfma_f32_16x16x32_bf16 v[32:35], a[8:11], a[32:35], v[32:35]
    ds_read_b64_tr_b16 a[8:9], v7 offset:16512
    ds_read_b64_tr_b16 a[10:11], v7 offset:17536
    v_mfma_f32_16x16x32_bf16 v[40:43], a[12:15], a[32:35], v[40:43]
    ds_read_b64_tr_b16 a[12:13], v7 offset:16544
    ds_read_b64_tr_b16 a[14:15], v7 offset:17568
    v_mfma_f32_16x16x32_bf16 v[44:47], a[16:19], a[40:43], v[44:47]
    v_mfma_f32_16x16x32_bf16 v[52:55], a[20:23], a[40:43], v[52:55]
    v_mfma_f32_16x16x32_bf16 v[60:63], a[24:27], a[40:43], v[60:63]
    s_waitcnt lgkmcnt(4)
    v_mfma_f32_16x16x32_bf16 v[68:71], a[28:31], a[40:43], v[68:71]
    s_barrier
    ds_read_b128 a[40:43], v4 offset:18432
    v_mfma_f32_16x16x32_bf16 v[48:51], a[16:19], a[32:35], v[48:51]
    ds_read_b64_tr_b16 a[16:17], v8 offset:16512
    ds_read_b64_tr_b16 a[18:19], v8 offset:17536
    v_mfma_f32_16x16x32_bf16 v[56:59], a[20:23], a[32:35], v[56:59]
    ds_read_b64_tr_b16 a[20:21], v8 offset:16544
    ds_read_b64_tr_b16 a[22:23], v8 offset:17568
    v_mfma_f32_16x16x32_bf16 v[64:67], a[24:27], a[32:35], v[64:67]
    ds_read_b64_tr_b16 a[24:25], v9 offset:16512
    ds_read_b64_tr_b16 a[26:27], v9 offset:17536
    v_mfma_f32_16x16x32_bf16 v[72:75], a[28:31], a[32:35], v[72:75]
    ds_read_b64_tr_b16 a[28:29], v9 offset:16544
    ds_read_b64_tr_b16 a[30:31], v9 offset:17568
    v_mfma_f32_16x16x32_bf16 v[12:15], a[0:3], a[36:39], v[12:15]
    v_mfma_f32_16x16x32_bf16 v[20:23], a[4:7], a[36:39], v[20:23]
    s_waitcnt lgkmcnt(6)
    v_mfma_f32_16x16x32_bf16 v[28:31], a[8:11], a[36:39], v[28:31]
    v_mfma_f32_16x16x32_bf16 v[36:39], a[12:15], a[36:39], v[36:39]
    ds_read_b128 a[32:35], v5 offset:16384
    v_mfma_f32_16x16x32_bf16 v[16:19], a[0:3], a[40:43], v[16:19]
    ds_read_b64_tr_b16 a[0:1], v6 offset:24768
    ds_read_b64_tr_b16 a[2:3], v6 offset:25792
    v_mfma_f32_16x16x32_bf16 v[24:27], a[4:7], a[40:43], v[24:27]
    ds_read_b64_tr_b16 a[4:5], v6 offset:24800
    ds_read_b64_tr_b16 a[6:7], v6 offset:25824
    v_mfma_f32_16x16x32_bf16 v[32:35], a[8:11], a[40:43], v[32:35]
    ds_read_b64_tr_b16 a[8:9], v7 offset:24768
    ds_read_b64_tr_b16 a[10:11], v7 offset:25792
    v_mfma_f32_16x16x32_bf16 v[40:43], a[12:15], a[40:43], v[40:43]
    ds_read_b64_tr_b16 a[12:13], v7 offset:24800
    ds_read_b64_tr_b16 a[14:15], v7 offset:25824
    v_mfma_f32_16x16x32_bf16 v[44:47], a[16:19], a[36:39], v[44:47]
    s_waitcnt lgkmcnt(8)
    v_mfma_f32_16x16x32_bf16 v[52:55], a[20:23], a[36:39], v[52:55]
    v_mfma_f32_16x16x32_bf16 v[60:63], a[24:27], a[36:39], v[60:63]
    v_mfma_f32_16x16x32_bf16 v[68:71], a[28:31], a[36:39], v[68:71]
    ds_read_b128 a[36:39], v5 offset:18432
    v_mfma_f32_16x16x32_bf16 v[48:51], a[16:19], a[40:43], v[48:51]
    ds_read_b64_tr_b16 a[16:17], v8 offset:24768
    ds_read_b64_tr_b16 a[18:19], v8 offset:25792
    v_mfma_f32_16x16x32_bf16 v[56:59], a[20:23], a[40:43], v[56:59]
    ds_read_b64_tr_b16 a[20:21], v8 offset:24800
    ds_read_b64_tr_b16 a[22:23], v8 offset:25824
    v_mfma_f32_16x16x32_bf16 v[64:67], a[24:27], a[40:43], v[64:67]
    ds_read_b64_tr_b16 a[24:25], v9 offset:24768
    ds_read_b64_tr_b16 a[26:27], v9 offset:25792
    v_mfma_f32_16x16x32_bf16 v[72:75], a[28:31], a[40:43], v[72:75]
    ds_read_b64_tr_b16 a[28:29], v9 offset:24800
    ds_read_b64_tr_b16 a[30:31], v9 offset:25824
    s_waitcnt lgkmcnt(9)
    v_mfma_f32_16x16x32_bf16 v[12:15], a[0:3], a[32:35], v[12:15]
    v_mfma_f32_16x16x32_bf16 v[20:23], a[4:7], a[32:35], v[20:23]
    v_mfma_f32_16x16x32_bf16 v[28:31], a[8:11], a[32:35], v[28:31]
    v_mfma_f32_16x16x32_bf16 v[36:39], a[12:15], a[32:35], v[36:39]
    ds_read_b128 a[40:43], v4 offset:32768
    s_waitcnt lgkmcnt(3)
    v_mfma_f32_16x16x32_bf16 v[16:19], a[0:3], a[36:39], v[16:19]
    ds_read_b64_tr_b16 a[0:1], v6 offset:33024
    ds_read_b64_tr_b16 a[2:3], v6 offset:34048
    v_mfma_f32_16x16x32_bf16 v[24:27], a[4:7], a[36:39], v[24:27]
    ds_read_b64_tr_b16 a[4:5], v6 offset:33056
    ds_read_b64_tr_b16 a[6:7], v6 offset:34080
    v_mfma_f32_16x16x32_bf16 v[32:35], a[8:11], a[36:39], v[32:35]
    ds_read_b64_tr_b16 a[8:9], v7 offset:33024
    ds_read_b64_tr_b16 a[10:11], v7 offset:34048
    v_mfma_f32_16x16x32_bf16 v[40:43], a[12:15], a[36:39], v[40:43]
    ds_read_b64_tr_b16 a[12:13], v7 offset:33056
    ds_read_b64_tr_b16 a[14:15], v7 offset:34080
    v_mfma_f32_16x16x32_bf16 v[44:47], a[16:19], a[32:35], v[44:47]
    v_mfma_f32_16x16x32_bf16 v[52:55], a[20:23], a[32:35], v[52:55]
    v_mfma_f32_16x16x32_bf16 v[60:63], a[24:27], a[32:35], v[60:63]
    s_waitcnt lgkmcnt(4)
    v_mfma_f32_16x16x32_bf16 v[68:71], a[28:31], a[32:35], v[68:71]
    s_barrier
    ds_read_b128 a[32:35], v4 offset:34816
    v_mfma_f32_16x16x32_bf16 v[48:51], a[16:19], a[36:39], v[48:51]
    ds_read_b64_tr_b16 a[16:17], v8 offset:33024
    ds_read_b64_tr_b16 a[18:19], v8 offset:34048
    v_mfma_f32_16x16x32_bf16 v[56:59], a[20:23], a[36:39], v[56:59]
    ds_read_b64_tr_b16 a[20:21], v8 offset:33056
    ds_read_b64_tr_b16 a[22:23], v8 offset:34080
    v_mfma_f32_16x16x32_bf16 v[64:67], a[24:27], a[36:39], v[64:67]
    ds_read_b64_tr_b16 a[24:25], v9 offset:33024
    ds_read_b64_tr_b16 a[26:27], v9 offset:34048
    v_mfma_f32_16x16x32_bf16 v[72:75], a[28:31], a[36:39], v[72:75]
    ds_read_b64_tr_b16 a[28:29], v9 offset:33056
    ds_read_b64_tr_b16 a[30:31], v9 offset:34080
    v_mfma_f32_16x16x32_bf16 v[12:15], a[0:3], a[40:43], v[12:15]
    v_mfma_f32_16x16x32_bf16 v[20:23], a[4:7], a[40:43], v[20:23]
    s_waitcnt lgkmcnt(6)
    v_mfma_f32_16x16x32_bf16 v[28:31], a[8:11], a[40:43], v[28:31]
    v_mfma_f32_16x16x32_bf16 v[36:39], a[12:15], a[40:43], v[36:39]
    ds_read_b128 a[36:39], v5 offset:32768
    v_mfma_f32_16x16x32_bf16 v[16:19], a[0:3], a[32:35], v[16:19]
    ds_read_b64_tr_b16 a[0:1], v6 offset:41280
    ds_read_b64_tr_b16 a[2:3], v6 offset:42304
    v_mfma_f32_16x16x32_bf16 v[24:27], a[4:7], a[32:35], v[24:27]
    ds_read_b64_tr_b16 a[4:5], v6 offset:41312
    ds_read_b64_tr_b16 a[6:7], v6 offset:42336
    v_mfma_f32_16x16x32_bf16 v[32:35], a[8:11], a[32:35], v[32:35]
    ds_read_b64_tr_b16 a[8:9], v7 offset:41280
    ds_read_b64_tr_b16 a[10:11], v7 offset:42304
    v_mfma_f32_16x16x32_bf16 v[40:43], a[12:15], a[32:35], v[40:43]
    ds_read_b64_tr_b16 a[12:13], v7 offset:41312
    ds_read_b64_tr_b16 a[14:15], v7 offset:42336
    v_mfma_f32_16x16x32_bf16 v[44:47], a[16:19], a[40:43], v[44:47]
    s_waitcnt lgkmcnt(8)
    v_mfma_f32_16x16x32_bf16 v[52:55], a[20:23], a[40:43], v[52:55]
    v_mfma_f32_16x16x32_bf16 v[60:63], a[24:27], a[40:43], v[60:63]
    v_mfma_f32_16x16x32_bf16 v[68:71], a[28:31], a[40:43], v[68:71]
    ds_read_b128 a[40:43], v5 offset:34816
    v_mfma_f32_16x16x32_bf16 v[48:51], a[16:19], a[32:35], v[48:51]
    ds_read_b64_tr_b16 a[16:17], v8 offset:41280
    ds_read_b64_tr_b16 a[18:19], v8 offset:42304
    v_mfma_f32_16x16x32_bf16 v[56:59], a[20:23], a[32:35], v[56:59]
    ds_read_b64_tr_b16 a[20:21], v8 offset:41312
    ds_read_b64_tr_b16 a[22:23], v8 offset:42336
    v_mfma_f32_16x16x32_bf16 v[64:67], a[24:27], a[32:35], v[64:67]
    ds_read_b64_tr_b16 a[24:25], v9 offset:41280
    ds_read_b64_tr_b16 a[26:27], v9 offset:42304
    v_mfma_f32_16x16x32_bf16 v[72:75], a[28:31], a[32:35], v[72:75]
    ds_read_b64_tr_b16 a[28:29], v9 offset:41312
    ds_read_b64_tr_b16 a[30:31], v9 offset:42336
    s_waitcnt lgkmcnt(9)
    v_mfma_f32_16x16x32_bf16 v[12:15], a[0:3], a[36:39], v[12:15]
    v_mfma_f32_16x16x32_bf16 v[20:23], a[4:7], a[36:39], v[20:23]
    v_mfma_f32_16x16x32_bf16 v[28:31], a[8:11], a[36:39], v[28:31]
    v_mfma_f32_16x16x32_bf16 v[36:39], a[12:15], a[36:39], v[36:39]
    ds_read_b128 a[32:35], v4 offset:49152
    s_waitcnt lgkmcnt(3)
    v_mfma_f32_16x16x32_bf16 v[16:19], a[0:3], a[40:43], v[16:19]
    ds_read_b64_tr_b16 a[0:1], v6 offset:49536
    ds_read_b64_tr_b16 a[2:3], v6 offset:50560
    v_mfma_f32_16x16x32_bf16 v[24:27], a[4:7], a[40:43], v[24:27]
    ds_read_b64_tr_b16 a[4:5], v6 offset:49568
    ds_read_b64_tr_b16 a[6:7], v6 offset:50592
    v_mfma_f32_16x16x32_bf16 v[32:35], a[8:11], a[40:43], v[32:35]
    ds_read_b64_tr_b16 a[8:9], v7 offset:49536
    ds_read_b64_tr_b16 a[10:11], v7 offset:50560
    v_mfma_f32_16x16x32_bf16 v[40:43], a[12:15], a[40:43], v[40:43]
    ds_read_b64_tr_b16 a[12:13], v7 offset:49568
    ds_read_b64_tr_b16 a[14:15], v7 offset:50592
    v_mfma_f32_16x16x32_bf16 v[44:47], a[16:19], a[36:39], v[44:47]
    v_mfma_f32_16x16x32_bf16 v[52:55], a[20:23], a[36:39], v[52:55]
    v_mfma_f32_16x16x32_bf16 v[60:63], a[24:27], a[36:39], v[60:63]
    s_waitcnt lgkmcnt(4)
    v_mfma_f32_16x16x32_bf16 v[68:71], a[28:31], a[36:39], v[68:71]
    s_barrier
    ds_read_b128 a[36:39], v4 offset:51200
    v_mfma_f32_16x16x32_bf16 v[48:51], a[16:19], a[40:43], v[48:51]
    ds_read_b64_tr_b16 a[16:17], v8 offset:49536
    ds_read_b64_tr_b16 a[18:19], v8 offset:50560
    v_mfma_f32_16x16x32_bf16 v[56:59], a[20:23], a[40:43], v[56:59]
    ds_read_b64_tr_b16 a[20:21], v8 offset:49568
    ds_read_b64_tr_b16 a[22:23], v8 offset:50592
    v_mfma_f32_16x16x32_bf16 v[64:67], a[24:27], a[40:43], v[64:67]
    ds_read_b64_tr_b16 a[24:25], v9 offset:49536
    ds_read_b64_tr_b16 a[26:27], v9 offset:50560
    v_mfma_f32_16x16x32_bf16 v[72:75], a[28:31], a[40:43], v[72:75]
    ds_read_b64_tr_b16 a[28:29], v9 offset:49568
    ds_read_b64_tr_b16 a[30:31], v9 offset:50592
    v_mfma_f32_16x16x32_bf16 v[12:15], a[0:3], a[32:35], v[12:15]
    v_mfma_f32_16x16x32_bf16 v[20:23], a[4:7], a[32:35], v[20:23]
    s_waitcnt lgkmcnt(6)
    v_mfma_f32_16x16x32_bf16 v[28:31], a[8:11], a[32:35], v[28:31]
    v_mfma_f32_16x16x32_bf16 v[36:39], a[12:15], a[32:35], v[36:39]
    ds_read_b128 a[40:43], v5 offset:49152
    v_mfma_f32_16x16x32_bf16 v[16:19], a[0:3], a[36:39], v[16:19]
    ds_read_b64_tr_b16 a[0:1], v6 offset:57792
    ds_read_b64_tr_b16 a[2:3], v6 offset:58816
    v_mfma_f32_16x16x32_bf16 v[24:27], a[4:7], a[36:39], v[24:27]
    ds_read_b64_tr_b16 a[4:5], v6 offset:57824
    ds_read_b64_tr_b16 a[6:7], v6 offset:58848
    v_mfma_f32_16x16x32_bf16 v[32:35], a[8:11], a[36:39], v[32:35]
    ds_read_b64_tr_b16 a[8:9], v7 offset:57792
    ds_read_b64_tr_b16 a[10:11], v7 offset:58816
    v_mfma_f32_16x16x32_bf16 v[40:43], a[12:15], a[36:39], v[40:43]
    ds_read_b64_tr_b16 a[12:13], v7 offset:57824
    ds_read_b64_tr_b16 a[14:15], v7 offset:58848
    v_mfma_f32_16x16x32_bf16 v[44:47], a[16:19], a[32:35], v[44:47]
    s_waitcnt lgkmcnt(8)
    v_mfma_f32_16x16x32_bf16 v[52:55], a[20:23], a[32:35], v[52:55]
    v_mfma_f32_16x16x32_bf16 v[60:63], a[24:27], a[32:35], v[60:63]
    v_mfma_f32_16x16x32_bf16 v[68:71], a[28:31], a[32:35], v[68:71]
    ds_read_b128 a[32:35], v5 offset:51200
    v_mfma_f32_16x16x32_bf16 v[48:51], a[16:19], a[36:39], v[48:51]
    ds_read_b64_tr_b16 a[16:17], v8 offset:57792
    ds_read_b64_tr_b16 a[18:19], v8 offset:58816
    v_mfma_f32_16x16x32_bf16 v[56:59], a[20:23], a[36:39], v[56:59]
    ds_read_b64_tr_b16 a[20:21], v8 offset:57824
    ds_read_b64_tr_b16 a[22:23], v8 offset:58848
    v_mfma_f32_16x16x32_bf16 v[64:67], a[24:27], a[36:39], v[64:67]
    ds_read_b64_tr_b16 a[24:25], v9 offset:57792
    ds_read_b64_tr_b16 a[26:27], v9 offset:58816
    v_mfma_f32_16x16x32_bf16 v[72:75], a[28:31], a[36:39], v[72:75]
    ds_read_b64_tr_b16 a[28:29], v9 offset:57824
    ds_read_b64_tr_b16 a[30:31], v9 offset:58848
    s_waitcnt lgkmcnt(9)
    v_mfma_f32_16x16x32_bf16 v[12:15], a[0:3], a[40:43], v[12:15]
    v_mfma_f32_16x16x32_bf16 v[20:23], a[4:7], a[40:43], v[20:23]
    v_mfma_f32_16x16x32_bf16 v[28:31], a[8:11], a[40:43], v[28:31]
    v_mfma_f32_16x16x32_bf16 v[36:39], a[12:15], a[40:43], v[36:39]
    ds_read_b128 a[36:39], v4 offset:0
    s_waitcnt lgkmcnt(3)
    v_mfma_f32_16x16x32_bf16 v[16:19], a[0:3], a[32:35], v[16:19]
    ds_read_b64_tr_b16 a[0:1], v6 offset:0
    ds_read_b64_tr_b16 a[2:3], v6 offset:1024
    v_mfma_f32_16x16x32_bf16 v[24:27], a[4:7], a[32:35], v[24:27]
    ds_read_b64_tr_b16 a[4:5], v6 offset:32
    ds_read_b64_tr_b16 a[6:7], v6 offset:1056
    v_mfma_f32_16x16x32_bf16 v[32:35], a[8:11], a[32:35], v[32:35]
    ds_read_b64_tr_b16 a[8:9], v7 offset:0
    ds_read_b64_tr_b16 a[10:11], v7 offset:1024
    v_mfma_f32_16x16x32_bf16 v[40:43], a[12:15], a[32:35], v[40:43]
    ds_read_b64_tr_b16 a[12:13], v7 offset:32
    ds_read_b64_tr_b16 a[14:15], v7 offset:1056
    v_mfma_f32_16x16x32_bf16 v[44:47], a[16:19], a[40:43], v[44:47]
    v_mfma_f32_16x16x32_bf16 v[52:55], a[20:23], a[40:43], v[52:55]
    v_mfma_f32_16x16x32_bf16 v[60:63], a[24:27], a[40:43], v[60:63]
    s_waitcnt lgkmcnt(4)
    v_mfma_f32_16x16x32_bf16 v[68:71], a[28:31], a[40:43], v[68:71]
    s_barrier
    ds_read_b128 a[40:43], v4 offset:2048
    v_mfma_f32_16x16x32_bf16 v[48:51], a[16:19], a[32:35], v[48:51]
    ds_read_b64_tr_b16 a[16:17], v8 offset:0
    ds_read_b64_tr_b16 a[18:19], v8 offset:1024
    v_mfma_f32_16x16x32_bf16 v[56:59], a[20:23], a[32:35], v[56:59]
    ds_read_b64_tr_b16 a[20:21], v8 offset:32
    ds_read_b64_tr_b16 a[22:23], v8 offset:1056
    v_mfma_f32_16x16x32_bf16 v[64:67], a[24:27], a[32:35], v[64:67]
    ds_read_b64_tr_b16 a[24:25], v9 offset:0
    ds_read_b64_tr_b16 a[26:27], v9 offset:1024
    v_mfma_f32_16x16x32_bf16 v[72:75], a[28:31], a[32:35], v[72:75]
    ds_read_b64_tr_b16 a[28:29], v9 offset:32
    ds_read_b64_tr_b16 a[30:31], v9 offset:1056
    v_mfma_f32_16x16x32_bf16 v[12:15], a[0:3], a[36:39], v[12:15]
    v_mfma_f32_16x16x32_bf16 v[20:23], a[4:7], a[36:39], v[20:23]
    s_waitcnt lgkmcnt(6)
    v_mfma_f32_16x16x32_bf16 v[28:31], a[8:11], a[36:39], v[28:31]
    v_mfma_f32_16x16x32_bf16 v[36:39], a[12:15], a[36:39], v[36:39]
    ds_read_b128 a[32:35], v5 offset:0
    v_mfma_f32_16x16x32_bf16 v[16:19], a[0:3], a[40:43], v[16:19]
    ds_read_b64_tr_b16 a[0:1], v6 offset:8256
    ds_read_b64_tr_b16 a[2:3], v6 offset:9280
    v_mfma_f32_16x16x32_bf16 v[24:27], a[4:7], a[40:43], v[24:27]
    ds_read_b64_tr_b16 a[4:5], v6 offset:8288
    ds_read_b64_tr_b16 a[6:7], v6 offset:9312
    v_mfma_f32_16x16x32_bf16 v[32:35], a[8:11], a[40:43], v[32:35]
    ds_read_b64_tr_b16 a[8:9], v7 offset:8256
    ds_read_b64_tr_b16 a[10:11], v7 offset:9280
    v_mfma_f32_16x16x32_bf16 v[40:43], a[12:15], a[40:43], v[40:43]
    ds_read_b64_tr_b16 a[12:13], v7 offset:8288
    ds_read_b64_tr_b16 a[14:15], v7 offset:9312
    v_mfma_f32_16x16x32_bf16 v[44:47], a[16:19], a[36:39], v[44:47]
    s_waitcnt lgkmcnt(8)
    v_mfma_f32_16x16x32_bf16 v[52:55], a[20:23], a[36:39], v[52:55]
    v_mfma_f32_16x16x32_bf16 v[60:63], a[24:27], a[36:39], v[60:63]
    v_mfma_f32_16x16x32_bf16 v[68:71], a[28:31], a[36:39], v[68:71]
    ds_read_b128 a[36:39], v5 offset:2048
    v_mfma_f32_16x16x32_bf16 v[48:51], a[16:19], a[40:43], v[48:51]
    ds_read_b64_tr_b16 a[16:17], v8 offset:8256
    ds_read_b64_tr_b16 a[18:19], v8 offset:9280
    v_mfma_f32_16x16x32_bf16 v[56:59], a[20:23], a[40:43], v[56:59]
    ds_read_b64_tr_b16 a[20:21], v8 offset:8288
    ds_read_b64_tr_b16 a[22:23], v8 offset:9312
    v_mfma_f32_16x16x32_bf16 v[64:67], a[24:27], a[40:43], v[64:67]
    ds_read_b64_tr_b16 a[24:25], v9 offset:8256
    ds_read_b64_tr_b16 a[26:27], v9 offset:9280
    v_mfma_f32_16x16x32_bf16 v[72:75], a[28:31], a[40:43], v[72:75]
    ds_read_b64_tr_b16 a[28:29], v9 offset:8288
    ds_read_b64_tr_b16 a[30:31], v9 offset:9312
    s_waitcnt lgkmcnt(9)
    v_mfma_f32_16x16x32_bf16 v[12:15], a[0:3], a[32:35], v[12:15]
    v_mfma_f32_16x16x32_bf16 v[20:23], a[4:7], a[32:35], v[20:23]
    v_mfma_f32_16x16x32_bf16 v[28:31], a[8:11], a[32:35], v[28:31]
    v_mfma_f32_16x16x32_bf16 v[36:39], a[12:15], a[32:35], v[36:39]
    ds_read_b128 a[40:43], v4 offset:16384
    s_waitcnt lgkmcnt(3)
    v_mfma_f32_16x16x32_bf16 v[16:19], a[0:3], a[36:39], v[16:19]
    ds_read_b64_tr_b16 a[0:1], v6 offset:16512
    ds_read_b64_tr_b16 a[2:3], v6 offset:17536
    v_mfma_f32_16x16x32_bf16 v[24:27], a[4:7], a[36:39], v[24:27]
    ds_read_b64_tr_b16 a[4:5], v6 offset:16544
    ds_read_b64_tr_b16 a[6:7], v6 offset:17568
    v_mfma_f32_16x16x32_bf16 v[32:35], a[8:11], a[36:39], v[32:35]
    ds_read_b64_tr_b16 a[8:9], v7 offset:16512
    ds_read_b64_tr_b16 a[10:11], v7 offset:17536
    v_mfma_f32_16x16x32_bf16 v[40:43], a[12:15], a[36:39], v[40:43]
    ds_read_b64_tr_b16 a[12:13], v7 offset:16544
    ds_read_b64_tr_b16 a[14:15], v7 offset:17568
    v_mfma_f32_16x16x32_bf16 v[44:47], a[16:19], a[32:35], v[44:47]
    v_mfma_f32_16x16x32_bf16 v[52:55], a[20:23], a[32:35], v[52:55]
    v_mfma_f32_16x16x32_bf16 v[60:63], a[24:27], a[32:35], v[60:63]
    s_waitcnt lgkmcnt(4)
    v_mfma_f32_16x16x32_bf16 v[68:71], a[28:31], a[32:35], v[68:71]
    s_barrier
    ds_read_b128 a[32:35], v4 offset:18432
    v_mfma_f32_16x16x32_bf16 v[48:51], a[16:19], a[36:39], v[48:51]
    ds_read_b64_tr_b16 a[16:17], v8 offset:16512
    ds_read_b64_tr_b16 a[18:19], v8 offset:17536
    v_mfma_f32_16x16x32_bf16 v[56:59], a[20:23], a[36:39], v[56:59]
    ds_read_b64_tr_b16 a[20:21], v8 offset:16544
    ds_read_b64_tr_b16 a[22:23], v8 offset:17568
    v_mfma_f32_16x16x32_bf16 v[64:67], a[24:27], a[36:39], v[64:67]
    ds_read_b64_tr_b16 a[24:25], v9 offset:16512
    ds_read_b64_tr_b16 a[26:27], v9 offset:17536
    v_mfma_f32_16x16x32_bf16 v[72:75], a[28:31], a[36:39], v[72:75]
    ds_read_b64_tr_b16 a[28:29], v9 offset:16544
    ds_read_b64_tr_b16 a[30:31], v9 offset:17568
    v_mfma_f32_16x16x32_bf16 v[12:15], a[0:3], a[40:43], v[12:15]
    v_mfma_f32_16x16x32_bf16 v[20:23], a[4:7], a[40:43], v[20:23]
    s_waitcnt lgkmcnt(6)
    v_mfma_f32_16x16x32_bf16 v[28:31], a[8:11], a[40:43], v[28:31]
    v_mfma_f32_16x16x32_bf16 v[36:39], a[12:15], a[40:43], v[36:39]
    v_mfma_f32_16x16x32_bf16 v[16:19], a[0:3], a[32:35], v[16:19]
    v_xor_b32 v1, 0, v11
    ds_read_b64 a[52:53], v1 offset:0
    v_mfma_f32_16x16x32_bf16 v[24:27], a[4:7], a[32:35], v[24:27]
    ds_read_b64 a[56:57], v1 offset:2048
    ds_read_b128 a[36:39], v5 offset:16384
    v_mfma_f32_16x16x32_bf16 v[32:35], a[8:11], a[32:35], v[32:35]
    ds_read_b64_tr_b16 a[0:1], v6 offset:24768
    ds_read_b64_tr_b16 a[2:3], v6 offset:25792
    v_mfma_f32_16x16x32_bf16 v[40:43], a[12:15], a[32:35], v[40:43]
    v_mfma_f32_16x16x32_bf16 v[44:47], a[16:19], a[40:43], v[44:47]
    v_xor_b32 v1, 32, v11
    ds_read_b64 a[54:55], v1 offset:0
    s_waitcnt lgkmcnt(6)
    v_mfma_f32_16x16x32_bf16 v[52:55], a[20:23], a[40:43], v[52:55]
    ds_read_b64 a[58:59], v1 offset:2048
    ds_read_b64_tr_b16 a[4:5], v6 offset:24800
    v_mfma_f32_16x16x32_bf16 v[60:63], a[24:27], a[40:43], v[60:63]
    ds_read_b64_tr_b16 a[6:7], v6 offset:25824
    ds_read_b64_tr_b16 a[8:9], v7 offset:24768
    v_mfma_f32_16x16x32_bf16 v[68:71], a[28:31], a[40:43], v[68:71]
    ds_read_b64_tr_b16 a[10:11], v7 offset:25792
    ds_read_b64_tr_b16 a[12:13], v7 offset:24800
    v_mfma_f32_16x16x32_bf16 v[48:51], a[16:19], a[32:35], v[48:51]
    ds_read_b64_tr_b16 a[14:15], v7 offset:25824
    ds_read_b128 a[40:43], v5 offset:18432
    v_mfma_f32_16x16x32_bf16 v[56:59], a[20:23], a[32:35], v[56:59]
    v_xor_b32 v1, 64, v11
    ds_read_b64 a[60:61], v1 offset:0
    v_mfma_f32_16x16x32_bf16 v[64:67], a[24:27], a[32:35], v[64:67]
    ds_read_b64 a[64:65], v1 offset:2048
    ds_read_b64_tr_b16 a[16:17], v8 offset:24768
    v_mfma_f32_16x16x32_bf16 v[72:75], a[28:31], a[32:35], v[72:75]
    ds_read_b64_tr_b16 a[18:19], v8 offset:25792
    s_waitcnt lgkmcnt(8)
    v_mfma_f32_16x16x32_bf16 v[12:15], a[0:3], a[36:39], v[12:15]
    v_xor_b32 v1, 96, v11
    ds_read_b64 a[62:63], v1 offset:0
    v_mfma_f32_16x16x32_bf16 v[20:23], a[4:7], a[36:39], v[20:23]
    ds_read_b64 a[66:67], v1 offset:2048
    ds_read_b64_tr_b16 a[20:21], v8 offset:24800
    s_waitcnt lgkmcnt(7)
    v_mfma_f32_16x16x32_bf16 v[28:31], a[8:11], a[36:39], v[28:31]
    ds_read_b64_tr_b16 a[22:23], v8 offset:25824
    ds_read_b64_tr_b16 a[24:25], v9 offset:24768
    v_mfma_f32_16x16x32_bf16 v[36:39], a[12:15], a[36:39], v[36:39]
    ds_read_b64_tr_b16 a[26:27], v9 offset:25792
    ds_read_b64_tr_b16 a[28:29], v9 offset:24800
    v_mfma_f32_16x16x32_bf16 v[16:19], a[0:3], a[40:43], v[16:19]
    ds_read_b64_tr_b16 a[30:31], v9 offset:25824
    ds_read_b128 a[32:35], v4 offset:32768
    v_mfma_f32_16x16x32_bf16 v[24:27], a[4:7], a[40:43], v[24:27]
    ds_read_b64_tr_b16 a[0:1], v6 offset:33024
    ds_read_b64_tr_b16 a[2:3], v6 offset:34048
    v_mfma_f32_16x16x32_bf16 v[32:35], a[8:11], a[40:43], v[32:35]
    ds_read_b64_tr_b16 a[4:5], v6 offset:33056
    ds_read_b64_tr_b16 a[6:7], v6 offset:34080
    v_mfma_f32_16x16x32_bf16 v[40:43], a[12:15], a[40:43], v[40:43]
    ds_read_b64_tr_b16 a[8:9], v7 offset:33024
    ds_read_b64_tr_b16 a[10:11], v7 offset:34048
    s_waitcnt lgkmcnt(10)
    v_mfma_f32_16x16x32_bf16 v[44:47], a[16:19], a[36:39], v[44:47]
    ds_read_b64_tr_b16 a[12:13], v7 offset:33056
    ds_read_b64_tr_b16 a[14:15], v7 offset:34080
    v_mfma_f32_16x16x32_bf16 v[52:55], a[20:23], a[36:39], v[52:55]
    s_waitcnt lgkmcnt(8)
    v_mfma_f32_16x16x32_bf16 v[60:63], a[24:27], a[36:39], v[60:63]
    s_barrier
    v_mfma_f32_16x16x32_bf16 v[68:71], a[28:31], a[36:39], v[68:71]
    ds_read_b128 a[36:39], v4 offset:34816
    v_mfma_f32_16x16x32_bf16 v[48:51], a[16:19], a[40:43], v[48:51]
    ds_read_b64_tr_b16 a[16:17], v8 offset:33024
    ds_read_b64_tr_b16 a[18:19], v8 offset:34048
    v_mfma_f32_16x16x32_bf16 v[56:59], a[20:23], a[40:43], v[56:59]
    ds_read_b64_tr_b16 a[20:21], v8 offset:33056
    ds_read_b64_tr_b16 a[22:23], v8 offset:34080
    v_mfma_f32_16x16x32_bf16 v[64:67], a[24:27], a[40:43], v[64:67]
    ds_read_b64_tr_b16 a[24:25], v9 offset:33024
    ds_read_b64_tr_b16 a[26:27], v9 offset:34048
    v_mfma_f32_16x16x32_bf16 v[72:75], a[28:31], a[40:43], v[72:75]
    ds_read_b64_tr_b16 a[28:29], v9 offset:33056
    ds_read_b64_tr_b16 a[30:31], v9 offset:34080
    s_waitcnt lgkmcnt(9)
    v_mfma_f32_16x16x32_bf16 v[12:15], a[0:3], a[32:35], v[12:15]
    v_mfma_f32_16x16x32_bf16 v[20:23], a[4:7], a[32:35], v[20:23]
    v_mfma_f32_16x16x32_bf16 v[28:31], a[8:11], a[32:35], v[28:31]
    v_mfma_f32_16x16x32_bf16 v[36:39], a[12:15], a[32:35], v[36:39]
    ds_read_b128 a[40:43], v5 offset:32768
    s_waitcnt lgkmcnt(3)
    v_mfma_f32_16x16x32_bf16 v[16:19], a[0:3], a[36:39], v[16:19]
    ds_read_b64_tr_b16 a[0:1], v6 offset:41280
    ds_read_b64_tr_b16 a[2:3], v6 offset:42304
    v_mfma_f32_16x16x32_bf16 v[24:27], a[4:7], a[36:39], v[24:27]
    ds_read_b64_tr_b16 a[4:5], v6 offset:41312
    ds_read_b64_tr_b16 a[6:7], v6 offset:42336
    v_mfma_f32_16x16x32_bf16 v[32:35], a[8:11], a[36:39], v[32:35]
    ds_read_b64_tr_b16 a[8:9], v7 offset:41280
    ds_read_b64_tr_b16 a[10:11], v7 offset:42304
    v_mfma_f32_16x16x32_bf16 v[40:43], a[12:15], a[36:39], v[40:43]
    ds_read_b64_tr_b16 a[12:13], v7 offset:41312
    ds_read_b64_tr_b16 a[14:15], v7 offset:42336
    v_mfma_f32_16x16x32_bf16 v[44:47], a[16:19], a[32:35], v[44:47]
    v_mfma_f32_16x16x32_bf16 v[52:55], a[20:23], a[32:35], v[52:55]
    v_mfma_f32_16x16x32_bf16 v[60:63], a[24:27], a[32:35], v[60:63]
    s_waitcnt lgkmcnt(4)
    v_mfma_f32_16x16x32_bf16 v[68:71], a[28:31], a[32:35], v[68:71]
    ds_read_b128 a[32:35], v5 offset:34816
    v_mfma_f32_16x16x32_bf16 v[48:51], a[16:19], a[36:39], v[48:51]
    ds_read_b64_tr_b16 a[16:17], v8 offset:41280
    ds_read_b64_tr_b16 a[18:19], v8 offset:42304
    v_mfma_f32_16x16x32_bf16 v[56:59], a[20:23], a[36:39], v[56:59]
    ds_read_b64_tr_b16 a[20:21], v8 offset:41312
    ds_read_b64_tr_b16 a[22:23], v8 offset:42336
    v_mfma_f32_16x16x32_bf16 v[64:67], a[24:27], a[36:39], v[64:67]
    ds_read_b64_tr_b16 a[24:25], v9 offset:41280
    ds_read_b64_tr_b16 a[26:27], v9 offset:42304
    v_mfma_f32_16x16x32_bf16 v[72:75], a[28:31], a[36:39], v[72:75]
    ds_read_b64_tr_b16 a[28:29], v9 offset:41312
    ds_read_b64_tr_b16 a[30:31], v9 offset:42336
    v_mfma_f32_16x16x32_bf16 v[12:15], a[0:3], a[40:43], v[12:15]
    v_mfma_f32_16x16x32_bf16 v[20:23], a[4:7], a[40:43], v[20:23]
    s_waitcnt lgkmcnt(6)
    v_mfma_f32_16x16x32_bf16 v[28:31], a[8:11], a[40:43], v[28:31]
    v_mfma_f32_16x16x32_bf16 v[36:39], a[12:15], a[40:43], v[36:39]
    ds_read_b128 a[36:39], v4 offset:49152
    v_mfma_f32_16x16x32_bf16 v[16:19], a[0:3], a[32:35], v[16:19]
    ds_read_b64_tr_b16 a[0:1], v6 offset:49536
    ds_read_b64_tr_b16 a[2:3], v6 offset:50560
    v_mfma_f32_16x16x32_bf16 v[24:27], a[4:7], a[32:35], v[24:27]
    ds_read_b64_tr_b16 a[4:5], v6 offset:49568
    ds_read_b64_tr_b16 a[6:7], v6 offset:50592
    v_mfma_f32_16x16x32_bf16 v[32:35], a[8:11], a[32:35], v[32:35]
    ds_read_b64_tr_b16 a[8:9], v7 offset:49536
    ds_read_b64_tr_b16 a[10:11], v7 offset:50560
    v_mfma_f32_16x16x32_bf16 v[40:43], a[12:15], a[32:35], v[40:43]
    ds_read_b64_tr_b16 a[12:13], v7 offset:49568
    ds_read_b64_tr_b16 a[14:15], v7 offset:50592
    v_mfma_f32_16x16x32_bf16 v[44:47], a[16:19], a[40:43], v[44:47]
    s_waitcnt lgkmcnt(8)
    v_mfma_f32_16x16x32_bf16 v[52:55], a[20:23], a[40:43], v[52:55]
    s_barrier
    v_mfma_f32_16x16x32_bf16 v[60:63], a[24:27], a[40:43], v[60:63]
    v_mfma_f32_16x16x32_bf16 v[68:71], a[28:31], a[40:43], v[68:71]
    ds_read_b128 a[40:43], v4 offset:51200
    v_mfma_f32_16x16x32_bf16 v[48:51], a[16:19], a[32:35], v[48:51]
    ds_read_b64_tr_b16 a[16:17], v8 offset:49536
    ds_read_b64_tr_b16 a[18:19], v8 offset:50560
    v_mfma_f32_16x16x32_bf16 v[56:59], a[20:23], a[32:35], v[56:59]
    ds_read_b64_tr_b16 a[20:21], v8 offset:49568
    ds_read_b64_tr_b16 a[22:23], v8 offset:50592
    v_mfma_f32_16x16x32_bf16 v[64:67], a[24:27], a[32:35], v[64:67]
    ds_read_b64_tr_b16 a[24:25], v9 offset:49536
    ds_read_b64_tr_b16 a[26:27], v9 offset:50560
    v_mfma_f32_16x16x32_bf16 v[72:75], a[28:31], a[32:35], v[72:75]
    ds_read_b64_tr_b16 a[28:29], v9 offset:49568
    ds_read_b64_tr_b16 a[30:31], v9 offset:50592
    s_waitcnt lgkmcnt(9)
    v_mfma_f32_16x16x32_bf16 v[12:15], a[0:3], a[36:39], v[12:15]
    v_mfma_f32_16x16x32_bf16 v[20:23], a[4:7], a[36:39], v[20:23]
    v_mfma_f32_16x16x32_bf16 v[28:31], a[8:11], a[36:39], v[28:31]
    v_mfma_f32_16x16x32_bf16 v[36:39], a[12:15], a[36:39], v[36:39]
    ds_read_b128 a[32:35], v5 offset:49152
    s_waitcnt lgkmcnt(3)
    v_mfma_f32_16x16x32_bf16 v[16:19], a[0:3], a[40:43], v[16:19]
    ds_read_b64_tr_b16 a[0:1], v6 offset:57792
    ds_read_b64_tr_b16 a[2:3], v6 offset:58816
    v_mfma_f32_16x16x32_bf16 v[24:27], a[4:7], a[40:43], v[24:27]
    ds_read_b64_tr_b16 a[4:5], v6 offset:57824
    ds_read_b64_tr_b16 a[6:7], v6 offset:58848
    v_mfma_f32_16x16x32_bf16 v[32:35], a[8:11], a[40:43], v[32:35]
    ds_read_b64_tr_b16 a[8:9], v7 offset:57792
    ds_read_b64_tr_b16 a[10:11], v7 offset:58816
    v_mfma_f32_16x16x32_bf16 v[40:43], a[12:15], a[40:43], v[40:43]
    ds_read_b64_tr_b16 a[12:13], v7 offset:57824
    ds_read_b64_tr_b16 a[14:15], v7 offset:58848
    v_mfma_f32_16x16x32_bf16 v[44:47], a[16:19], a[36:39], v[44:47]
    v_mfma_f32_16x16x32_bf16 v[52:55], a[20:23], a[36:39], v[52:55]
    v_mfma_f32_16x16x32_bf16 v[60:63], a[24:27], a[36:39], v[60:63]
    s_waitcnt lgkmcnt(4)
    v_mfma_f32_16x16x32_bf16 v[68:71], a[28:31], a[36:39], v[68:71]
    ds_read_b128 a[36:39], v5 offset:51200
    v_mfma_f32_16x16x32_bf16 v[48:51], a[16:19], a[40:43], v[48:51]
    ds_read_b64_tr_b16 a[16:17], v8 offset:57792
    ds_read_b64_tr_b16 a[18:19], v8 offset:58816
    v_mfma_f32_16x16x32_bf16 v[56:59], a[20:23], a[40:43], v[56:59]
    ds_read_b64_tr_b16 a[20:21], v8 offset:57824
    ds_read_b64_tr_b16 a[22:23], v8 offset:58848
    v_mfma_f32_16x16x32_bf16 v[64:67], a[24:27], a[40:43], v[64:67]
    ds_read_b64_tr_b16 a[24:25], v9 offset:57792
    ds_read_b64_tr_b16 a[26:27], v9 offset:58816
    v_mfma_f32_16x16x32_bf16 v[72:75], a[28:31], a[40:43], v[72:75]
    ds_read_b64_tr_b16 a[28:29], v9 offset:57824
    ds_read_b64_tr_b16 a[30:31], v9 offset:58848
    v_mfma_f32_16x16x32_bf16 v[12:15], a[0:3], a[32:35], v[12:15]
    v_mfma_f32_16x16x32_bf16 v[20:23], a[4:7], a[32:35], v[20:23]
    s_waitcnt lgkmcnt(6)
    v_mfma_f32_16x16x32_bf16 v[28:31], a[8:11], a[32:35], v[28:31]
    v_mfma_f32_16x16x32_bf16 v[36:39], a[12:15], a[32:35], v[36:39]
    ds_read_b128 a[40:43], v4 offset:0
    v_mfma_f32_16x16x32_bf16 v[16:19], a[0:3], a[36:39], v[16:19]
    ds_read_b64_tr_b16 a[0:1], v6 offset:0
    ds_read_b64_tr_b16 a[2:3], v6 offset:1024
    v_mfma_f32_16x16x32_bf16 v[24:27], a[4:7], a[36:39], v[24:27]
    ds_read_b64_tr_b16 a[4:5], v6 offset:32
    ds_read_b64_tr_b16 a[6:7], v6 offset:1056
    v_mfma_f32_16x16x32_bf16 v[32:35], a[8:11], a[36:39], v[32:35]
    ds_read_b64_tr_b16 a[8:9], v7 offset:0
    ds_read_b64_tr_b16 a[10:11], v7 offset:1024
    v_mfma_f32_16x16x32_bf16 v[40:43], a[12:15], a[36:39], v[40:43]
    ds_read_b64_tr_b16 a[12:13], v7 offset:32
    ds_read_b64_tr_b16 a[14:15], v7 offset:1056
    v_mfma_f32_16x16x32_bf16 v[44:47], a[16:19], a[32:35], v[44:47]
    s_waitcnt lgkmcnt(8)
    v_mfma_f32_16x16x32_bf16 v[52:55], a[20:23], a[32:35], v[52:55]
    s_barrier
    v_mfma_f32_16x16x32_bf16 v[60:63], a[24:27], a[32:35], v[60:63]
    v_mfma_f32_16x16x32_bf16 v[68:71], a[28:31], a[32:35], v[68:71]
    ds_read_b128 a[32:35], v4 offset:2048
    v_mfma_f32_16x16x32_bf16 v[48:51], a[16:19], a[36:39], v[48:51]
    ds_read_b64_tr_b16 a[16:17], v8 offset:0
    ds_read_b64_tr_b16 a[18:19], v8 offset:1024
    v_mfma_f32_16x16x32_bf16 v[56:59], a[20:23], a[36:39], v[56:59]
    ds_read_b64_tr_b16 a[20:21], v8 offset:32
    ds_read_b64_tr_b16 a[22:23], v8 offset:1056
    v_mfma_f32_16x16x32_bf16 v[64:67], a[24:27], a[36:39], v[64:67]
    ds_read_b64_tr_b16 a[24:25], v9 offset:0
    ds_read_b64_tr_b16 a[26:27], v9 offset:1024
    v_mfma_f32_16x16x32_bf16 v[72:75], a[28:31], a[36:39], v[72:75]
    ds_read_b64_tr_b16 a[28:29], v9 offset:32
    ds_read_b64_tr_b16 a[30:31], v9 offset:1056
    s_waitcnt lgkmcnt(9)
    v_mfma_f32_16x16x32_bf16 v[12:15], a[0:3], a[40:43], v[12:15]
    v_mfma_f32_16x16x32_bf16 v[20:23], a[4:7], a[40:43], v[20:23]
    v_mfma_f32_16x16x32_bf16 v[28:31], a[8:11], a[40:43], v[28:31]
    v_mfma_f32_16x16x32_bf16 v[36:39], a[12:15], a[40:43], v[36:39]
    ds_read_b128 a[36:39], v5 offset:0
    s_waitcnt lgkmcnt(3)
    v_mfma_f32_16x16x32_bf16 v[16:19], a[0:3], a[32:35], v[16:19]
    ds_read_b64_tr_b16 a[0:1], v6 offset:8256
    v_mfma_f32_16x16x32_bf16 v[24:27], a[4:7], a[32:35], v[24:27]
    ds_read_b64_tr_b16 a[2:3], v6 offset:9280
    v_mfma_f32_16x16x32_bf16 v[32:35], a[8:11], a[32:35], v[32:35]
    ds_read_b64_tr_b16 a[4:5], v6 offset:8288
    v_mfma_f32_16x16x32_bf16 v[40:43], a[12:15], a[32:35], v[40:43]
    ds_read_b64_tr_b16 a[6:7], v6 offset:9312
    v_mfma_f32_16x16x32_bf16 v[44:47], a[16:19], a[40:43], v[44:47]
    ds_read_b64_tr_b16 a[8:9], v7 offset:8256
    v_mfma_f32_16x16x32_bf16 v[52:55], a[20:23], a[40:43], v[52:55]
    ds_read_b64_tr_b16 a[10:11], v7 offset:9280
    v_mfma_f32_16x16x32_bf16 v[60:63], a[24:27], a[40:43], v[60:63]
    ds_read_b64_tr_b16 a[12:13], v7 offset:8288
    s_waitcnt lgkmcnt(5)
    v_mfma_f32_16x16x32_bf16 v[68:71], a[28:31], a[40:43], v[68:71]
    ds_read_b64_tr_b16 a[14:15], v7 offset:9312
    ds_read_b128 a[40:43], v5 offset:2048
    v_mfma_f32_16x16x32_bf16 v[48:51], a[16:19], a[32:35], v[48:51]
    ds_read_b64_tr_b16 a[16:17], v8 offset:8256
    v_mfma_f32_16x16x32_bf16 v[56:59], a[20:23], a[32:35], v[56:59]
    ds_read_b64_tr_b16 a[18:19], v8 offset:9280
    v_mfma_f32_16x16x32_bf16 v[64:67], a[24:27], a[32:35], v[64:67]
    ds_read_b64_tr_b16 a[20:21], v8 offset:8288
    v_mfma_f32_16x16x32_bf16 v[72:75], a[28:31], a[32:35], v[72:75]
    ds_read_b64_tr_b16 a[22:23], v8 offset:9312
    v_mfma_f32_16x16x32_bf16 v[12:15], a[0:3], a[36:39], v[12:15]
    ds_read_b64_tr_b16 a[24:25], v9 offset:8256
    s_waitcnt lgkmcnt(5)
    v_mfma_f32_16x16x32_bf16 v[20:23], a[4:7], a[36:39], v[20:23]
    ds_read_b64_tr_b16 a[26:27], v9 offset:9280
    v_mfma_f32_16x16x32_bf16 v[28:31], a[8:11], a[36:39], v[28:31]
    ds_read_b64_tr_b16 a[28:29], v9 offset:8288
    v_mfma_f32_16x16x32_bf16 v[36:39], a[12:15], a[36:39], v[36:39]
    ds_read_b64_tr_b16 a[30:31], v9 offset:9312
    ds_read_b128 a[32:35], v4 offset:16384
    v_mfma_f32_16x16x32_bf16 v[16:19], a[0:3], a[40:43], v[16:19]
    ds_read_b64_tr_b16 a[0:1], v6 offset:16512
    v_mfma_f32_16x16x32_bf16 v[24:27], a[4:7], a[40:43], v[24:27]
    ds_read_b64_tr_b16 a[2:3], v6 offset:17536
    v_mfma_f32_16x16x32_bf16 v[32:35], a[8:11], a[40:43], v[32:35]
    ds_read_b64_tr_b16 a[4:5], v6 offset:16544
    v_mfma_f32_16x16x32_bf16 v[40:43], a[12:15], a[40:43], v[40:43]
    ds_read_b64_tr_b16 a[6:7], v6 offset:17568
    s_waitcnt lgkmcnt(6)
    v_mfma_f32_16x16x32_bf16 v[44:47], a[16:19], a[36:39], v[44:47]
    ds_read_b64_tr_b16 a[8:9], v7 offset:16512
    v_mfma_f32_16x16x32_bf16 v[52:55], a[20:23], a[36:39], v[52:55]
    ds_read_b64_tr_b16 a[10:11], v7 offset:17536
    v_mfma_f32_16x16x32_bf16 v[60:63], a[24:27], a[36:39], v[60:63]
    ds_read_b64_tr_b16 a[12:13], v7 offset:16544
    s_waitcnt lgkmcnt(5)
    v_mfma_f32_16x16x32_bf16 v[68:71], a[28:31], a[36:39], v[68:71]
    s_barrier
    ds_read_b64_tr_b16 a[14:15], v7 offset:17568
    ds_read_b128 a[36:39], v4 offset:18432
    v_mfma_f32_16x16x32_bf16 v[48:51], a[16:19], a[40:43], v[48:51]
    ds_read_b64_tr_b16 a[16:17], v8 offset:16512
    v_mfma_f32_16x16x32_bf16 v[56:59], a[20:23], a[40:43], v[56:59]
    ds_read_b64_tr_b16 a[18:19], v8 offset:17536
    v_mfma_f32_16x16x32_bf16 v[64:67], a[24:27], a[40:43], v[64:67]
    ds_read_b64_tr_b16 a[20:21], v8 offset:16544
    v_mfma_f32_16x16x32_bf16 v[72:75], a[28:31], a[40:43], v[72:75]
    ds_read_b64_tr_b16 a[22:23], v8 offset:17568
    v_mfma_f32_16x16x32_bf16 v[12:15], a[0:3], a[32:35], v[12:15]
    ds_read_b64_tr_b16 a[24:25], v9 offset:16512
    s_waitcnt lgkmcnt(5)
    v_mfma_f32_16x16x32_bf16 v[20:23], a[4:7], a[32:35], v[20:23]
    ds_read_b64_tr_b16 a[26:27], v9 offset:17536
    v_mfma_f32_16x16x32_bf16 v[28:31], a[8:11], a[32:35], v[28:31]
    ds_read_b64_tr_b16 a[28:29], v9 offset:16544
    v_mfma_f32_16x16x32_bf16 v[36:39], a[12:15], a[32:35], v[36:39]
    ds_read_b64_tr_b16 a[30:31], v9 offset:17568
    ds_read_b128 a[40:43], v5 offset:16384
    v_mfma_f32_16x16x32_bf16 v[16:19], a[0:3], a[36:39], v[16:19]
    ds_read_b64_tr_b16 a[0:1], v6 offset:24768
    v_mfma_f32_16x16x32_bf16 v[24:27], a[4:7], a[36:39], v[24:27]
    ds_read_b64_tr_b16 a[2:3], v6 offset:25792
    v_mfma_f32_16x16x32_bf16 v[32:35], a[8:11], a[36:39], v[32:35]
    ds_read_b64_tr_b16 a[4:5], v6 offset:24800
    v_mfma_f32_16x16x32_bf16 v[40:43], a[12:15], a[36:39], v[40:43]
    ds_read_b64_tr_b16 a[6:7], v6 offset:25824
    s_waitcnt lgkmcnt(6)
    v_mfma_f32_16x16x32_bf16 v[44:47], a[16:19], a[32:35], v[44:47]
    ds_read_b64_tr_b16 a[8:9], v7 offset:24768
    v_mfma_f32_16x16x32_bf16 v[52:55], a[20:23], a[32:35], v[52:55]
    ds_read_b64_tr_b16 a[10:11], v7 offset:25792
    v_mfma_f32_16x16x32_bf16 v[60:63], a[24:27], a[32:35], v[60:63]
    ds_read_b64_tr_b16 a[12:13], v7 offset:24800
    s_waitcnt lgkmcnt(5)
    v_mfma_f32_16x16x32_bf16 v[68:71], a[28:31], a[32:35], v[68:71]
    ds_read_b64_tr_b16 a[14:15], v7 offset:25824
    ds_read_b128 a[32:35], v5 offset:18432
    v_mfma_f32_16x16x32_bf16 v[48:51], a[16:19], a[36:39], v[48:51]
    ds_read_b64_tr_b16 a[16:17], v8 offset:24768
    v_mfma_f32_16x16x32_bf16 v[56:59], a[20:23], a[36:39], v[56:59]
    ds_read_b64_tr_b16 a[18:19], v8 offset:25792
    v_mfma_f32_16x16x32_bf16 v[64:67], a[24:27], a[36:39], v[64:67]
    ds_read_b64_tr_b16 a[20:21], v8 offset:24800
    v_mfma_f32_16x16x32_bf16 v[72:75], a[28:31], a[36:39], v[72:75]
    ds_read_b64_tr_b16 a[22:23], v8 offset:25824
    v_mfma_f32_16x16x32_bf16 v[12:15], a[0:3], a[40:43], v[12:15]
    ds_read_b64_tr_b16 a[24:25], v9 offset:24768
    s_waitcnt lgkmcnt(5)
    v_mfma_f32_16x16x32_bf16 v[20:23], a[4:7], a[40:43], v[20:23]
    ds_read_b64_tr_b16 a[26:27], v9 offset:25792
    v_mfma_f32_16x16x32_bf16 v[28:31], a[8:11], a[40:43], v[28:31]
    ds_read_b64_tr_b16 a[28:29], v9 offset:24800
    v_mfma_f32_16x16x32_bf16 v[36:39], a[12:15], a[40:43], v[36:39]
    ds_read_b64_tr_b16 a[30:31], v9 offset:25824
    ds_read_b128 a[36:39], v4 offset:32768
    v_mfma_f32_16x16x32_bf16 v[16:19], a[0:3], a[32:35], v[16:19]
    ds_read_b64_tr_b16 a[0:1], v6 offset:33024
    v_mfma_f32_16x16x32_bf16 v[24:27], a[4:7], a[32:35], v[24:27]
    ds_read_b64_tr_b16 a[2:3], v6 offset:34048
    v_mfma_f32_16x16x32_bf16 v[32:35], a[8:11], a[32:35], v[32:35]
    ds_read_b64_tr_b16 a[4:5], v6 offset:33056
    v_mfma_f32_16x16x32_bf16 v[40:43], a[12:15], a[32:35], v[40:43]
    ds_read_b64_tr_b16 a[6:7], v6 offset:34080
    s_waitcnt lgkmcnt(6)
    v_mfma_f32_16x16x32_bf16 v[44:47], a[16:19], a[40:43], v[44:47]
    ds_read_b64_tr_b16 a[8:9], v7 offset:33024
    v_mfma_f32_16x16x32_bf16 v[52:55], a[20:23], a[40:43], v[52:55]
    ds_read_b64_tr_b16 a[10:11], v7 offset:34048
    v_mfma_f32_16x16x32_bf16 v[60:63], a[24:27], a[40:43], v[60:63]
    ds_read_b64_tr_b16 a[12:13], v7 offset:33056
    s_waitcnt lgkmcnt(5)
    v_mfma_f32_16x16x32_bf16 v[68:71], a[28:31], a[40:43], v[68:71]
    s_barrier
    ds_read_b64_tr_b16 a[14:15], v7 offset:34080
    ds_read_b128 a[40:43], v4 offset:34816
    v_mfma_f32_16x16x32_bf16 v[48:51], a[16:19], a[32:35], v[48:51]
    ds_read_b64_tr_b16 a[16:17], v8 offset:33024
    v_mfma_f32_16x16x32_bf16 v[56:59], a[20:23], a[32:35], v[56:59]
    ds_read_b64_tr_b16 a[18:19], v8 offset:34048
    v_mfma_f32_16x16x32_bf16 v[64:67], a[24:27], a[32:35], v[64:67]
    ds_read_b64_tr_b16 a[20:21], v8 offset:33056
    v_mfma_f32_16x16x32_bf16 v[72:75], a[28:31], a[32:35], v[72:75]
    ds_read_b64_tr_b16 a[22:23], v8 offset:34080
    v_mfma_f32_16x16x32_bf16 v[12:15], a[0:3], a[36:39], v[12:15]
    ds_read_b64_tr_b16 a[24:25], v9 offset:33024
    s_waitcnt lgkmcnt(5)
    v_mfma_f32_16x16x32_bf16 v[20:23], a[4:7], a[36:39], v[20:23]
    ds_read_b64_tr_b16 a[26:27], v9 offset:34048
    v_mfma_f32_16x16x32_bf16 v[28:31], a[8:11], a[36:39], v[28:31]
    ds_read_b64_tr_b16 a[28:29], v9 offset:33056
    v_mfma_f32_16x16x32_bf16 v[36:39], a[12:15], a[36:39], v[36:39]
    ds_read_b64_tr_b16 a[30:31], v9 offset:34080
    ds_read_b128 a[32:35], v5 offset:32768
    v_mfma_f32_16x16x32_bf16 v[16:19], a[0:3], a[40:43], v[16:19]
    ds_read_b64_tr_b16 a[0:1], v6 offset:41280
    v_mfma_f32_16x16x32_bf16 v[24:27], a[4:7], a[40:43], v[24:27]
    ds_read_b64_tr_b16 a[2:3], v6 offset:42304
    v_mfma_f32_16x16x32_bf16 v[32:35], a[8:11], a[40:43], v[32:35]
    ds_read_b64_tr_b16 a[4:5], v6 offset:41312
    v_mfma_f32_16x16x32_bf16 v[40:43], a[12:15], a[40:43], v[40:43]
    ds_read_b64_tr_b16 a[6:7], v6 offset:42336
    s_waitcnt lgkmcnt(6)
    v_mfma_f32_16x16x32_bf16 v[44:47], a[16:19], a[36:39], v[44:47]
    ds_read_b64_tr_b16 a[8:9], v7 offset:41280
    v_mfma_f32_16x16x32_bf16 v[52:55], a[20:23], a[36:39], v[52:55]
    ds_read_b64_tr_b16 a[10:11], v7 offset:42304
    v_mfma_f32_16x16x32_bf16 v[60:63], a[24:27], a[36:39], v[60:63]
    ds_read_b64_tr_b16 a[12:13], v7 offset:41312
    s_waitcnt lgkmcnt(5)
    v_mfma_f32_16x16x32_bf16 v[68:71], a[28:31], a[36:39], v[68:71]
    ds_read_b64_tr_b16 a[14:15], v7 offset:42336
    ds_read_b128 a[36:39], v5 offset:34816
    v_mfma_f32_16x16x32_bf16 v[48:51], a[16:19], a[40:43], v[48:51]
    ds_read_b64_tr_b16 a[16:17], v8 offset:41280
    v_mfma_f32_16x16x32_bf16 v[56:59], a[20:23], a[40:43], v[56:59]
    ds_read_b64_tr_b16 a[18:19], v8 offset:42304
    v_mfma_f32_16x16x32_bf16 v[64:67], a[24:27], a[40:43], v[64:67]
    ds_read_b64_tr_b16 a[20:21], v8 offset:41312
    v_mfma_f32_16x16x32_bf16 v[72:75], a[28:31], a[40:43], v[72:75]
    ds_read_b64_tr_b16 a[22:23], v8 offset:42336
    v_mfma_f32_16x16x32_bf16 v[12:15], a[0:3], a[32:35], v[12:15]
    ds_read_b64_tr_b16 a[24:25], v9 offset:41280
    s_waitcnt lgkmcnt(5)
    v_mfma_f32_16x16x32_bf16 v[20:23], a[4:7], a[32:35], v[20:23]
    ds_read_b64_tr_b16 a[26:27], v9 offset:42304
    v_mfma_f32_16x16x32_bf16 v[28:31], a[8:11], a[32:35], v[28:31]
    ds_read_b64_tr_b16 a[28:29], v9 offset:41312
    v_mfma_f32_16x16x32_bf16 v[36:39], a[12:15], a[32:35], v[36:39]
    ds_read_b64_tr_b16 a[30:31], v9 offset:42336
    ds_read_b128 a[40:43], v4 offset:49152
    v_mfma_f32_16x16x32_bf16 v[16:19], a[0:3], a[36:39], v[16:19]
    ds_read_b64_tr_b16 a[0:1], v6 offset:49536
    v_mfma_f32_16x16x32_bf16 v[24:27], a[4:7], a[36:39], v[24:27]
    ds_read_b64_tr_b16 a[2:3], v6 offset:50560
    v_mfma_f32_16x16x32_bf16 v[32:35], a[8:11], a[36:39], v[32:35]
    ds_read_b64_tr_b16 a[4:5], v6 offset:49568
    v_mfma_f32_16x16x32_bf16 v[40:43], a[12:15], a[36:39], v[40:43]
    ds_read_b64_tr_b16 a[6:7], v6 offset:50592
    s_waitcnt lgkmcnt(6)
    v_mfma_f32_16x16x32_bf16 v[44:47], a[16:19], a[32:35], v[44:47]
    ds_read_b64_tr_b16 a[8:9], v7 offset:49536
    v_mfma_f32_16x16x32_bf16 v[52:55], a[20:23], a[32:35], v[52:55]
    ds_read_b64_tr_b16 a[10:11], v7 offset:50560
    v_mfma_f32_16x16x32_bf16 v[60:63], a[24:27], a[32:35], v[60:63]
    ds_read_b64_tr_b16 a[12:13], v7 offset:49568
    s_waitcnt lgkmcnt(5)
    v_mfma_f32_16x16x32_bf16 v[68:71], a[28:31], a[32:35], v[68:71]
    s_barrier
    ds_read_b64_tr_b16 a[14:15], v7 offset:50592
    ds_read_b128 a[32:35], v4 offset:51200
    v_mfma_f32_16x16x32_bf16 v[48:51], a[16:19], a[36:39], v[48:51]
    ds_read_b64_tr_b16 a[16:17], v8 offset:49536
    v_mfma_f32_16x16x32_bf16 v[56:59], a[20:23], a[36:39], v[56:59]
    ds_read_b64_tr_b16 a[18:19], v8 offset:50560
    v_mfma_f32_16x16x32_bf16 v[64:67], a[24:27], a[36:39], v[64:67]
    ds_read_b64_tr_b16 a[20:21], v8 offset:49568
    v_mfma_f32_16x16x32_bf16 v[72:75], a[28:31], a[36:39], v[72:75]
    ds_read_b64_tr_b16 a[22:23], v8 offset:50592
    v_mfma_f32_16x16x32_bf16 v[12:15], a[0:3], a[40:43], v[12:15]
    ds_read_b64_tr_b16 a[24:25], v9 offset:49536
    s_waitcnt lgkmcnt(5)
    v_mfma_f32_16x16x32_bf16 v[20:23], a[4:7], a[40:43], v[20:23]
    ds_read_b64_tr_b16 a[26:27], v9 offset:50560
    v_mfma_f32_16x16x32_bf16 v[28:31], a[8:11], a[40:43], v[28:31]
    ds_read_b64_tr_b16 a[28:29], v9 offset:49568
    v_mfma_f32_16x16x32_bf16 v[36:39], a[12:15], a[40:43], v[36:39]
    ds_read_b64_tr_b16 a[30:31], v9 offset:50592
    ds_read_b128 a[36:39], v5 offset:49152
    v_mfma_f32_16x16x32_bf16 v[16:19], a[0:3], a[32:35], v[16:19]
    ds_read_b64_tr_b16 a[0:1], v6 offset:57792
    v_mfma_f32_16x16x32_bf16 v[24:27], a[4:7], a[32:35], v[24:27]
    ds_read_b64_tr_b16 a[2:3], v6 offset:58816
    v_mfma_f32_16x16x32_bf16 v[32:35], a[8:11], a[32:35], v[32:35]
    ds_read_b64_tr_b16 a[4:5], v6 offset:57824
    v_mfma_f32_16x16x32_bf16 v[40:43], a[12:15], a[32:35], v[40:43]
    ds_read_b64_tr_b16 a[6:7], v6 offset:58848
    s_waitcnt lgkmcnt(6)
    v_mfma_f32_16x16x32_bf16 v[44:47], a[16:19], a[40:43], v[44:47]
    ds_read_b64_tr_b16 a[8:9], v7 offset:57792
    v_mfma_f32_16x16x32_bf16 v[52:55], a[20:23], a[40:43], v[52:55]
    ds_read_b64_tr_b16 a[10:11], v7 offset:58816
    v_mfma_f32_16x16x32_bf16 v[60:63], a[24:27], a[40:43], v[60:63]
    ds_read_b64_tr_b16 a[12:13], v7 offset:57824
    s_waitcnt lgkmcnt(5)
    v_mfma_f32_16x16x32_bf16 v[68:71], a[28:31], a[40:43], v[68:71]
    ds_read_b64_tr_b16 a[14:15], v7 offset:58848
    ds_read_b128 a[40:43], v5 offset:51200
    v_mfma_f32_16x16x32_bf16 v[48:51], a[16:19], a[32:35], v[48:51]
    ds_read_b64_tr_b16 a[16:17], v8 offset:57792
    v_mfma_f32_16x16x32_bf16 v[56:59], a[20:23], a[32:35], v[56:59]
    ds_read_b64_tr_b16 a[18:19], v8 offset:58816
    v_mfma_f32_16x16x32_bf16 v[64:67], a[24:27], a[32:35], v[64:67]
    ds_read_b64_tr_b16 a[20:21], v8 offset:57824
    v_mfma_f32_16x16x32_bf16 v[72:75], a[28:31], a[32:35], v[72:75]
    ds_read_b64_tr_b16 a[22:23], v8 offset:58848
    v_mfma_f32_16x16x32_bf16 v[12:15], a[0:3], a[36:39], v[12:15]
    ds_read_b64_tr_b16 a[24:25], v9 offset:57792
    s_waitcnt lgkmcnt(5)
    v_mfma_f32_16x16x32_bf16 v[20:23], a[4:7], a[36:39], v[20:23]
    ds_read_b64_tr_b16 a[26:27], v9 offset:58816
    v_mfma_f32_16x16x32_bf16 v[28:31], a[8:11], a[36:39], v[28:31]
    ds_read_b64_tr_b16 a[28:29], v9 offset:57824
    v_mfma_f32_16x16x32_bf16 v[36:39], a[12:15], a[36:39], v[36:39]
    ds_read_b64_tr_b16 a[30:31], v9 offset:58848
    ds_read_b128 a[32:35], v4 offset:0
    v_mfma_f32_16x16x32_bf16 v[16:19], a[0:3], a[40:43], v[16:19]
    ds_read_b64_tr_b16 a[0:1], v6 offset:0
    v_mfma_f32_16x16x32_bf16 v[24:27], a[4:7], a[40:43], v[24:27]
    ds_read_b64_tr_b16 a[2:3], v6 offset:1024
    v_mfma_f32_16x16x32_bf16 v[32:35], a[8:11], a[40:43], v[32:35]
    ds_read_b64_tr_b16 a[4:5], v6 offset:32
    v_mfma_f32_16x16x32_bf16 v[40:43], a[12:15], a[40:43], v[40:43]
    ds_read_b64_tr_b16 a[6:7], v6 offset:1056
    s_waitcnt lgkmcnt(6)
    v_mfma_f32_16x16x32_bf16 v[44:47], a[16:19], a[36:39], v[44:47]
    ds_read_b64_tr_b16 a[8:9], v7 offset:0
    v_mfma_f32_16x16x32_bf16 v[52:55], a[20:23], a[36:39], v[52:55]
    ds_read_b64_tr_b16 a[10:11], v7 offset:1024
    v_mfma_f32_16x16x32_bf16 v[60:63], a[24:27], a[36:39], v[60:63]
    ds_read_b64_tr_b16 a[12:13], v7 offset:32
    s_waitcnt lgkmcnt(5)
    v_mfma_f32_16x16x32_bf16 v[68:71], a[28:31], a[36:39], v[68:71]
    s_barrier
    ds_read_b64_tr_b16 a[14:15], v7 offset:1056
    ds_read_b128 a[36:39], v4 offset:2048
    v_mfma_f32_16x16x32_bf16 v[48:51], a[16:19], a[40:43], v[48:51]
    ds_read_b64_tr_b16 a[16:17], v8 offset:0
    v_mfma_f32_16x16x32_bf16 v[56:59], a[20:23], a[40:43], v[56:59]
    ds_read_b64_tr_b16 a[18:19], v8 offset:1024
    v_mfma_f32_16x16x32_bf16 v[64:67], a[24:27], a[40:43], v[64:67]
    ds_read_b64_tr_b16 a[20:21], v8 offset:32
    v_mfma_f32_16x16x32_bf16 v[72:75], a[28:31], a[40:43], v[72:75]
    ds_read_b64_tr_b16 a[22:23], v8 offset:1056
    v_mfma_f32_16x16x32_bf16 v[12:15], a[0:3], a[32:35], v[12:15]
    ds_read_b64_tr_b16 a[24:25], v9 offset:0
    s_waitcnt lgkmcnt(5)
    v_mfma_f32_16x16x32_bf16 v[20:23], a[4:7], a[32:35], v[20:23]
    ds_read_b64_tr_b16 a[26:27], v9 offset:1024
    v_mfma_f32_16x16x32_bf16 v[28:31], a[8:11], a[32:35], v[28:31]
    ds_read_b64_tr_b16 a[28:29], v9 offset:32
    v_mfma_f32_16x16x32_bf16 v[36:39], a[12:15], a[32:35], v[36:39]
    ds_read_b64_tr_b16 a[30:31], v9 offset:1056
    ds_read_b128 a[40:43], v5 offset:0
    v_mfma_f32_16x16x32_bf16 v[16:19], a[0:3], a[36:39], v[16:19]
    ds_read_b64_tr_b16 a[0:1], v6 offset:8256
    v_mfma_f32_16x16x32_bf16 v[24:27], a[4:7], a[36:39], v[24:27]
    ds_read_b64_tr_b16 a[2:3], v6 offset:9280
    v_mfma_f32_16x16x32_bf16 v[32:35], a[8:11], a[36:39], v[32:35]
    ds_read_b64_tr_b16 a[4:5], v6 offset:8288
    v_mfma_f32_16x16x32_bf16 v[40:43], a[12:15], a[36:39], v[40:43]
    ds_read_b64_tr_b16 a[6:7], v6 offset:9312
    s_waitcnt lgkmcnt(6)
    v_mfma_f32_16x16x32_bf16 v[44:47], a[16:19], a[32:35], v[44:47]
    ds_read_b64_tr_b16 a[8:9], v7 offset:8256
    v_mfma_f32_16x16x32_bf16 v[52:55], a[20:23], a[32:35], v[52:55]
    ds_read_b64_tr_b16 a[10:11], v7 offset:9280
    v_mfma_f32_16x16x32_bf16 v[60:63], a[24:27], a[32:35], v[60:63]
    ds_read_b64_tr_b16 a[12:13], v7 offset:8288
    s_waitcnt lgkmcnt(5)
    v_mfma_f32_16x16x32_bf16 v[68:71], a[28:31], a[32:35], v[68:71]
    ds_read_b64_tr_b16 a[14:15], v7 offset:9312
    ds_read_b128 a[32:35], v5 offset:2048
    v_mfma_f32_16x16x32_bf16 v[48:51], a[16:19], a[36:39], v[48:51]
    ds_read_b64_tr_b16 a[16:17], v8 offset:8256
    v_mfma_f32_16x16x32_bf16 v[56:59], a[20:23], a[36:39], v[56:59]
    ds_read_b64_tr_b16 a[18:19], v8 offset:9280
    v_mfma_f32_16x16x32_bf16 v[64:67], a[24:27], a[36:39], v[64:67]
    ds_read_b64_tr_b16 a[20:21], v8 offset:8288
    v_mfma_f32_16x16x32_bf16 v[72:75], a[28:31], a[36:39], v[72:75]
    ds_read_b64_tr_b16 a[22:23], v8 offset:9312
    v_mfma_f32_16x16x32_bf16 v[12:15], a[0:3], a[40:43], v[12:15]
    ds_read_b64_tr_b16 a[24:25], v9 offset:8256
    s_waitcnt lgkmcnt(5)
    v_mfma_f32_16x16x32_bf16 v[20:23], a[4:7], a[40:43], v[20:23]
    ds_read_b64_tr_b16 a[26:27], v9 offset:9280
    v_mfma_f32_16x16x32_bf16 v[28:31], a[8:11], a[40:43], v[28:31]
    ds_read_b64_tr_b16 a[28:29], v9 offset:8288
    v_mfma_f32_16x16x32_bf16 v[36:39], a[12:15], a[40:43], v[36:39]
    ds_read_b64_tr_b16 a[30:31], v9 offset:9312
    ds_read_b128 a[36:39], v4 offset:16384
    v_mfma_f32_16x16x32_bf16 v[16:19], a[0:3], a[32:35], v[16:19]
    ds_read_b64_tr_b16 a[0:1], v6 offset:16512
    v_mfma_f32_16x16x32_bf16 v[24:27], a[4:7], a[32:35], v[24:27]
    ds_read_b64_tr_b16 a[2:3], v6 offset:17536
    v_mfma_f32_16x16x32_bf16 v[32:35], a[8:11], a[32:35], v[32:35]
    ds_read_b64_tr_b16 a[4:5], v6 offset:16544
    v_mfma_f32_16x16x32_bf16 v[40:43], a[12:15], a[32:35], v[40:43]
    ds_read_b64_tr_b16 a[6:7], v6 offset:17568
    s_waitcnt lgkmcnt(6)
    v_mfma_f32_16x16x32_bf16 v[44:47], a[16:19], a[40:43], v[44:47]
    ds_read_b64_tr_b16 a[8:9], v7 offset:16512
    v_mfma_f32_16x16x32_bf16 v[52:55], a[20:23], a[40:43], v[52:55]
    ds_read_b64_tr_b16 a[10:11], v7 offset:17536
    v_mfma_f32_16x16x32_bf16 v[60:63], a[24:27], a[40:43], v[60:63]
    ds_read_b64_tr_b16 a[12:13], v7 offset:16544
    s_waitcnt lgkmcnt(5)
    v_mfma_f32_16x16x32_bf16 v[68:71], a[28:31], a[40:43], v[68:71]
    s_barrier
    ds_read_b64_tr_b16 a[14:15], v7 offset:17568
    ds_read_b128 a[40:43], v4 offset:18432
    v_mfma_f32_16x16x32_bf16 v[48:51], a[16:19], a[32:35], v[48:51]
    ds_read_b64_tr_b16 a[16:17], v8 offset:16512
    v_mfma_f32_16x16x32_bf16 v[56:59], a[20:23], a[32:35], v[56:59]
    ds_read_b64_tr_b16 a[18:19], v8 offset:17536
    v_mfma_f32_16x16x32_bf16 v[64:67], a[24:27], a[32:35], v[64:67]
    ds_read_b64_tr_b16 a[20:21], v8 offset:16544
    v_mfma_f32_16x16x32_bf16 v[72:75], a[28:31], a[32:35], v[72:75]
    ds_read_b64_tr_b16 a[22:23], v8 offset:17568
    v_mfma_f32_16x16x32_bf16 v[12:15], a[0:3], a[36:39], v[12:15]
    ds_read_b64_tr_b16 a[24:25], v9 offset:16512
    s_waitcnt lgkmcnt(5)
    v_mfma_f32_16x16x32_bf16 v[20:23], a[4:7], a[36:39], v[20:23]
    ds_read_b64_tr_b16 a[26:27], v9 offset:17536
    v_mfma_f32_16x16x32_bf16 v[28:31], a[8:11], a[36:39], v[28:31]
    ds_read_b64_tr_b16 a[28:29], v9 offset:16544
    v_mfma_f32_16x16x32_bf16 v[36:39], a[12:15], a[36:39], v[36:39]
    ds_read_b64_tr_b16 a[30:31], v9 offset:17568
    v_mfma_f32_16x16x32_bf16 v[16:19], a[0:3], a[40:43], v[16:19]
    v_xor_b32 v1, 0, v11
    ds_read_b64 a[68:69], v1 offset:0
    v_mfma_f32_16x16x32_bf16 v[24:27], a[4:7], a[40:43], v[24:27]
    ds_read_b64 a[72:73], v1 offset:2048
    ds_read_b128 a[32:35], v5 offset:16384
    v_mfma_f32_16x16x32_bf16 v[32:35], a[8:11], a[40:43], v[32:35]
    ds_read_b64_tr_b16 a[0:1], v6 offset:24768
    v_mfma_f32_16x16x32_bf16 v[40:43], a[12:15], a[40:43], v[40:43]
    ds_read_b64_tr_b16 a[2:3], v6 offset:25792
    s_waitcnt lgkmcnt(6)
    v_mfma_f32_16x16x32_bf16 v[44:47], a[16:19], a[36:39], v[44:47]
    v_xor_b32 v1, 32, v11
    ds_read_b64 a[70:71], v1 offset:0
    v_mfma_f32_16x16x32_bf16 v[52:55], a[20:23], a[36:39], v[52:55]
    ds_read_b64 a[74:75], v1 offset:2048
    ds_read_b64_tr_b16 a[4:5], v6 offset:24800
    v_mfma_f32_16x16x32_bf16 v[60:63], a[24:27], a[36:39], v[60:63]
    ds_read_b64_tr_b16 a[6:7], v6 offset:25824
    ds_read_b64_tr_b16 a[8:9], v7 offset:24768
    s_waitcnt lgkmcnt(7)
    v_mfma_f32_16x16x32_bf16 v[68:71], a[28:31], a[36:39], v[68:71]
    ds_read_b64_tr_b16 a[10:11], v7 offset:25792
    ds_read_b64_tr_b16 a[12:13], v7 offset:24800
    v_mfma_f32_16x16x32_bf16 v[48:51], a[16:19], a[40:43], v[48:51]
    ds_read_b64_tr_b16 a[14:15], v7 offset:25824
    ds_read_b128 a[36:39], v5 offset:18432
    v_mfma_f32_16x16x32_bf16 v[56:59], a[20:23], a[40:43], v[56:59]
    v_xor_b32 v1, 64, v11
    ds_read_b64 a[76:77], v1 offset:0
    v_mfma_f32_16x16x32_bf16 v[64:67], a[24:27], a[40:43], v[64:67]
    ds_read_b64 a[80:81], v1 offset:2048
    ds_read_b64_tr_b16 a[16:17], v8 offset:24768
    v_mfma_f32_16x16x32_bf16 v[72:75], a[28:31], a[40:43], v[72:75]
    ds_read_b64_tr_b16 a[18:19], v8 offset:25792
    s_waitcnt lgkmcnt(8)
    v_mfma_f32_16x16x32_bf16 v[12:15], a[0:3], a[32:35], v[12:15]
    v_xor_b32 v1, 96, v11
    ds_read_b64 a[78:79], v1 offset:0
    v_mfma_f32_16x16x32_bf16 v[20:23], a[4:7], a[32:35], v[20:23]
    ds_read_b64 a[82:83], v1 offset:2048
    ds_read_b64_tr_b16 a[20:21], v8 offset:24800
    s_waitcnt lgkmcnt(7)
    v_mfma_f32_16x16x32_bf16 v[28:31], a[8:11], a[32:35], v[28:31]
    ds_read_b64_tr_b16 a[22:23], v8 offset:25824
    ds_read_b64_tr_b16 a[24:25], v9 offset:24768
    v_mfma_f32_16x16x32_bf16 v[36:39], a[12:15], a[32:35], v[36:39]
    ds_read_b64_tr_b16 a[26:27], v9 offset:25792
    ds_read_b64_tr_b16 a[28:29], v9 offset:24800
    v_mfma_f32_16x16x32_bf16 v[16:19], a[0:3], a[36:39], v[16:19]
    ds_read_b64_tr_b16 a[30:31], v9 offset:25824
    ds_read_b128 a[40:43], v4 offset:32768
    v_mfma_f32_16x16x32_bf16 v[24:27], a[4:7], a[36:39], v[24:27]
    ds_read_b64_tr_b16 a[0:1], v6 offset:33024
    v_mfma_f32_16x16x32_bf16 v[32:35], a[8:11], a[36:39], v[32:35]
    ds_read_b64_tr_b16 a[2:3], v6 offset:34048
    v_mfma_f32_16x16x32_bf16 v[40:43], a[12:15], a[36:39], v[40:43]
    ds_read_b64_tr_b16 a[4:5], v6 offset:33056
    s_waitcnt lgkmcnt(7)
    v_mfma_f32_16x16x32_bf16 v[44:47], a[16:19], a[32:35], v[44:47]
    ds_read_b64_tr_b16 a[6:7], v6 offset:34080
    v_mfma_f32_16x16x32_bf16 v[52:55], a[20:23], a[32:35], v[52:55]
    ds_read_b64_tr_b16 a[8:9], v7 offset:33024
    s_waitcnt lgkmcnt(5)
    v_mfma_f32_16x16x32_bf16 v[60:63], a[24:27], a[32:35], v[60:63]
    s_barrier
    ds_read_b64_tr_b16 a[10:11], v7 offset:34048
    ds_read_b64_tr_b16 a[12:13], v7 offset:33056
    v_mfma_f32_16x16x32_bf16 v[68:71], a[28:31], a[32:35], v[68:71]
    ds_read_b64_tr_b16 a[14:15], v7 offset:34080
    ds_read_b128 a[32:35], v4 offset:34816
    v_mfma_f32_16x16x32_bf16 v[48:51], a[16:19], a[36:39], v[48:51]
    ds_read_b64_tr_b16 a[16:17], v8 offset:33024
    v_mfma_f32_16x16x32_bf16 v[56:59], a[20:23], a[36:39], v[56:59]
    ds_read_b64_tr_b16 a[18:19], v8 offset:34048
    v_mfma_f32_16x16x32_bf16 v[64:67], a[24:27], a[36:39], v[64:67]
    ds_read_b64_tr_b16 a[20:21], v8 offset:33056
    v_mfma_f32_16x16x32_bf16 v[72:75], a[28:31], a[36:39], v[72:75]
    ds_read_b64_tr_b16 a[22:23], v8 offset:34080
    s_waitcnt lgkmcnt(6)
    v_mfma_f32_16x16x32_bf16 v[12:15], a[0:3], a[40:43], v[12:15]
    ds_read_b64_tr_b16 a[24:25], v9 offset:33024
    v_mfma_f32_16x16x32_bf16 v[20:23], a[4:7], a[40:43], v[20:23]
    ds_read_b64_tr_b16 a[26:27], v9 offset:34048
    v_mfma_f32_16x16x32_bf16 v[28:31], a[8:11], a[40:43], v[28:31]
    ds_read_b64_tr_b16 a[28:29], v9 offset:33056
    s_waitcnt lgkmcnt(5)
    v_mfma_f32_16x16x32_bf16 v[36:39], a[12:15], a[40:43], v[36:39]
    ds_read_b64_tr_b16 a[30:31], v9 offset:34080
    ds_read_b128 a[36:39], v5 offset:32768
    v_mfma_f32_16x16x32_bf16 v[16:19], a[0:3], a[32:35], v[16:19]
    ds_read_b64_tr_b16 a[0:1], v6 offset:41280
    v_mfma_f32_16x16x32_bf16 v[24:27], a[4:7], a[32:35], v[24:27]
    ds_read_b64_tr_b16 a[2:3], v6 offset:42304
    v_mfma_f32_16x16x32_bf16 v[32:35], a[8:11], a[32:35], v[32:35]
    ds_read_b64_tr_b16 a[4:5], v6 offset:41312
    v_mfma_f32_16x16x32_bf16 v[40:43], a[12:15], a[32:35], v[40:43]
    ds_read_b64_tr_b16 a[6:7], v6 offset:42336
    v_mfma_f32_16x16x32_bf16 v[44:47], a[16:19], a[40:43], v[44:47]
    ds_read_b64_tr_b16 a[8:9], v7 offset:41280
    s_waitcnt lgkmcnt(5)
    v_mfma_f32_16x16x32_bf16 v[52:55], a[20:23], a[40:43], v[52:55]
    ds_read_b64_tr_b16 a[10:11], v7 offset:42304
    v_mfma_f32_16x16x32_bf16 v[60:63], a[24:27], a[40:43], v[60:63]
    ds_read_b64_tr_b16 a[12:13], v7 offset:41312
    v_mfma_f32_16x16x32_bf16 v[68:71], a[28:31], a[40:43], v[68:71]
    ds_read_b64_tr_b16 a[14:15], v7 offset:42336
    ds_read_b128 a[40:43], v5 offset:34816
    v_mfma_f32_16x16x32_bf16 v[48:51], a[16:19], a[32:35], v[48:51]
    ds_read_b64_tr_b16 a[16:17], v8 offset:41280
    v_mfma_f32_16x16x32_bf16 v[56:59], a[20:23], a[32:35], v[56:59]
    ds_read_b64_tr_b16 a[18:19], v8 offset:42304
    v_mfma_f32_16x16x32_bf16 v[64:67], a[24:27], a[32:35], v[64:67]
    ds_read_b64_tr_b16 a[20:21], v8 offset:41312
    v_mfma_f32_16x16x32_bf16 v[72:75], a[28:31], a[32:35], v[72:75]
    ds_read_b64_tr_b16 a[22:23], v8 offset:42336
    s_waitcnt lgkmcnt(6)
    v_mfma_f32_16x16x32_bf16 v[12:15], a[0:3], a[36:39], v[12:15]
    ds_read_b64_tr_b16 a[24:25], v9 offset:41280
    v_mfma_f32_16x16x32_bf16 v[20:23], a[4:7], a[36:39], v[20:23]
    ds_read_b64_tr_b16 a[26:27], v9 offset:42304
    v_mfma_f32_16x16x32_bf16 v[28:31], a[8:11], a[36:39], v[28:31]
    ds_read_b64_tr_b16 a[28:29], v9 offset:41312
    s_waitcnt lgkmcnt(5)
    v_mfma_f32_16x16x32_bf16 v[36:39], a[12:15], a[36:39], v[36:39]
    ds_read_b64_tr_b16 a[30:31], v9 offset:42336
    ds_read_b128 a[32:35], v4 offset:49152
    v_mfma_f32_16x16x32_bf16 v[16:19], a[0:3], a[40:43], v[16:19]
    ds_read_b64_tr_b16 a[0:1], v6 offset:49536
    v_mfma_f32_16x16x32_bf16 v[24:27], a[4:7], a[40:43], v[24:27]
    ds_read_b64_tr_b16 a[2:3], v6 offset:50560
    v_mfma_f32_16x16x32_bf16 v[32:35], a[8:11], a[40:43], v[32:35]
    ds_read_b64_tr_b16 a[4:5], v6 offset:49568
    v_mfma_f32_16x16x32_bf16 v[40:43], a[12:15], a[40:43], v[40:43]
    ds_read_b64_tr_b16 a[6:7], v6 offset:50592
    v_mfma_f32_16x16x32_bf16 v[44:47], a[16:19], a[36:39], v[44:47]
    ds_read_b64_tr_b16 a[8:9], v7 offset:49536
    s_waitcnt lgkmcnt(5)
    v_mfma_f32_16x16x32_bf16 v[52:55], a[20:23], a[36:39], v[52:55]
    ds_read_b64_tr_b16 a[10:11], v7 offset:50560
    v_mfma_f32_16x16x32_bf16 v[60:63], a[24:27], a[36:39], v[60:63]
    ds_read_b64_tr_b16 a[12:13], v7 offset:49568
    v_mfma_f32_16x16x32_bf16 v[68:71], a[28:31], a[36:39], v[68:71]
    ds_read_b64_tr_b16 a[14:15], v7 offset:50592
    ds_read_b128 a[36:39], v4 offset:51200
    v_mfma_f32_16x16x32_bf16 v[48:51], a[16:19], a[40:43], v[48:51]
    ds_read_b64_tr_b16 a[16:17], v8 offset:49536
    v_mfma_f32_16x16x32_bf16 v[56:59], a[20:23], a[40:43], v[56:59]
    ds_read_b64_tr_b16 a[18:19], v8 offset:50560
    v_mfma_f32_16x16x32_bf16 v[64:67], a[24:27], a[40:43], v[64:67]
    ds_read_b64_tr_b16 a[20:21], v8 offset:49568
    v_mfma_f32_16x16x32_bf16 v[72:75], a[28:31], a[40:43], v[72:75]
    ds_read_b64_tr_b16 a[22:23], v8 offset:50592
    s_waitcnt lgkmcnt(6)
    v_mfma_f32_16x16x32_bf16 v[12:15], a[0:3], a[32:35], v[12:15]
    ds_read_b64_tr_b16 a[24:25], v9 offset:49536
    v_mfma_f32_16x16x32_bf16 v[20:23], a[4:7], a[32:35], v[20:23]
    ds_read_b64_tr_b16 a[26:27], v9 offset:50560
    v_mfma_f32_16x16x32_bf16 v[28:31], a[8:11], a[32:35], v[28:31]
    ds_read_b64_tr_b16 a[28:29], v9 offset:49568
    s_waitcnt lgkmcnt(5)
    v_mfma_f32_16x16x32_bf16 v[36:39], a[12:15], a[32:35], v[36:39]
    ds_read_b64_tr_b16 a[30:31], v9 offset:50592
    ds_read_b128 a[40:43], v5 offset:49152
    v_mfma_f32_16x16x32_bf16 v[16:19], a[0:3], a[36:39], v[16:19]
    ds_read_b64_tr_b16 a[0:1], v6 offset:57792
    v_mfma_f32_16x16x32_bf16 v[24:27], a[4:7], a[36:39], v[24:27]
    ds_read_b64_tr_b16 a[2:3], v6 offset:58816
    v_mfma_f32_16x16x32_bf16 v[32:35], a[8:11], a[36:39], v[32:35]
    ds_read_b64_tr_b16 a[4:5], v6 offset:57824
    v_mfma_f32_16x16x32_bf16 v[40:43], a[12:15], a[36:39], v[40:43]
    ds_read_b64_tr_b16 a[6:7], v6 offset:58848
    v_mfma_f32_16x16x32_bf16 v[44:47], a[16:19], a[32:35], v[44:47]
    ds_read_b64_tr_b16 a[8:9], v7 offset:57792
    s_waitcnt lgkmcnt(5)
    v_mfma_f32_16x16x32_bf16 v[52:55], a[20:23], a[32:35], v[52:55]
    ds_read_b64_tr_b16 a[10:11], v7 offset:58816
    v_mfma_f32_16x16x32_bf16 v[60:63], a[24:27], a[32:35], v[60:63]
    ds_read_b64_tr_b16 a[12:13], v7 offset:57824
    v_mfma_f32_16x16x32_bf16 v[68:71], a[28:31], a[32:35], v[68:71]
    ds_read_b64_tr_b16 a[14:15], v7 offset:58848
    ds_read_b128 a[32:35], v5 offset:51200
    v_mfma_f32_16x16x32_bf16 v[48:51], a[16:19], a[36:39], v[48:51]
    ds_read_b64_tr_b16 a[16:17], v8 offset:57792
    v_mfma_f32_16x16x32_bf16 v[56:59], a[20:23], a[36:39], v[56:59]
    ds_read_b64_tr_b16 a[18:19], v8 offset:58816
    v_mfma_f32_16x16x32_bf16 v[64:67], a[24:27], a[36:39], v[64:67]
    ds_read_b64_tr_b16 a[20:21], v8 offset:57824
    v_mfma_f32_16x16x32_bf16 v[72:75], a[28:31], a[36:39], v[72:75]
    ds_read_b64_tr_b16 a[22:23], v8 offset:58848
    s_waitcnt lgkmcnt(6)
    v_mfma_f32_16x16x32_bf16 v[12:15], a[0:3], a[40:43], v[12:15]
    ds_read_b64_tr_b16 a[24:25], v9 offset:57792
    v_mfma_f32_16x16x32_bf16 v[20:23], a[4:7], a[40:43], v[20:23]
    ds_read_b64_tr_b16 a[26:27], v9 offset:58816
    v_mfma_f32_16x16x32_bf16 v[28:31], a[8:11], a[40:43], v[28:31]
    ds_read_b64_tr_b16 a[28:29], v9 offset:57824
    s_waitcnt lgkmcnt(5)
    v_mfma_f32_16x16x32_bf16 v[36:39], a[12:15], a[40:43], v[36:39]
    ds_read_b64_tr_b16 a[30:31], v9 offset:58848
    v_mfma_f32_16x16x32_bf16 v[16:19], a[0:3], a[32:35], v[16:19]
    v_mfma_f32_16x16x32_bf16 v[24:27], a[4:7], a[32:35], v[24:27]
    v_mfma_f32_16x16x32_bf16 v[32:35], a[8:11], a[32:35], v[32:35]
    v_mfma_f32_16x16x32_bf16 v[40:43], a[12:15], a[32:35], v[40:43]
    v_mfma_f32_16x16x32_bf16 v[44:47], a[16:19], a[40:43], v[44:47]
    s_waitcnt lgkmcnt(0)
    v_mfma_f32_16x16x32_bf16 v[52:55], a[20:23], a[40:43], v[52:55]
    v_mfma_f32_16x16x32_bf16 v[60:63], a[24:27], a[40:43], v[60:63]
    v_mfma_f32_16x16x32_bf16 v[68:71], a[28:31], a[40:43], v[68:71]
    v_mfma_f32_16x16x32_bf16 v[48:51], a[16:19], a[32:35], v[48:51]
    v_mfma_f32_16x16x32_bf16 v[56:59], a[20:23], a[32:35], v[56:59]
    v_mfma_f32_16x16x32_bf16 v[64:67], a[24:27], a[32:35], v[64:67]
    v_mfma_f32_16x16x32_bf16 v[72:75], a[28:31], a[32:35], v[72:75]
    v_mov_b32 v1, 162848
    ds_read_b64 v[132:133], v1
    v_cvt_pk_bf16_f32 v76, v12, v13
    v_cvt_pk_bf16_f32 v77, v14, v15
    v_cvt_pk_bf16_f32 v78, v20, v21
    v_cvt_pk_bf16_f32 v79, v22, v23
    v_cvt_pk_bf16_f32 v80, v16, v17
    v_cvt_pk_bf16_f32 v81, v18, v19
    v_cvt_pk_bf16_f32 v82, v24, v25
    v_cvt_pk_bf16_f32 v83, v26, v27
    v_cvt_pk_bf16_f32 v84, v28, v29
    v_cvt_pk_bf16_f32 v85, v30, v31
    v_cvt_pk_bf16_f32 v86, v36, v37
    v_cvt_pk_bf16_f32 v87, v38, v39
    v_cvt_pk_bf16_f32 v88, v32, v33
    v_cvt_pk_bf16_f32 v89, v34, v35
    v_cvt_pk_bf16_f32 v90, v40, v41
    v_cvt_pk_bf16_f32 v91, v42, v43
    v_mfma_f32_16x16x32_bf16 v[108:111], a[52:55], v[76:79], 0
    v_cvt_pk_bf16_f32 v92, v44, v45
    v_cvt_pk_bf16_f32 v93, v46, v47
    v_mfma_f32_16x16x32_bf16 v[112:115], a[56:59], v[76:79], 0
    v_cvt_pk_bf16_f32 v94, v52, v53
    v_cvt_pk_bf16_f32 v95, v54, v55
    v_mfma_f32_16x16x32_bf16 v[116:119], a[52:55], v[80:83], 0
    v_cvt_pk_bf16_f32 v96, v48, v49
    v_cvt_pk_bf16_f32 v97, v50, v51
    v_mfma_f32_16x16x32_bf16 v[120:123], a[56:59], v[80:83], 0
    v_cvt_pk_bf16_f32 v98, v56, v57
    v_cvt_pk_bf16_f32 v99, v58, v59
    v_mfma_f32_16x16x32_bf16 v[108:111], a[60:63], v[84:87], v[108:111]
    v_cvt_pk_bf16_f32 v100, v60, v61
    v_cvt_pk_bf16_f32 v101, v62, v63
    v_mfma_f32_16x16x32_bf16 v[112:115], a[64:67], v[84:87], v[112:115]
    v_cvt_pk_bf16_f32 v102, v68, v69
    v_cvt_pk_bf16_f32 v103, v70, v71
    v_mfma_f32_16x16x32_bf16 v[116:119], a[60:63], v[88:91], v[116:119]
    v_cvt_pk_bf16_f32 v104, v64, v65
    v_cvt_pk_bf16_f32 v105, v66, v67
    v_mfma_f32_16x16x32_bf16 v[120:123], a[64:67], v[88:91], v[120:123]
    v_cvt_pk_bf16_f32 v106, v72, v73
    v_cvt_pk_bf16_f32 v107, v74, v75
    v_mfma_f32_16x16x32_bf16 v[108:111], a[68:71], v[92:95], v[108:111]
    v_mfma_f32_16x16x32_bf16 v[112:115], a[72:75], v[92:95], v[112:115]
    v_mfma_f32_16x16x32_bf16 v[116:119], a[68:71], v[96:99], v[116:119]
    v_mfma_f32_16x16x32_bf16 v[120:123], a[72:75], v[96:99], v[120:123]
    v_mfma_f32_16x16x32_bf16 v[108:111], a[76:79], v[100:103], v[108:111]
    v_mfma_f32_16x16x32_bf16 v[112:115], a[80:83], v[100:103], v[112:115]
    v_mfma_f32_16x16x32_bf16 v[116:119], a[76:79], v[104:107], v[116:119]
    v_mfma_f32_16x16x32_bf16 v[120:123], a[80:83], v[104:107], v[120:123]
    s_waitcnt lgkmcnt(0)
    v_readfirstlane_b32 s16, v132
    v_readfirstlane_b32 s17, v133
    s_bitcmp1_b32 s6, 0
    s_cbranch_scc0 RS0
    v_swap_b32 v6, v7
    v_swap_b32 v8, v9
RS0:
    s_bitcmp1_b32 s6, 1
    s_cbranch_scc0 RS1
    v_swap_b32 v6, v8
    v_swap_b32 v7, v9
RS1:
    s_nop 1
    v_max3_f32 v12, v108, v109, v110
    v_max3_f32 v13, v116, v117, v118
    v_max3_f32 v12, v12, v111, v112
    v_max3_f32 v13, v13, v119, v120
    v_max3_f32 v12, v12, v113, v114
    v_max3_f32 v13, v13, v121, v122
    v_max_f32 v12, v12, v115
    v_max_f32 v13, v13, v123
    v_mov_b32 v14, v12
    v_mov_b32 v15, v13
    s_nop 0
    v_permlane32_swap_b32 v12, v14
    v_permlane32_swap_b32 v13, v15
    s_nop 0
    v_max_f32 v12, v12, v14
    v_max_f32 v13, v13, v15
    v_mov_b32 v14, v12
    v_mov_b32 v15, v13
    s_nop 0
    v_permlane16_swap_b32 v12, v14
    v_permlane16_swap_b32 v13, v15
    s_nop 0
    v_max_f32 v12, v12, v14
    v_max_f32 v13, v13, v15
    v_mul_f32 v12, s34, v12
    v_mul_f32 v13, s34, v13
    v_fma_f32 v108, v108, s34, -v12
    v_fma_f32 v109, v109, s34, -v12
    v_fma_f32 v110, v110, s34, -v12
    v_fma_f32 v111, v111, s34, -v12
    v_fma_f32 v112, v112, s34, -v12
    v_fma_f32 v113, v113, s34, -v12
    v_fma_f32 v114, v114, s34, -v12
    v_fma_f32 v115, v115, s34, -v12
    v_fma_f32 v116, v116, s34, -v13
    v_fma_f32 v117, v117, s34, -v13
    v_fma_f32 v118, v118, s34, -v13
    v_fma_f32 v119, v119, s34, -v13
    v_fma_f32 v120, v120, s34, -v13
    v_fma_f32 v121, v121, s34, -v13
    v_fma_f32 v122, v122, s34, -v13
    v_fma_f32 v123, v123, s34, -v13
    v_exp_f32 v108, v108
    v_exp_f32 v109, v109
    v_exp_f32 v110, v110
    v_exp_f32 v111, v111
    v_exp_f32 v112, v112
    v_exp_f32 v113, v113
    v_exp_f32 v114, v114
    v_exp_f32 v115, v115
    v_exp_f32 v116, v116
    v_exp_f32 v117, v117
    v_exp_f32 v118, v118
    v_exp_f32 v119, v119
    v_exp_f32 v120, v120
    v_exp_f32 v121, v121
    v_exp_f32 v122, v122
    v_exp_f32 v123, v123
    v_add_f32 v12, v108, v109
    v_add_f32 v13, v116, v117
    v_add_f32 v12, v12, v110
    v_add_f32 v13, v13, v118
    v_add_f32 v12, v12, v111
    v_add_f32 v13, v13, v119
    v_add_f32 v12, v12, v112
    v_add_f32 v13, v13, v120
    v_add_f32 v12, v12, v113
    v_add_f32 v13, v13, v121
    v_add_f32 v12, v12, v114
    v_add_f32 v13, v13, v122
    v_add_f32 v12, v12, v115
    v_add_f32 v13, v13, v123
    v_mov_b32 v14, v12
    v_mov_b32 v15, v13
    s_nop 0
    v_permlane32_swap_b32 v12, v14
    v_permlane32_swap_b32 v13, v15
    s_nop 0
    v_add_f32 v12, v12, v14
    v_add_f32 v13, v13, v15
    v_mov_b32 v14, v12
    v_mov_b32 v15, v13
    s_nop 0
    v_permlane16_swap_b32 v12, v14
    v_permlane16_swap_b32 v13, v15
    s_nop 0
    v_add_f32 v12, v12, v14
    v_add_f32 v13, v13, v15
    v_rcp_f32 v12, v12
    v_rcp_f32 v13, v13
    s_nop 0
    v_mul_f32 v108, v108, v12
    v_mul_f32 v109, v109, v12
    v_mul_f32 v110, v110, v12
    v_mul_f32 v111, v111, v12
    v_mul_f32 v112, v112, v12
    v_mul_f32 v113, v113, v12
    v_mul_f32 v114, v114, v12
    v_mul_f32 v115, v115, v12
    v_mul_f32 v116, v116, v13
    v_mul_f32 v117, v117, v13
    v_mul_f32 v118, v118, v13
    v_mul_f32 v119, v119, v13
    v_mul_f32 v120, v120, v13
    v_mul_f32 v121, v121, v13
    v_mul_f32 v122, v122, v13
    v_mul_f32 v123, v123, v13
    v_cvt_pk_bf16_f32 v124, v108, v109
    v_cvt_pk_bf16_f32 v125, v110, v111
    v_cvt_pk_bf16_f32 v126, v112, v113
    v_cvt_pk_bf16_f32 v127, v114, v115
    v_cvt_pk_bf16_f32 v128, v116, v117
    v_cvt_pk_bf16_f32 v129, v118, v119
    v_cvt_pk_bf16_f32 v130, v120, v121
    v_cvt_pk_bf16_f32 v131, v122, v123
    buffer_store_dwordx4 v[124:127], v10, s[64:67], s30 offen offset:0 sc0 sc1
    buffer_store_dwordx4 v[128:131], v10, s[64:67], s30 offen offset:1024 sc0 sc1
    v_add_u32 v11, s32, v10
    s_mul_i32 s18, s16, 0x9e3779b1
    s_xor_b32 s18, s18, s17
    s_barrier
    ds_read_b128 a[32:35], v4 offset:0
    ds_read_b64_tr_b16 a[0:1], v6 offset:0
    ds_read_b64_tr_b16 a[2:3], v6 offset:1024
    ds_read_b64_tr_b16 a[4:5], v6 offset:32
    ds_read_b64_tr_b16 a[6:7], v6 offset:1056
    ds_read_b64_tr_b16 a[8:9], v7 offset:0
    ds_read_b64_tr_b16 a[10:11], v7 offset:1024
    ds_read_b64_tr_b16 a[12:13], v7 offset:32
    ds_read_b64_tr_b16 a[14:15], v7 offset:1056
    ds_read_b128 a[36:39], v4 offset:2048
    ds_read_b64_tr_b16 a[16:17], v8 offset:0
    ds_read_b64_tr_b16 a[18:19], v8 offset:1024
    ds_read_b64_tr_b16 a[20:21], v8 offset:32
    ds_read_b64_tr_b16 a[22:23], v8 offset:1056
    ds_read_b64_tr_b16 a[24:25], v9 offset:0
    ds_read_b64_tr_b16 a[26:27], v9 offset:1024
    ds_read_b64_tr_b16 a[28:29], v9 offset:32
    ds_read_b64_tr_b16 a[30:31], v9 offset:1056
    s_waitcnt lgkmcnt(14)
    v_mfma_f32_16x16x32_bf16 v[12:15], a[32:35], a[0:3], 0
    s_barrier
    s_waitcnt lgkmcnt(13)
    v_mfma_f32_16x16x32_bf16 v[20:23], a[32:35], a[4:7], 0
    s_waitcnt lgkmcnt(11)
    v_mfma_f32_16x16x32_bf16 v[28:31], a[32:35], a[8:11], 0
    s_waitcnt lgkmcnt(9)
    v_mfma_f32_16x16x32_bf16 v[36:39], a[32:35], a[12:15], 0
    ds_read_b128 a[40:43], v5 offset:0
    s_waitcnt lgkmcnt(9)
    v_mfma_f32_16x16x32_bf16 v[16:19], a[36:39], a[0:3], 0
    ds_read_b64_tr_b16 a[0:1], v6 offset:8256
    v_mfma_f32_16x16x32_bf16 v[24:27], a[36:39], a[4:7], 0
    ds_read_b64_tr_b16 a[2:3], v6 offset:9280
    v_mfma_f32_16x16x32_bf16 v[32:35], a[36:39], a[8:11], 0
    ds_read_b64_tr_b16 a[4:5], v6 offset:8288
    v_mfma_f32_16x16x32_bf16 v[40:43], a[36:39], a[12:15], 0
    ds_read_b64_tr_b16 a[6:7], v6 offset:9312
    s_waitcnt lgkmcnt(5)
    v_mfma_f32_16x16x32_bf16 v[44:47], a[32:35], a[16:19], 0
    ds_read_b64_tr_b16 a[8:9], v7 offset:8256
    v_mfma_f32_16x16x32_bf16 v[52:55], a[32:35], a[20:23], 0
    ds_read_b64_tr_b16 a[10:11], v7 offset:9280
    v_mfma_f32_16x16x32_bf16 v[60:63], a[32:35], a[24:27], 0
    ds_read_b64_tr_b16 a[12:13], v7 offset:8288
    v_mfma_f32_16x16x32_bf16 v[68:71], a[32:35], a[28:31], 0
    ds_read_b64_tr_b16 a[14:15], v7 offset:9312
    ds_read_b128 a[32:35], v5 offset:2048
    v_mfma_f32_16x16x32_bf16 v[48:51], a[36:39], a[16:19], 0
    ds_read_b64_tr_b16 a[16:17], v8 offset:8256
    v_mfma_f32_16x16x32_bf16 v[56:59], a[36:39], a[20:23], 0
    ds_read_b64_tr_b16 a[18:19], v8 offset:9280
    v_mfma_f32_16x16x32_bf16 v[64:67], a[36:39], a[24:27], 0
    ds_read_b64_tr_b16 a[20:21], v8 offset:8288
    v_mfma_f32_16x16x32_bf16 v[72:75], a[36:39], a[28:31], 0
    ds_read_b64_tr_b16 a[22:23], v8 offset:9312
    s_waitcnt lgkmcnt(6)
    v_mfma_f32_16x16x32_bf16 v[12:15], a[40:43], a[0:3], v[12:15]
    ds_read_b64_tr_b16 a[24:25], v9 offset:8256
    v_mfma_f32_16x16x32_bf16 v[20:23], a[40:43], a[4:7], v[20:23]
    ds_read_b64_tr_b16 a[26:27], v9 offset:9280
    v_mfma_f32_16x16x32_bf16 v[28:31], a[40:43], a[8:11], v[28:31]
    ds_read_b64_tr_b16 a[28:29], v9 offset:8288
    s_waitcnt lgkmcnt(5)
    v_mfma_f32_16x16x32_bf16 v[36:39], a[40:43], a[12:15], v[36:39]
    ds_read_b64_tr_b16 a[30:31], v9 offset:9312
    ds_read_b128 a[36:39], v4 offset:16384
    v_mfma_f32_16x16x32_bf16 v[16:19], a[32:35], a[0:3], v[16:19]
    ds_read_b64_tr_b16 a[0:1], v6 offset:16512
    v_mfma_f32_16x16x32_bf16 v[24:27], a[32:35], a[4:7], v[24:27]
    ds_read_b64_tr_b16 a[2:3], v6 offset:17536
    s_waitcnt vmcnt(0)
    v_mfma_f32_16x16x32_bf16 v[32:35], a[32:35], a[8:11], v[32:35]
    ds_read_b64_tr_b16 a[4:5], v6 offset:16544
    v_mov_b32 v108, s16
    v_mfma_f32_16x16x32_bf16 v[40:43], a[32:35], a[12:15], v[40:43]
    ds_read_b64_tr_b16 a[6:7], v6 offset:17568
    v_mov_b32 v109, s17
    v_mfma_f32_16x16x32_bf16 v[44:47], a[40:43], a[16:19], v[44:47]
    ds_read_b64_tr_b16 a[8:9], v7 offset:16512
    buffer_store_dwordx2 v[108:109], off, s[64:67], s31 sc0 sc1
    s_waitcnt lgkmcnt(5)
    v_mfma_f32_16x16x32_bf16 v[52:55], a[40:43], a[20:23], v[52:55]
    s_barrier
    ds_read_b64_tr_b16 a[10:11], v7 offset:17536
    v_mfma_f32_16x16x32_bf16 v[60:63], a[40:43], a[24:27], v[60:63]
    ds_read_b64_tr_b16 a[12:13], v7 offset:16544
    v_mfma_f32_16x16x32_bf16 v[68:71], a[40:43], a[28:31], v[68:71]
    ds_read_b64_tr_b16 a[14:15], v7 offset:17568
    ds_read_b128 a[40:43], v4 offset:18432
    v_mfma_f32_16x16x32_bf16 v[48:51], a[32:35], a[16:19], v[48:51]
    ds_read_b64_tr_b16 a[16:17], v8 offset:16512
    v_mfma_f32_16x16x32_bf16 v[56:59], a[32:35], a[20:23], v[56:59]
    ds_read_b64_tr_b16 a[18:19], v8 offset:17536
    v_mfma_f32_16x16x32_bf16 v[64:67], a[32:35], a[24:27], v[64:67]
    ds_read_b64_tr_b16 a[20:21], v8 offset:16544
    v_mfma_f32_16x16x32_bf16 v[72:75], a[32:35], a[28:31], v[72:75]
    ds_read_b64_tr_b16 a[22:23], v8 offset:17568
    s_waitcnt lgkmcnt(6)
    v_mfma_f32_16x16x32_bf16 v[12:15], a[36:39], a[0:3], v[12:15]
    ds_read_b64_tr_b16 a[24:25], v9 offset:16512
    v_mfma_f32_16x16x32_bf16 v[20:23], a[36:39], a[4:7], v[20:23]
    ds_read_b64_tr_b16 a[26:27], v9 offset:17536
    v_mfma_f32_16x16x32_bf16 v[28:31], a[36:39], a[8:11], v[28:31]
    ds_read_b64_tr_b16 a[28:29], v9 offset:16544
    s_waitcnt lgkmcnt(5)
    v_mfma_f32_16x16x32_bf16 v[36:39], a[36:39], a[12:15], v[36:39]
    ds_read_b64_tr_b16 a[30:31], v9 offset:17568
    ds_read_b128 a[32:35], v5 offset:16384
    v_mfma_f32_16x16x32_bf16 v[16:19], a[40:43], a[0:3], v[16:19]
    ds_read_b64_tr_b16 a[0:1], v6 offset:24768
    v_mfma_f32_16x16x32_bf16 v[24:27], a[40:43], a[4:7], v[24:27]
    ds_read_b64_tr_b16 a[2:3], v6 offset:25792
    v_mfma_f32_16x16x32_bf16 v[32:35], a[40:43], a[8:11], v[32:35]
    ds_read_b64_tr_b16 a[4:5], v6 offset:24800
    v_mfma_f32_16x16x32_bf16 v[40:43], a[40:43], a[12:15], v[40:43]
    ds_read_b64_tr_b16 a[6:7], v6 offset:25824
    v_mfma_f32_16x16x32_bf16 v[44:47], a[36:39], a[16:19], v[44:47]
    ds_read_b64_tr_b16 a[8:9], v7 offset:24768
    s_waitcnt lgkmcnt(5)
    v_mfma_f32_16x16x32_bf16 v[52:55], a[36:39], a[20:23], v[52:55]
    ds_read_b64_tr_b16 a[10:11], v7 offset:25792
    v_mfma_f32_16x16x32_bf16 v[60:63], a[36:39], a[24:27], v[60:63]
    ds_read_b64_tr_b16 a[12:13], v7 offset:24800
    v_mfma_f32_16x16x32_bf16 v[68:71], a[36:39], a[28:31], v[68:71]
    ds_read_b64_tr_b16 a[14:15], v7 offset:25824
    ds_read_b128 a[36:39], v5 offset:18432
    v_mfma_f32_16x16x32_bf16 v[48:51], a[40:43], a[16:19], v[48:51]
    ds_read_b64_tr_b16 a[16:17], v8 offset:24768
    v_mfma_f32_16x16x32_bf16 v[56:59], a[40:43], a[20:23], v[56:59]
    ds_read_b64_tr_b16 a[18:19], v8 offset:25792
    v_mfma_f32_16x16x32_bf16 v[64:67], a[40:43], a[24:27], v[64:67]
    ds_read_b64_tr_b16 a[20:21], v8 offset:24800
    v_mfma_f32_16x16x32_bf16 v[72:75], a[40:43], a[28:31], v[72:75]
    ds_read_b64_tr_b16 a[22:23], v8 offset:25824
    s_waitcnt lgkmcnt(6)
    v_mfma_f32_16x16x32_bf16 v[12:15], a[32:35], a[0:3], v[12:15]
    ds_read_b64_tr_b16 a[24:25], v9 offset:24768
    v_mfma_f32_16x16x32_bf16 v[20:23], a[32:35], a[4:7], v[20:23]
    ds_read_b64_tr_b16 a[26:27], v9 offset:25792
    v_mfma_f32_16x16x32_bf16 v[28:31], a[32:35], a[8:11], v[28:31]
    ds_read_b64_tr_b16 a[28:29], v9 offset:24800
    s_waitcnt lgkmcnt(5)
    v_mfma_f32_16x16x32_bf16 v[36:39], a[32:35], a[12:15], v[36:39]
    ds_read_b64_tr_b16 a[30:31], v9 offset:25824
    ds_read_b128 a[40:43], v4 offset:32768
    v_mfma_f32_16x16x32_bf16 v[16:19], a[36:39], a[0:3], v[16:19]
    ds_read_b64_tr_b16 a[0:1], v6 offset:33024
    v_mfma_f32_16x16x32_bf16 v[24:27], a[36:39], a[4:7], v[24:27]
    ds_read_b64_tr_b16 a[2:3], v6 offset:34048
    v_mfma_f32_16x16x32_bf16 v[32:35], a[36:39], a[8:11], v[32:35]
    ds_read_b64_tr_b16 a[4:5], v6 offset:33056
    v_mfma_f32_16x16x32_bf16 v[40:43], a[36:39], a[12:15], v[40:43]
    ds_read_b64_tr_b16 a[6:7], v6 offset:34080
    v_mfma_f32_16x16x32_bf16 v[44:47], a[32:35], a[16:19], v[44:47]
    ds_read_b64_tr_b16 a[8:9], v7 offset:33024
    s_waitcnt lgkmcnt(5)
    v_mfma_f32_16x16x32_bf16 v[52:55], a[32:35], a[20:23], v[52:55]
    s_barrier
    ds_read_b64_tr_b16 a[10:11], v7 offset:34048
    v_cvt_pk_bf16_f32 v76, v12, v13
    v_mfma_f32_16x16x32_bf16 v[60:63], a[32:35], a[24:27], v[60:63]
    ds_read_b64_tr_b16 a[12:13], v7 offset:33056
    v_cvt_pk_bf16_f32 v77, v14, v15
    v_mfma_f32_16x16x32_bf16 v[68:71], a[32:35], a[28:31], v[68:71]
    ds_read_b64_tr_b16 a[14:15], v7 offset:34080
    ds_read_b128 a[32:35], v4 offset:34816
    v_cvt_pk_bf16_f32 v78, v16, v17
    v_mfma_f32_16x16x32_bf16 v[48:51], a[36:39], a[16:19], v[48:51]
    ds_read_b64_tr_b16 a[16:17], v8 offset:33024
    v_cvt_pk_bf16_f32 v79, v18, v19
    v_mfma_f32_16x16x32_bf16 v[56:59], a[36:39], a[20:23], v[56:59]
    ds_read_b64_tr_b16 a[18:19], v8 offset:34048
    v_cvt_pk_bf16_f32 v80, v20, v21
    v_mfma_f32_16x16x32_bf16 v[64:67], a[36:39], a[24:27], v[64:67]
    ds_read_b64_tr_b16 a[20:21], v8 offset:33056
    v_cvt_pk_bf16_f32 v81, v22, v23
    v_mfma_f32_16x16x32_bf16 v[72:75], a[36:39], a[28:31], v[72:75]
    ds_read_b64_tr_b16 a[22:23], v8 offset:34080
    v_cvt_pk_bf16_f32 v82, v24, v25
    s_waitcnt lgkmcnt(6)
    v_mfma_f32_16x16x32_bf16 v[12:15], a[40:43], a[0:3], 0
    ds_read_b64_tr_b16 a[24:25], v9 offset:33024
    v_cvt_pk_bf16_f32 v83, v26, v27
    v_mfma_f32_16x16x32_bf16 v[20:23], a[40:43], a[4:7], 0
    ds_read_b64_tr_b16 a[26:27], v9 offset:34048
    v_cvt_pk_bf16_f32 v84, v28, v29
    v_cvt_pk_bf16_f32 v85, v30, v31
    v_cvt_pk_bf16_f32 v86, v32, v33
    v_cvt_pk_bf16_f32 v87, v34, v35
    v_mfma_f32_16x16x32_bf16 v[28:31], a[40:43], a[8:11], 0
    ds_read_b64_tr_b16 a[28:29], v9 offset:33056
    v_cvt_pk_bf16_f32 v88, v36, v37
    v_cvt_pk_bf16_f32 v89, v38, v39
    v_cvt_pk_bf16_f32 v90, v40, v41
    v_cvt_pk_bf16_f32 v91, v42, v43
    s_waitcnt lgkmcnt(5)
    v_mfma_f32_16x16x32_bf16 v[36:39], a[40:43], a[12:15], 0
    ds_read_b64_tr_b16 a[30:31], v9 offset:34080
    ds_read_b128 a[36:39], v5 offset:32768
    v_cvt_pk_bf16_f32 v92, v44, v45
    v_mfma_f32_16x16x32_bf16 v[16:19], a[32:35], a[0:3], 0
    ds_read_b64_tr_b16 a[0:1], v6 offset:41280
    v_cvt_pk_bf16_f32 v93, v46, v47
    v_mfma_f32_16x16x32_bf16 v[24:27], a[32:35], a[4:7], 0
    ds_read_b64_tr_b16 a[2:3], v6 offset:42304
    v_cvt_pk_bf16_f32 v94, v48, v49
    v_mfma_f32_16x16x32_bf16 v[32:35], a[32:35], a[8:11], 0
    ds_read_b64_tr_b16 a[4:5], v6 offset:41312
    v_cvt_pk_bf16_f32 v95, v50, v51
    v_mfma_f32_16x16x32_bf16 v[40:43], a[32:35], a[12:15], 0
    ds_read_b64_tr_b16 a[6:7], v6 offset:42336
    v_cvt_pk_bf16_f32 v96, v52, v53
    v_mfma_f32_16x16x32_bf16 v[44:47], a[40:43], a[16:19], 0
    ds_read_b64_tr_b16 a[8:9], v7 offset:41280
    v_cvt_pk_bf16_f32 v97, v54, v55
    v_cvt_pk_bf16_f32 v98, v56, v57
    v_cvt_pk_bf16_f32 v99, v58, v59
    s_waitcnt lgkmcnt(5)
    v_mfma_f32_16x16x32_bf16 v[52:55], a[40:43], a[20:23], 0
    ds_read_b64_tr_b16 a[10:11], v7 offset:42304
    v_cvt_pk_bf16_f32 v100, v60, v61
    v_cvt_pk_bf16_f32 v101, v62, v63
    v_cvt_pk_bf16_f32 v102, v64, v65
    v_cvt_pk_bf16_f32 v103, v66, v67
    v_mfma_f32_16x16x32_bf16 v[60:63], a[40:43], a[24:27], 0
    ds_read_b64_tr_b16 a[12:13], v7 offset:41312
    v_cvt_pk_bf16_f32 v104, v68, v69
    v_cvt_pk_bf16_f32 v105, v70, v71
    v_cvt_pk_bf16_f32 v106, v72, v73
    v_cvt_pk_bf16_f32 v107, v74, v75
    v_mfma_f32_16x16x32_bf16 v[68:71], a[40:43], a[28:31], 0
    ds_read_b64_tr_b16 a[14:15], v7 offset:42336
    ds_read_b128 a[40:43], v5 offset:34816
    v_mfma_f32_16x16x32_bf16 v[48:51], a[32:35], a[16:19], 0
    ds_read_b64_tr_b16 a[16:17], v8 offset:41280
    v_mfma_f32_16x16x32_bf16 v[56:59], a[32:35], a[20:23], 0
    ds_read_b64_tr_b16 a[18:19], v8 offset:42304
    v_mfma_f32_16x16x32_bf16 v[64:67], a[32:35], a[24:27], 0
    ds_read_b64_tr_b16 a[20:21], v8 offset:41312
    v_mfma_f32_16x16x32_bf16 v[72:75], a[32:35], a[28:31], 0
    ds_read_b64_tr_b16 a[22:23], v8 offset:42336
    s_waitcnt lgkmcnt(6)
    v_mfma_f32_16x16x32_bf16 v[12:15], a[36:39], a[0:3], v[12:15]
    ds_read_b64_tr_b16 a[24:25], v9 offset:41280
    v_mfma_f32_16x16x32_bf16 v[20:23], a[36:39], a[4:7], v[20:23]
    ds_read_b64_tr_b16 a[26:27], v9 offset:42304
    v_mfma_f32_16x16x32_bf16 v[28:31], a[36:39], a[8:11], v[28:31]
    ds_read_b64_tr_b16 a[28:29], v9 offset:41312
    s_waitcnt lgkmcnt(5)
    v_mfma_f32_16x16x32_bf16 v[36:39], a[36:39], a[12:15], v[36:39]
    ds_read_b64_tr_b16 a[30:31], v9 offset:42336
    v_mfma_f32_16x16x32_bf16 v[16:19], a[40:43], a[0:3], v[16:19]
    v_mfma_f32_16x16x32_bf16 v[24:27], a[40:43], a[4:7], v[24:27]
    v_mfma_f32_16x16x32_bf16 v[32:35], a[40:43], a[8:11], v[32:35]
    v_mfma_f32_16x16x32_bf16 v[40:43], a[40:43], a[12:15], v[40:43]
    v_mfma_f32_16x16x32_bf16 v[44:47], a[36:39], a[16:19], v[44:47]
    s_waitcnt lgkmcnt(0)
    v_mfma_f32_16x16x32_bf16 v[52:55], a[36:39], a[20:23], v[52:55]
    s_barrier
    v_mfma_f32_16x16x32_bf16 v[60:63], a[36:39], a[24:27], v[60:63]
    v_mfma_f32_16x16x32_bf16 v[68:71], a[36:39], a[28:31], v[68:71]
    v_mfma_f32_16x16x32_bf16 v[48:51], a[40:43], a[16:19], v[48:51]
    v_mfma_f32_16x16x32_bf16 v[56:59], a[40:43], a[20:23], v[56:59]
    v_mfma_f32_16x16x32_bf16 v[64:67], a[40:43], a[24:27], v[64:67]
    v_mfma_f32_16x16x32_bf16 v[72:75], a[40:43], a[28:31], v[72:75]
    v_mfma_f32_16x16x32_bf16 a[68:71], v[84:87], v[124:127], 0
    v_mfma_f32_16x16x32_bf16 a[72:75], v[84:87], v[128:131], 0
    v_mfma_f32_16x16x32_bf16 a[76:79], v[88:91], v[124:127], 0
    v_mfma_f32_16x16x32_bf16 a[80:83], v[88:91], v[128:131], 0
    ds_read_b128 a[32:35], v4 offset:49152
    v_mfma_f32_16x16x32_bf16 a[84:87], v[92:95], v[124:127], 0
    ds_read_b64_tr_b16 a[0:1], v6 offset:49536
    v_mfma_f32_16x16x32_bf16 a[88:91], v[92:95], v[128:131], 0
    ds_read_b64_tr_b16 a[2:3], v6 offset:50560
    v_mfma_f32_16x16x32_bf16 a[92:95], v[96:99], v[124:127], 0
    ds_read_b64_tr_b16 a[4:5], v6 offset:49568
    v_mfma_f32_16x16x32_bf16 a[96:99], v[96:99], v[128:131], 0
    ds_read_b64_tr_b16 a[6:7], v6 offset:50592
    v_mfma_f32_16x16x32_bf16 a[100:103], v[100:103], v[124:127], 0
    ds_read_b64_tr_b16 a[8:9], v7 offset:49536
    v_mfma_f32_16x16x32_bf16 a[104:107], v[100:103], v[128:131], 0
    ds_read_b64_tr_b16 a[10:11], v7 offset:50560
    v_mfma_f32_16x16x32_bf16 a[108:111], v[104:107], v[124:127], 0
    ds_read_b64_tr_b16 a[12:13], v7 offset:49568
    v_mfma_f32_16x16x32_bf16 a[112:115], v[104:107], v[128:131], 0
    ds_read_b64_tr_b16 a[14:15], v7 offset:50592
    ds_read_b128 a[36:39], v4 offset:51200
    v_mfma_f32_16x16x32_bf16 a[52:55], v[76:79], v[124:127], 0
    ds_read_b64_tr_b16 a[16:17], v8 offset:49536
    v_mfma_f32_16x16x32_bf16 a[56:59], v[76:79], v[128:131], 0
    ds_read_b64_tr_b16 a[18:19], v8 offset:50560
    v_mfma_f32_16x16x32_bf16 a[60:63], v[80:83], v[124:127], 0
    ds_read_b64_tr_b16 a[20:21], v8 offset:49568
    v_mfma_f32_16x16x32_bf16 a[64:67], v[80:83], v[128:131], 0
    ds_read_b64_tr_b16 a[22:23], v8 offset:50592
    s_waitcnt lgkmcnt(6)
    v_mfma_f32_16x16x32_bf16 v[12:15], a[32:35], a[0:3], v[12:15]
    ds_read_b64_tr_b16 a[24:25], v9 offset:49536
    v_mfma_f32_16x16x32_bf16 v[20:23], a[32:35], a[4:7], v[20:23]
    ds_read_b64_tr_b16 a[26:27], v9 offset:50560
    v_mfma_f32_16x16x32_bf16 v[28:31], a[32:35], a[8:11], v[28:31]
    ds_read_b64_tr_b16 a[28:29], v9 offset:49568
    s_waitcnt lgkmcnt(5)
    v_mfma_f32_16x16x32_bf16 v[36:39], a[32:35], a[12:15], v[36:39]
    ds_read_b64_tr_b16 a[30:31], v9 offset:50592
    ds_read_b128 a[40:43], v5 offset:49152
    v_mfma_f32_16x16x32_bf16 v[16:19], a[36:39], a[0:3], v[16:19]
    ds_read_b64_tr_b16 a[0:1], v6 offset:57792
    v_mfma_f32_16x16x32_bf16 v[24:27], a[36:39], a[4:7], v[24:27]
    ds_read_b64_tr_b16 a[2:3], v6 offset:58816
    v_mfma_f32_16x16x32_bf16 v[32:35], a[36:39], a[8:11], v[32:35]
    ds_read_b64_tr_b16 a[4:5], v6 offset:57824
    v_mfma_f32_16x16x32_bf16 v[40:43], a[36:39], a[12:15], v[40:43]
    ds_read_b64_tr_b16 a[6:7], v6 offset:58848
    v_mfma_f32_16x16x32_bf16 v[44:47], a[32:35], a[16:19], v[44:47]
    ds_read_b64_tr_b16 a[8:9], v7 offset:57792
    s_waitcnt lgkmcnt(5)
    v_mfma_f32_16x16x32_bf16 v[52:55], a[32:35], a[20:23], v[52:55]
    ds_read_b64_tr_b16 a[10:11], v7 offset:58816
    v_mfma_f32_16x16x32_bf16 v[60:63], a[32:35], a[24:27], v[60:63]
    ds_read_b64_tr_b16 a[12:13], v7 offset:57824
    v_mfma_f32_16x16x32_bf16 v[68:71], a[32:35], a[28:31], v[68:71]
    ds_read_b64_tr_b16 a[14:15], v7 offset:58848
    ds_read_b128 a[32:35], v5 offset:51200
    v_mfma_f32_16x16x32_bf16 v[48:51], a[36:39], a[16:19], v[48:51]
    ds_read_b64_tr_b16 a[16:17], v8 offset:57792
    v_mfma_f32_16x16x32_bf16 v[56:59], a[36:39], a[20:23], v[56:59]
    ds_read_b64_tr_b16 a[18:19], v8 offset:58816
    v_mfma_f32_16x16x32_bf16 v[64:67], a[36:39], a[24:27], v[64:67]
    ds_read_b64_tr_b16 a[20:21], v8 offset:57824
    v_mfma_f32_16x16x32_bf16 v[72:75], a[36:39], a[28:31], v[72:75]
    ds_read_b64_tr_b16 a[22:23], v8 offset:58848
    s_waitcnt lgkmcnt(6)
    v_mfma_f32_16x16x32_bf16 v[12:15], a[40:43], a[0:3], v[12:15]
    ds_read_b64_tr_b16 a[24:25], v9 offset:57792
    v_mfma_f32_16x16x32_bf16 v[20:23], a[40:43], a[4:7], v[20:23]
    ds_read_b64_tr_b16 a[26:27], v9 offset:58816
    v_mfma_f32_16x16x32_bf16 v[28:31], a[40:43], a[8:11], v[28:31]
    ds_read_b64_tr_b16 a[28:29], v9 offset:57824
    s_waitcnt lgkmcnt(5)
    v_mfma_f32_16x16x32_bf16 v[36:39], a[40:43], a[12:15], v[36:39]
    ds_read_b64_tr_b16 a[30:31], v9 offset:58848
    ds_read_b128 a[36:39], v4 offset:0
    v_mfma_f32_16x16x32_bf16 v[16:19], a[32:35], a[0:3], v[16:19]
    ds_read_b64_tr_b16 a[0:1], v6 offset:0
    v_mfma_f32_16x16x32_bf16 v[24:27], a[32:35], a[4:7], v[24:27]
    ds_read_b64_tr_b16 a[2:3], v6 offset:1024
    v_mfma_f32_16x16x32_bf16 v[32:35], a[32:35], a[8:11], v[32:35]
    ds_read_b64_tr_b16 a[4:5], v6 offset:32
    v_mfma_f32_16x16x32_bf16 v[40:43], a[32:35], a[12:15], v[40:43]
    ds_read_b64_tr_b16 a[6:7], v6 offset:1056
    v_mfma_f32_16x16x32_bf16 v[44:47], a[40:43], a[16:19], v[44:47]
    ds_read_b64_tr_b16 a[8:9], v7 offset:0
    s_waitcnt lgkmcnt(5)
    v_mfma_f32_16x16x32_bf16 v[52:55], a[40:43], a[20:23], v[52:55]
    s_barrier
    ds_read_b64_tr_b16 a[10:11], v7 offset:1024
    v_cvt_pk_bf16_f32 v108, v12, v13
    v_mfma_f32_16x16x32_bf16 v[60:63], a[40:43], a[24:27], v[60:63]
    ds_read_b64_tr_b16 a[12:13], v7 offset:32
    v_cvt_pk_bf16_f32 v109, v14, v15
    v_mfma_f32_16x16x32_bf16 v[68:71], a[40:43], a[28:31], v[68:71]
    ds_read_b64_tr_b16 a[14:15], v7 offset:1056
    ds_read_b128 a[40:43], v4 offset:2048
    v_cvt_pk_bf16_f32 v110, v16, v17
    v_mfma_f32_16x16x32_bf16 v[48:51], a[32:35], a[16:19], v[48:51]
    ds_read_b64_tr_b16 a[16:17], v8 offset:0
    v_cvt_pk_bf16_f32 v111, v18, v19
    v_mfma_f32_16x16x32_bf16 v[56:59], a[32:35], a[20:23], v[56:59]
    ds_read_b64_tr_b16 a[18:19], v8 offset:1024
    v_cvt_pk_bf16_f32 v112, v20, v21
    v_mfma_f32_16x16x32_bf16 v[64:67], a[32:35], a[24:27], v[64:67]
    ds_read_b64_tr_b16 a[20:21], v8 offset:32
    v_cvt_pk_bf16_f32 v113, v22, v23
    v_mfma_f32_16x16x32_bf16 v[72:75], a[32:35], a[28:31], v[72:75]
    ds_read_b64_tr_b16 a[22:23], v8 offset:1056
    v_cvt_pk_bf16_f32 v114, v24, v25
    s_waitcnt lgkmcnt(6)
    v_mfma_f32_16x16x32_bf16 v[12:15], a[36:39], a[0:3], 0
    ds_read_b64_tr_b16 a[24:25], v9 offset:0
    v_cvt_pk_bf16_f32 v115, v26, v27
    v_mfma_f32_16x16x32_bf16 v[20:23], a[36:39], a[4:7], 0
    ds_read_b64_tr_b16 a[26:27], v9 offset:1024
    v_cvt_pk_bf16_f32 v116, v28, v29
    v_cvt_pk_bf16_f32 v117, v30, v31
    v_cvt_pk_bf16_f32 v118, v32, v33
    v_cvt_pk_bf16_f32 v119, v34, v35
    v_mfma_f32_16x16x32_bf16 v[28:31], a[36:39], a[8:11], 0
    ds_read_b64_tr_b16 a[28:29], v9 offset:32
    v_cvt_pk_bf16_f32 v120, v36, v37
    v_cvt_pk_bf16_f32 v121, v38, v39
    v_cvt_pk_bf16_f32 v122, v40, v41
    v_cvt_pk_bf16_f32 v123, v42, v43
    s_waitcnt lgkmcnt(5)
    v_mfma_f32_16x16x32_bf16 v[36:39], a[36:39], a[12:15], 0
    ds_read_b64_tr_b16 a[30:31], v9 offset:1056
    ds_read_b128 a[32:35], v5 offset:0
    v_cvt_pk_bf16_f32 v124, v44, v45
    v_mfma_f32_16x16x32_bf16 v[16:19], a[40:43], a[0:3], 0
    ds_read_b64_tr_b16 a[0:1], v6 offset:8256
    v_cvt_pk_bf16_f32 v125, v46, v47
    v_mfma_f32_16x16x32_bf16 v[24:27], a[40:43], a[4:7], 0
    ds_read_b64_tr_b16 a[2:3], v6 offset:9280
    v_cvt_pk_bf16_f32 v126, v48, v49
    v_mfma_f32_16x16x32_bf16 v[32:35], a[40:43], a[8:11], 0
    ds_read_b64_tr_b16 a[4:5], v6 offset:8288
    v_cvt_pk_bf16_f32 v127, v50, v51
    v_mfma_f32_16x16x32_bf16 v[40:43], a[40:43], a[12:15], 0
    ds_read_b64_tr_b16 a[6:7], v6 offset:9312
    v_cvt_pk_bf16_f32 v128, v52, v53
    v_mfma_f32_16x16x32_bf16 v[44:47], a[36:39], a[16:19], 0
    ds_read_b64_tr_b16 a[8:9], v7 offset:8256
    v_cvt_pk_bf16_f32 v129, v54, v55
    v_cvt_pk_bf16_f32 v130, v56, v57
    v_cvt_pk_bf16_f32 v131, v58, v59
    s_waitcnt lgkmcnt(5)
    v_mfma_f32_16x16x32_bf16 v[52:55], a[36:39], a[20:23], 0
    ds_read_b64_tr_b16 a[10:11], v7 offset:9280
    v_cvt_pk_bf16_f32 v132, v60, v61
    v_cvt_pk_bf16_f32 v133, v62, v63
    v_cvt_pk_bf16_f32 v134, v64, v65
    v_cvt_pk_bf16_f32 v135, v66, v67
    v_mfma_f32_16x16x32_bf16 v[60:63], a[36:39], a[24:27], 0
    ds_read_b64_tr_b16 a[12:13], v7 offset:8288
    v_cvt_pk_bf16_f32 v136, v68, v69
    v_cvt_pk_bf16_f32 v137, v70, v71
    v_cvt_pk_bf16_f32 v138, v72, v73
    v_cvt_pk_bf16_f32 v139, v74, v75
    v_mfma_f32_16x16x32_bf16 v[68:71], a[36:39], a[28:31], 0
    ds_read_b64_tr_b16 a[14:15], v7 offset:9312
    ds_read_b128 a[36:39], v5 offset:2048
    v_mfma_f32_16x16x32_bf16 v[48:51], a[40:43], a[16:19], 0
    ds_read_b64_tr_b16 a[16:17], v8 offset:8256
    v_mfma_f32_16x16x32_bf16 v[56:59], a[40:43], a[20:23], 0
    ds_read_b64_tr_b16 a[18:19], v8 offset:9280
    v_mfma_f32_16x16x32_bf16 v[64:67], a[40:43], a[24:27], 0
    ds_read_b64_tr_b16 a[20:21], v8 offset:8288
    v_mfma_f32_16x16x32_bf16 v[72:75], a[40:43], a[28:31], 0
    ds_read_b64_tr_b16 a[22:23], v8 offset:9312
    s_waitcnt lgkmcnt(6)
    v_mfma_f32_16x16x32_bf16 v[12:15], a[32:35], a[0:3], v[12:15]
    ds_read_b64_tr_b16 a[24:25], v9 offset:8256
    v_mfma_f32_16x16x32_bf16 v[20:23], a[32:35], a[4:7], v[20:23]
    ds_read_b64_tr_b16 a[26:27], v9 offset:9280
    v_mfma_f32_16x16x32_bf16 v[28:31], a[32:35], a[8:11], v[28:31]
    ds_read_b64_tr_b16 a[28:29], v9 offset:8288
    s_waitcnt lgkmcnt(5)
    v_mfma_f32_16x16x32_bf16 v[36:39], a[32:35], a[12:15], v[36:39]
    ds_read_b64_tr_b16 a[30:31], v9 offset:9312
    ds_read_b128 a[40:43], v4 offset:16384
    v_mfma_f32_16x16x32_bf16 v[16:19], a[36:39], a[0:3], v[16:19]
    ds_read_b64_tr_b16 a[0:1], v6 offset:16512
    v_mfma_f32_16x16x32_bf16 v[24:27], a[36:39], a[4:7], v[24:27]
    ds_read_b64_tr_b16 a[2:3], v6 offset:17536
    v_mfma_f32_16x16x32_bf16 v[32:35], a[36:39], a[8:11], v[32:35]
    ds_read_b64_tr_b16 a[4:5], v6 offset:16544
    v_mfma_f32_16x16x32_bf16 v[40:43], a[36:39], a[12:15], v[40:43]
    ds_read_b64_tr_b16 a[6:7], v6 offset:17568
    v_mfma_f32_16x16x32_bf16 v[44:47], a[32:35], a[16:19], v[44:47]
    ds_read_b64_tr_b16 a[8:9], v7 offset:16512
    s_waitcnt lgkmcnt(5)
    v_mfma_f32_16x16x32_bf16 v[52:55], a[32:35], a[20:23], v[52:55]
    s_barrier
    ds_read_b64_tr_b16 a[10:11], v7 offset:17536
    v_mfma_f32_16x16x32_bf16 v[60:63], a[32:35], a[24:27], v[60:63]
    ds_read_b64_tr_b16 a[12:13], v7 offset:16544
    v_mfma_f32_16x16x32_bf16 v[68:71], a[32:35], a[28:31], v[68:71]
    ds_read_b64_tr_b16 a[14:15], v7 offset:17568
    ds_read_b128 a[32:35], v4 offset:18432
    v_mfma_f32_16x16x32_bf16 v[48:51], a[36:39], a[16:19], v[48:51]
    ds_read_b64_tr_b16 a[16:17], v8 offset:16512
    v_mfma_f32_16x16x32_bf16 v[56:59], a[36:39], a[20:23], v[56:59]
    ds_read_b64_tr_b16 a[18:19], v8 offset:17536
    v_mfma_f32_16x16x32_bf16 v[64:67], a[36:39], a[24:27], v[64:67]
    ds_read_b64_tr_b16 a[20:21], v8 offset:16544
    v_mfma_f32_16x16x32_bf16 v[72:75], a[36:39], a[28:31], v[72:75]
    ds_read_b64_tr_b16 a[22:23], v8 offset:17568
    s_waitcnt lgkmcnt(6)
    v_mfma_f32_16x16x32_bf16 v[12:15], a[40:43], a[0:3], v[12:15]
    ds_read_b64_tr_b16 a[24:25], v9 offset:16512
    v_mfma_f32_16x16x32_bf16 v[20:23], a[40:43], a[4:7], v[20:23]
    ds_read_b64_tr_b16 a[26:27], v9 offset:17536
    v_mfma_f32_16x16x32_bf16 v[28:31], a[40:43], a[8:11], v[28:31]
    ds_read_b64_tr_b16 a[28:29], v9 offset:16544
    s_waitcnt lgkmcnt(5)
    v_mfma_f32_16x16x32_bf16 v[36:39], a[40:43], a[12:15], v[36:39]
    ds_read_b64_tr_b16 a[30:31], v9 offset:17568
    ds_read_b128 a[36:39], v5 offset:16384
    v_mfma_f32_16x16x32_bf16 v[16:19], a[32:35], a[0:3], v[16:19]
    ds_read_b64_tr_b16 a[0:1], v6 offset:24768
    v_mfma_f32_16x16x32_bf16 v[24:27], a[32:35], a[4:7], v[24:27]
    ds_read_b64_tr_b16 a[2:3], v6 offset:25792
    v_mfma_f32_16x16x32_bf16 v[32:35], a[32:35], a[8:11], v[32:35]
    ds_read_b64_tr_b16 a[4:5], v6 offset:24800
    v_mfma_f32_16x16x32_bf16 v[40:43], a[32:35], a[12:15], v[40:43]
    ds_read_b64_tr_b16 a[6:7], v6 offset:25824
    v_mfma_f32_16x16x32_bf16 v[44:47], a[40:43], a[16:19], v[44:47]
    ds_read_b64_tr_b16 a[8:9], v7 offset:24768
    s_waitcnt lgkmcnt(5)
    v_mfma_f32_16x16x32_bf16 v[52:55], a[40:43], a[20:23], v[52:55]
    ds_read_b64_tr_b16 a[10:11], v7 offset:25792
    v_mfma_f32_16x16x32_bf16 v[60:63], a[40:43], a[24:27], v[60:63]
    ds_read_b64_tr_b16 a[12:13], v7 offset:24800
    v_mfma_f32_16x16x32_bf16 v[68:71], a[40:43], a[28:31], v[68:71]
    ds_read_b64_tr_b16 a[14:15], v7 offset:25824
    ds_read_b128 a[40:43], v5 offset:18432
    v_mfma_f32_16x16x32_bf16 v[48:51], a[32:35], a[16:19], v[48:51]
    ds_read_b64_tr_b16 a[16:17], v8 offset:24768
    v_mfma_f32_16x16x32_bf16 v[56:59], a[32:35], a[20:23], v[56:59]
    ds_read_b64_tr_b16 a[18:19], v8 offset:25792
    v_mfma_f32_16x16x32_bf16 v[64:67], a[32:35], a[24:27], v[64:67]
    ds_read_b64_tr_b16 a[20:21], v8 offset:24800
    v_mfma_f32_16x16x32_bf16 v[72:75], a[32:35], a[28:31], v[72:75]
    ds_read_b64_tr_b16 a[22:23], v8 offset:25824
    s_waitcnt lgkmcnt(6)
    v_mfma_f32_16x16x32_bf16 v[12:15], a[36:39], a[0:3], v[12:15]
    ds_read_b64_tr_b16 a[24:25], v9 offset:24768
    v_mfma_f32_16x16x32_bf16 v[20:23], a[36:39], a[4:7], v[20:23]
    ds_read_b64_tr_b16 a[26:27], v9 offset:25792
    v_mfma_f32_16x16x32_bf16 v[28:31], a[36:39], a[8:11], v[28:31]
    ds_read_b64_tr_b16 a[28:29], v9 offset:24800
    s_waitcnt lgkmcnt(5)
    v_mfma_f32_16x16x32_bf16 v[36:39], a[36:39], a[12:15], v[36:39]
    ds_read_b64_tr_b16 a[30:31], v9 offset:25824
    ds_read_b128 a[32:35], v4 offset:32768
    v_mfma_f32_16x16x32_bf16 v[16:19], a[40:43], a[0:3], v[16:19]
    ds_read_b64_tr_b16 a[0:1], v6 offset:33024
    v_mfma_f32_16x16x32_bf16 v[24:27], a[40:43], a[4:7], v[24:27]
    ds_read_b64_tr_b16 a[2:3], v6 offset:34048
    v_mfma_f32_16x16x32_bf16 v[32:35], a[40:43], a[8:11], v[32:35]
    ds_read_b64_tr_b16 a[4:5], v6 offset:33056
    v_mfma_f32_16x16x32_bf16 v[40:43], a[40:43], a[12:15], v[40:43]
    ds_read_b64_tr_b16 a[6:7], v6 offset:34080
    v_mfma_f32_16x16x32_bf16 v[44:47], a[36:39], a[16:19], v[44:47]
    ds_read_b64_tr_b16 a[8:9], v7 offset:33024
    s_waitcnt lgkmcnt(5)
    v_mfma_f32_16x16x32_bf16 v[52:55], a[36:39], a[20:23], v[52:55]
    s_barrier
    ds_read_b64_tr_b16 a[10:11], v7 offset:34048
    v_cvt_pk_bf16_f32 v76, v12, v13
    v_mfma_f32_16x16x32_bf16 v[60:63], a[36:39], a[24:27], v[60:63]
    ds_read_b64_tr_b16 a[12:13], v7 offset:33056
    v_cvt_pk_bf16_f32 v77, v14, v15
    v_mfma_f32_16x16x32_bf16 v[68:71], a[36:39], a[28:31], v[68:71]
    ds_read_b64_tr_b16 a[14:15], v7 offset:34080
    ds_read_b128 a[36:39], v4 offset:34816
    v_cvt_pk_bf16_f32 v78, v16, v17
    v_mfma_f32_16x16x32_bf16 v[48:51], a[40:43], a[16:19], v[48:51]
    ds_read_b64_tr_b16 a[16:17], v8 offset:33024
    v_cvt_pk_bf16_f32 v79, v18, v19
    v_mfma_f32_16x16x32_bf16 v[56:59], a[40:43], a[20:23], v[56:59]
    ds_read_b64_tr_b16 a[18:19], v8 offset:34048
    v_cvt_pk_bf16_f32 v80, v20, v21
    v_mfma_f32_16x16x32_bf16 v[64:67], a[40:43], a[24:27], v[64:67]
    ds_read_b64_tr_b16 a[20:21], v8 offset:33056
    v_cvt_pk_bf16_f32 v81, v22, v23
    v_mfma_f32_16x16x32_bf16 v[72:75], a[40:43], a[28:31], v[72:75]
    ds_read_b64_tr_b16 a[22:23], v8 offset:34080
    v_cvt_pk_bf16_f32 v82, v24, v25
    s_waitcnt lgkmcnt(6)
    v_mfma_f32_16x16x32_bf16 v[12:15], a[32:35], a[0:3], 0
    ds_read_b64_tr_b16 a[24:25], v9 offset:33024
    v_cvt_pk_bf16_f32 v83, v26, v27
    v_mfma_f32_16x16x32_bf16 v[20:23], a[32:35], a[4:7], 0
    ds_read_b64_tr_b16 a[26:27], v9 offset:34048
    v_cvt_pk_bf16_f32 v84, v28, v29
    v_cvt_pk_bf16_f32 v85, v30, v31
    v_cvt_pk_bf16_f32 v86, v32, v33
    v_cvt_pk_bf16_f32 v87, v34, v35
    v_mfma_f32_16x16x32_bf16 v[28:31], a[32:35], a[8:11], 0
    ds_read_b64_tr_b16 a[28:29], v9 offset:33056
    v_cvt_pk_bf16_f32 v88, v36, v37
    v_cvt_pk_bf16_f32 v89, v38, v39
    v_cvt_pk_bf16_f32 v90, v40, v41
    v_cvt_pk_bf16_f32 v91, v42, v43
    s_waitcnt lgkmcnt(5)
    v_mfma_f32_16x16x32_bf16 v[36:39], a[32:35], a[12:15], 0
    ds_read_b64_tr_b16 a[30:31], v9 offset:34080
    ds_read_b128 a[40:43], v5 offset:32768
    v_cvt_pk_bf16_f32 v92, v44, v45
    v_mfma_f32_16x16x32_bf16 v[16:19], a[36:39], a[0:3], 0
    ds_read_b64_tr_b16 a[0:1], v6 offset:41280
    v_cvt_pk_bf16_f32 v93, v46, v47
    v_mfma_f32_16x16x32_bf16 v[24:27], a[36:39], a[4:7], 0
    ds_read_b64_tr_b16 a[2:3], v6 offset:42304
    v_cvt_pk_bf16_f32 v94, v48, v49
    v_mfma_f32_16x16x32_bf16 v[32:35], a[36:39], a[8:11], 0
    ds_read_b64_tr_b16 a[4:5], v6 offset:41312
    v_cvt_pk_bf16_f32 v95, v50, v51
    v_mfma_f32_16x16x32_bf16 v[40:43], a[36:39], a[12:15], 0
    ds_read_b64_tr_b16 a[6:7], v6 offset:42336
    v_cvt_pk_bf16_f32 v96, v52, v53
    v_mfma_f32_16x16x32_bf16 v[44:47], a[32:35], a[16:19], 0
    ds_read_b64_tr_b16 a[8:9], v7 offset:41280
    v_cvt_pk_bf16_f32 v97, v54, v55
    v_cvt_pk_bf16_f32 v98, v56, v57
    v_cvt_pk_bf16_f32 v99, v58, v59
    s_waitcnt lgkmcnt(5)
    v_mfma_f32_16x16x32_bf16 v[52:55], a[32:35], a[20:23], 0
    ds_read_b64_tr_b16 a[10:11], v7 offset:42304
    v_cvt_pk_bf16_f32 v100, v60, v61
    v_cvt_pk_bf16_f32 v101, v62, v63
    v_cvt_pk_bf16_f32 v102, v64, v65
    v_cvt_pk_bf16_f32 v103, v66, v67
    v_mfma_f32_16x16x32_bf16 v[60:63], a[32:35], a[24:27], 0
    ds_read_b64_tr_b16 a[12:13], v7 offset:41312
    v_cvt_pk_bf16_f32 v104, v68, v69
    v_cvt_pk_bf16_f32 v105, v70, v71
    v_cvt_pk_bf16_f32 v106, v72, v73
    v_cvt_pk_bf16_f32 v107, v74, v75
    v_mfma_f32_16x16x32_bf16 v[68:71], a[32:35], a[28:31], 0
    ds_read_b64_tr_b16 a[14:15], v7 offset:42336
    ds_read_b128 a[32:35], v5 offset:34816
    v_mfma_f32_16x16x32_bf16 v[48:51], a[36:39], a[16:19], 0
    ds_read_b64_tr_b16 a[16:17], v8 offset:41280
    v_mfma_f32_16x16x32_bf16 v[56:59], a[36:39], a[20:23], 0
    ds_read_b64_tr_b16 a[18:19], v8 offset:42304
    v_mfma_f32_16x16x32_bf16 v[64:67], a[36:39], a[24:27], 0
    ds_read_b64_tr_b16 a[20:21], v8 offset:41312
    v_mfma_f32_16x16x32_bf16 v[72:75], a[36:39], a[28:31], 0
    ds_read_b64_tr_b16 a[22:23], v8 offset:42336
    s_waitcnt lgkmcnt(6)
    v_mfma_f32_16x16x32_bf16 v[12:15], a[40:43], a[0:3], v[12:15]
    ds_read_b64_tr_b16 a[24:25], v9 offset:41280
    v_mfma_f32_16x16x32_bf16 v[20:23], a[40:43], a[4:7], v[20:23]
    ds_read_b64_tr_b16 a[26:27], v9 offset:42304
    v_mfma_f32_16x16x32_bf16 v[28:31], a[40:43], a[8:11], v[28:31]
    ds_read_b64_tr_b16 a[28:29], v9 offset:41312
    s_waitcnt lgkmcnt(5)
    v_mfma_f32_16x16x32_bf16 v[36:39], a[40:43], a[12:15], v[36:39]
    ds_read_b64_tr_b16 a[30:31], v9 offset:42336
    v_mfma_f32_16x16x32_bf16 v[16:19], a[32:35], a[0:3], v[16:19]
    v_mfma_f32_16x16x32_bf16 v[24:27], a[32:35], a[4:7], v[24:27]
    v_mfma_f32_16x16x32_bf16 v[32:35], a[32:35], a[8:11], v[32:35]
    v_mfma_f32_16x16x32_bf16 v[40:43], a[32:35], a[12:15], v[40:43]
    v_mfma_f32_16x16x32_bf16 v[44:47], a[40:43], a[16:19], v[44:47]
    s_waitcnt lgkmcnt(0)
    v_mfma_f32_16x16x32_bf16 v[52:55], a[40:43], a[20:23], v[52:55]
    s_barrier
    ds_read_b128 a[44:47], v11 offset:0
    ds_read_b128 a[48:51], v11 offset:1024
    v_mfma_f32_16x16x32_bf16 v[60:63], a[40:43], a[24:27], v[60:63]
    v_mfma_f32_16x16x32_bf16 v[68:71], a[40:43], a[28:31], v[68:71]
    v_mfma_f32_16x16x32_bf16 v[48:51], a[32:35], a[16:19], v[48:51]
    v_mfma_f32_16x16x32_bf16 v[56:59], a[32:35], a[20:23], v[56:59]
    v_mfma_f32_16x16x32_bf16 v[64:67], a[32:35], a[24:27], v[64:67]
    v_mfma_f32_16x16x32_bf16 v[72:75], a[32:35], a[28:31], v[72:75]
    s_waitcnt lgkmcnt(0)
    v_mfma_f32_16x16x32_bf16 a[68:71], v[116:119], a[44:47], a[68:71]
    v_mfma_f32_16x16x32_bf16 a[72:75], v[116:119], a[48:51], a[72:75]
    v_mfma_f32_16x16x32_bf16 a[76:79], v[120:123], a[44:47], a[76:79]
    v_mfma_f32_16x16x32_bf16 a[80:83], v[120:123], a[48:51], a[80:83]
    ds_read_b128 a[36:39], v4 offset:49152
    v_mfma_f32_16x16x32_bf16 a[84:87], v[124:127], a[44:47], a[84:87]
    ds_read_b64_tr_b16 a[0:1], v6 offset:49536
    v_mfma_f32_16x16x32_bf16 a[88:91], v[124:127], a[48:51], a[88:91]
    ds_read_b64_tr_b16 a[2:3], v6 offset:50560
    v_mfma_f32_16x16x32_bf16 a[92:95], v[128:131], a[44:47], a[92:95]
    ds_read_b64_tr_b16 a[4:5], v6 offset:49568
    v_mfma_f32_16x16x32_bf16 a[96:99], v[128:131], a[48:51], a[96:99]
    ds_read_b64_tr_b16 a[6:7], v6 offset:50592
    v_mfma_f32_16x16x32_bf16 a[100:103], v[132:135], a[44:47], a[100:103]
    ds_read_b64_tr_b16 a[8:9], v7 offset:49536
    v_mfma_f32_16x16x32_bf16 a[104:107], v[132:135], a[48:51], a[104:107]
    ds_read_b64_tr_b16 a[10:11], v7 offset:50560
    v_mfma_f32_16x16x32_bf16 a[108:111], v[136:139], a[44:47], a[108:111]
    ds_read_b64_tr_b16 a[12:13], v7 offset:49568
    v_mfma_f32_16x16x32_bf16 a[112:115], v[136:139], a[48:51], a[112:115]
    ds_read_b64_tr_b16 a[14:15], v7 offset:50592
    ds_read_b128 a[40:43], v4 offset:51200
    v_mfma_f32_16x16x32_bf16 a[52:55], v[108:111], a[44:47], a[52:55]
    ds_read_b64_tr_b16 a[16:17], v8 offset:49536
    v_mfma_f32_16x16x32_bf16 a[56:59], v[108:111], a[48:51], a[56:59]
    ds_read_b64_tr_b16 a[18:19], v8 offset:50560
    v_mfma_f32_16x16x32_bf16 a[60:63], v[112:115], a[44:47], a[60:63]
    ds_read_b64_tr_b16 a[20:21], v8 offset:49568
    v_mfma_f32_16x16x32_bf16 a[64:67], v[112:115], a[48:51], a[64:67]
    ds_read_b64_tr_b16 a[22:23], v8 offset:50592
    s_waitcnt lgkmcnt(6)
    v_mfma_f32_16x16x32_bf16 v[12:15], a[36:39], a[0:3], v[12:15]
    ds_read_b64_tr_b16 a[24:25], v9 offset:49536
    v_mfma_f32_16x16x32_bf16 v[20:23], a[36:39], a[4:7], v[20:23]
    ds_read_b64_tr_b16 a[26:27], v9 offset:50560
    v_mfma_f32_16x16x32_bf16 v[28:31], a[36:39], a[8:11], v[28:31]
    ds_read_b64_tr_b16 a[28:29], v9 offset:49568
    s_waitcnt lgkmcnt(5)
    v_mfma_f32_16x16x32_bf16 v[36:39], a[36:39], a[12:15], v[36:39]
    ds_read_b64_tr_b16 a[30:31], v9 offset:50592
    v_mfma_f32_16x16x32_bf16 v[16:19], a[40:43], a[0:3], v[16:19]
    v_mfma_f32_16x16x32_bf16 v[24:27], a[40:43], a[4:7], v[24:27]
    v_mfma_f32_16x16x32_bf16 v[32:35], a[40:43], a[8:11], v[32:35]
    ds_read_b128 a[44:47], v11 offset:2048
    ds_read_b128 a[48:51], v11 offset:3072
    v_mfma_f32_16x16x32_bf16 v[40:43], a[40:43], a[12:15], v[40:43]
    ds_read_b128 a[32:35], v5 offset:49152
    v_mfma_f32_16x16x32_bf16 v[44:47], a[36:39], a[16:19], v[44:47]
    ds_read_b64_tr_b16 a[0:1], v6 offset:57792
    ds_read_b64_tr_b16 a[2:3], v6 offset:58816
    s_waitcnt lgkmcnt(5)
    v_mfma_f32_16x16x32_bf16 v[52:55], a[36:39], a[20:23], v[52:55]
    ds_read_b64_tr_b16 a[4:5], v6 offset:57824
    ds_read_b64_tr_b16 a[6:7], v6 offset:58848
    v_mfma_f32_16x16x32_bf16 v[60:63], a[36:39], a[24:27], v[60:63]
    ds_read_b64_tr_b16 a[8:9], v7 offset:57792
    ds_read_b64_tr_b16 a[10:11], v7 offset:58816
    v_mfma_f32_16x16x32_bf16 v[68:71], a[36:39], a[28:31], v[68:71]
    ds_read_b64_tr_b16 a[12:13], v7 offset:57824
    ds_read_b64_tr_b16 a[14:15], v7 offset:58848
    v_mfma_f32_16x16x32_bf16 v[48:51], a[40:43], a[16:19], v[48:51]
    ds_read_b128 a[36:39], v5 offset:51200
    ds_read_b64_tr_b16 a[16:17], v8 offset:57792
    v_mfma_f32_16x16x32_bf16 v[56:59], a[40:43], a[20:23], v[56:59]
    ds_read_b64_tr_b16 a[18:19], v8 offset:58816
    v_mfma_f32_16x16x32_bf16 v[64:67], a[40:43], a[24:27], v[64:67]
    ds_read_b64_tr_b16 a[20:21], v8 offset:57824
    v_mfma_f32_16x16x32_bf16 v[72:75], a[40:43], a[28:31], v[72:75]
    ds_read_b64_tr_b16 a[22:23], v8 offset:58848
    s_waitcnt lgkmcnt(7)
    v_mfma_f32_16x16x32_bf16 v[12:15], a[32:35], a[0:3], v[12:15]
    ds_read_b64_tr_b16 a[24:25], v9 offset:57792
    v_mfma_f32_16x16x32_bf16 v[20:23], a[32:35], a[4:7], v[20:23]
    ds_read_b64_tr_b16 a[26:27], v9 offset:58816
    v_mfma_f32_16x16x32_bf16 v[28:31], a[32:35], a[8:11], v[28:31]
    ds_read_b64_tr_b16 a[28:29], v9 offset:57824
    s_waitcnt lgkmcnt(5)
    v_mfma_f32_16x16x32_bf16 v[36:39], a[32:35], a[12:15], v[36:39]
    ds_read_b64_tr_b16 a[30:31], v9 offset:58848
    v_mfma_f32_16x16x32_bf16 v[16:19], a[36:39], a[0:3], v[16:19]
    v_mfma_f32_16x16x32_bf16 v[24:27], a[36:39], a[4:7], v[24:27]
    v_mfma_f32_16x16x32_bf16 v[32:35], a[36:39], a[8:11], v[32:35]
    v_mfma_f32_16x16x32_bf16 v[40:43], a[36:39], a[12:15], v[40:43]
    v_mfma_f32_16x16x32_bf16 v[44:47], a[32:35], a[16:19], v[44:47]
    s_waitcnt lgkmcnt(0)
    v_mfma_f32_16x16x32_bf16 v[52:55], a[32:35], a[20:23], v[52:55]
    s_barrier
    v_cvt_pk_bf16_f32 v108, v12, v13
    v_cvt_pk_bf16_f32 v109, v14, v15
    v_mfma_f32_16x16x32_bf16 v[60:63], a[32:35], a[24:27], v[60:63]
    v_cvt_pk_bf16_f32 v110, v16, v17
    v_cvt_pk_bf16_f32 v111, v18, v19
    v_mfma_f32_16x16x32_bf16 v[68:71], a[32:35], a[28:31], v[68:71]
    v_cvt_pk_bf16_f32 v112, v20, v21
    v_cvt_pk_bf16_f32 v113, v22, v23
    v_mfma_f32_16x16x32_bf16 v[48:51], a[36:39], a[16:19], v[48:51]
    v_cvt_pk_bf16_f32 v114, v24, v25
    v_cvt_pk_bf16_f32 v115, v26, v27
    v_mfma_f32_16x16x32_bf16 v[56:59], a[36:39], a[20:23], v[56:59]
    v_cvt_pk_bf16_f32 v116, v28, v29
    v_cvt_pk_bf16_f32 v117, v30, v31
    v_mfma_f32_16x16x32_bf16 v[64:67], a[36:39], a[24:27], v[64:67]
    v_cvt_pk_bf16_f32 v118, v32, v33
    v_cvt_pk_bf16_f32 v119, v34, v35
    v_mfma_f32_16x16x32_bf16 v[72:75], a[36:39], a[28:31], v[72:75]
    v_cvt_pk_bf16_f32 v120, v36, v37
    v_cvt_pk_bf16_f32 v121, v38, v39
    v_mfma_f32_16x16x32_bf16 a[68:71], v[84:87], a[44:47], a[68:71]
    v_cvt_pk_bf16_f32 v122, v40, v41
    v_cvt_pk_bf16_f32 v123, v42, v43
    v_mfma_f32_16x16x32_bf16 a[72:75], v[84:87], a[48:51], a[72:75]
    v_cvt_pk_bf16_f32 v124, v44, v45
    v_cvt_pk_bf16_f32 v125, v46, v47
    v_mfma_f32_16x16x32_bf16 a[76:79], v[88:91], a[44:47], a[76:79]
    v_cvt_pk_bf16_f32 v126, v48, v49
    v_cvt_pk_bf16_f32 v127, v50, v51
    v_mfma_f32_16x16x32_bf16 a[80:83], v[88:91], a[48:51], a[80:83]
    ds_read_b128 a[40:43], v4 offset:0
    v_cvt_pk_bf16_f32 v128, v52, v53
    v_mfma_f32_16x16x32_bf16 a[84:87], v[92:95], a[44:47], a[84:87]
    ds_read_b64_tr_b16 a[0:1], v6 offset:0
    v_cvt_pk_bf16_f32 v129, v54, v55
    v_mfma_f32_16x16x32_bf16 a[88:91], v[92:95], a[48:51], a[88:91]
    ds_read_b64_tr_b16 a[2:3], v6 offset:1024
    v_cvt_pk_bf16_f32 v130, v56, v57
    v_mfma_f32_16x16x32_bf16 a[92:95], v[96:99], a[44:47], a[92:95]
    ds_read_b64_tr_b16 a[4:5], v6 offset:32
    v_cvt_pk_bf16_f32 v131, v58, v59
    v_mfma_f32_16x16x32_bf16 a[96:99], v[96:99], a[48:51], a[96:99]
    ds_read_b64_tr_b16 a[6:7], v6 offset:1056
    v_cvt_pk_bf16_f32 v132, v60, v61
    v_mfma_f32_16x16x32_bf16 a[100:103], v[100:103], a[44:47], a[100:103]
    ds_read_b64_tr_b16 a[8:9], v7 offset:0
    v_cvt_pk_bf16_f32 v133, v62, v63
    v_mfma_f32_16x16x32_bf16 a[104:107], v[100:103], a[48:51], a[104:107]
    ds_read_b64_tr_b16 a[10:11], v7 offset:1024
    v_cvt_pk_bf16_f32 v134, v64, v65
    v_mfma_f32_16x16x32_bf16 a[108:111], v[104:107], a[44:47], a[108:111]
    ds_read_b64_tr_b16 a[12:13], v7 offset:32
    v_cvt_pk_bf16_f32 v135, v66, v67
    v_mfma_f32_16x16x32_bf16 a[112:115], v[104:107], a[48:51], a[112:115]
    ds_read_b64_tr_b16 a[14:15], v7 offset:1056
    ds_read_b128 a[32:35], v4 offset:2048
    v_cvt_pk_bf16_f32 v136, v68, v69
    v_mfma_f32_16x16x32_bf16 a[52:55], v[76:79], a[44:47], a[52:55]
    ds_read_b64_tr_b16 a[16:17], v8 offset:0
    v_cvt_pk_bf16_f32 v137, v70, v71
    v_mfma_f32_16x16x32_bf16 a[56:59], v[76:79], a[48:51], a[56:59]
    ds_read_b64_tr_b16 a[18:19], v8 offset:1024
    v_cvt_pk_bf16_f32 v138, v72, v73
    v_mfma_f32_16x16x32_bf16 a[60:63], v[80:83], a[44:47], a[60:63]
    ds_read_b64_tr_b16 a[20:21], v8 offset:32
    v_cvt_pk_bf16_f32 v139, v74, v75
    v_mfma_f32_16x16x32_bf16 a[64:67], v[80:83], a[48:51], a[64:67]
    ds_read_b64_tr_b16 a[22:23], v8 offset:1056
    s_waitcnt lgkmcnt(6)
    v_mfma_f32_16x16x32_bf16 v[12:15], a[40:43], a[0:3], 0
    ds_read_b64_tr_b16 a[24:25], v9 offset:0
    v_mfma_f32_16x16x32_bf16 v[20:23], a[40:43], a[4:7], 0
    ds_read_b64_tr_b16 a[26:27], v9 offset:1024
    v_mfma_f32_16x16x32_bf16 v[28:31], a[40:43], a[8:11], 0
    ds_read_b64_tr_b16 a[28:29], v9 offset:32
    s_waitcnt lgkmcnt(5)
    v_mfma_f32_16x16x32_bf16 v[36:39], a[40:43], a[12:15], 0
    ds_read_b64_tr_b16 a[30:31], v9 offset:1056
    ds_read_b128 a[36:39], v5 offset:0
    v_mfma_f32_16x16x32_bf16 v[16:19], a[32:35], a[0:3], 0
    ds_read_b64_tr_b16 a[0:1], v6 offset:8256
    v_mfma_f32_16x16x32_bf16 v[24:27], a[32:35], a[4:7], 0
    ds_read_b64_tr_b16 a[2:3], v6 offset:9280
    v_mfma_f32_16x16x32_bf16 v[32:35], a[32:35], a[8:11], 0
    ds_read_b64_tr_b16 a[4:5], v6 offset:8288
    v_mfma_f32_16x16x32_bf16 v[40:43], a[32:35], a[12:15], 0
    ds_read_b64_tr_b16 a[6:7], v6 offset:9312
    v_mfma_f32_16x16x32_bf16 v[44:47], a[40:43], a[16:19], 0
    ds_read_b64_tr_b16 a[8:9], v7 offset:8256
    s_waitcnt lgkmcnt(5)
    v_mfma_f32_16x16x32_bf16 v[52:55], a[40:43], a[20:23], 0
    ds_read_b64_tr_b16 a[10:11], v7 offset:9280
    v_mfma_f32_16x16x32_bf16 v[60:63], a[40:43], a[24:27], 0
    ds_read_b64_tr_b16 a[12:13], v7 offset:8288
    v_mfma_f32_16x16x32_bf16 v[68:71], a[40:43], a[28:31], 0
    ds_read_b64_tr_b16 a[14:15], v7 offset:9312
    ds_read_b128 a[40:43], v5 offset:2048
    v_mfma_f32_16x16x32_bf16 v[48:51], a[32:35], a[16:19], 0
    ds_read_b64_tr_b16 a[16:17], v8 offset:8256
    v_mfma_f32_16x16x32_bf16 v[56:59], a[32:35], a[20:23], 0
    ds_read_b64_tr_b16 a[18:19], v8 offset:9280
    v_mfma_f32_16x16x32_bf16 v[64:67], a[32:35], a[24:27], 0
    ds_read_b64_tr_b16 a[20:21], v8 offset:8288
    v_mfma_f32_16x16x32_bf16 v[72:75], a[32:35], a[28:31], 0
    ds_read_b64_tr_b16 a[22:23], v8 offset:9312
    s_waitcnt lgkmcnt(6)
    v_mfma_f32_16x16x32_bf16 v[12:15], a[36:39], a[0:3], v[12:15]
    ds_read_b64_tr_b16 a[24:25], v9 offset:8256
    v_mfma_f32_16x16x32_bf16 v[20:23], a[36:39], a[4:7], v[20:23]
    ds_read_b64_tr_b16 a[26:27], v9 offset:9280
    v_mfma_f32_16x16x32_bf16 v[28:31], a[36:39], a[8:11], v[28:31]
    ds_read_b64_tr_b16 a[28:29], v9 offset:8288
    s_waitcnt lgkmcnt(5)
    v_mfma_f32_16x16x32_bf16 v[36:39], a[36:39], a[12:15], v[36:39]
    ds_read_b64_tr_b16 a[30:31], v9 offset:9312
    ds_read_b128 a[32:35], v4 offset:16384
    v_mfma_f32_16x16x32_bf16 v[16:19], a[40:43], a[0:3], v[16:19]
    ds_read_b64_tr_b16 a[0:1], v6 offset:16512
    v_mfma_f32_16x16x32_bf16 v[24:27], a[40:43], a[4:7], v[24:27]
    ds_read_b64_tr_b16 a[2:3], v6 offset:17536
    v_mfma_f32_16x16x32_bf16 v[32:35], a[40:43], a[8:11], v[32:35]
    ds_read_b64_tr_b16 a[4:5], v6 offset:16544
    v_mfma_f32_16x16x32_bf16 v[40:43], a[40:43], a[12:15], v[40:43]
    ds_read_b64_tr_b16 a[6:7], v6 offset:17568
    v_mfma_f32_16x16x32_bf16 v[44:47], a[36:39], a[16:19], v[44:47]
    ds_read_b64_tr_b16 a[8:9], v7 offset:16512
    s_waitcnt lgkmcnt(5)
    v_mfma_f32_16x16x32_bf16 v[52:55], a[36:39], a[20:23], v[52:55]
    s_barrier
    ds_read_b64_tr_b16 a[10:11], v7 offset:17536
    v_mfma_f32_16x16x32_bf16 v[60:63], a[36:39], a[24:27], v[60:63]
    ds_read_b64_tr_b16 a[12:13], v7 offset:16544
    v_mfma_f32_16x16x32_bf16 v[68:71], a[36:39], a[28:31], v[68:71]
    ds_read_b64_tr_b16 a[14:15], v7 offset:17568
    ds_read_b128 a[36:39], v4 offset:18432
    v_mfma_f32_16x16x32_bf16 v[48:51], a[40:43], a[16:19], v[48:51]
    ds_read_b64_tr_b16 a[16:17], v8 offset:16512
    v_mfma_f32_16x16x32_bf16 v[56:59], a[40:43], a[20:23], v[56:59]
    ds_read_b64_tr_b16 a[18:19], v8 offset:17536
    v_mfma_f32_16x16x32_bf16 v[64:67], a[40:43], a[24:27], v[64:67]
    ds_read_b64_tr_b16 a[20:21], v8 offset:16544
    v_mfma_f32_16x16x32_bf16 v[72:75], a[40:43], a[28:31], v[72:75]
    ds_read_b64_tr_b16 a[22:23], v8 offset:17568
    s_waitcnt lgkmcnt(6)
    v_mfma_f32_16x16x32_bf16 v[12:15], a[32:35], a[0:3], v[12:15]
    ds_read_b64_tr_b16 a[24:25], v9 offset:16512
    v_mfma_f32_16x16x32_bf16 v[20:23], a[32:35], a[4:7], v[20:23]
    ds_read_b64_tr_b16 a[26:27], v9 offset:17536
    v_mfma_f32_16x16x32_bf16 v[28:31], a[32:35], a[8:11], v[28:31]
    ds_read_b64_tr_b16 a[28:29], v9 offset:16544
    s_waitcnt lgkmcnt(5)
    v_mfma_f32_16x16x32_bf16 v[36:39], a[32:35], a[12:15], v[36:39]
    ds_read_b64_tr_b16 a[30:31], v9 offset:17568
    v_mfma_f32_16x16x32_bf16 v[16:19], a[36:39], a[0:3], v[16:19]
    v_mfma_f32_16x16x32_bf16 v[24:27], a[36:39], a[4:7], v[24:27]
    v_mfma_f32_16x16x32_bf16 v[32:35], a[36:39], a[8:11], v[32:35]
    ds_read_b128 a[44:47], v11 offset:4096
    ds_read_b128 a[48:51], v11 offset:5120
    v_mfma_f32_16x16x32_bf16 v[40:43], a[36:39], a[12:15], v[40:43]
    ds_read_b128 a[40:43], v5 offset:16384
    v_mfma_f32_16x16x32_bf16 v[44:47], a[32:35], a[16:19], v[44:47]
    ds_read_b64_tr_b16 a[0:1], v6 offset:24768
    ds_read_b64_tr_b16 a[2:3], v6 offset:25792
    s_waitcnt lgkmcnt(5)
    v_mfma_f32_16x16x32_bf16 v[52:55], a[32:35], a[20:23], v[52:55]
    ds_read_b64_tr_b16 a[4:5], v6 offset:24800
    ds_read_b64_tr_b16 a[6:7], v6 offset:25824
    v_mfma_f32_16x16x32_bf16 v[60:63], a[32:35], a[24:27], v[60:63]
    ds_read_b64_tr_b16 a[8:9], v7 offset:24768
    ds_read_b64_tr_b16 a[10:11], v7 offset:25792
    v_mfma_f32_16x16x32_bf16 v[68:71], a[32:35], a[28:31], v[68:71]
    ds_read_b64_tr_b16 a[12:13], v7 offset:24800
    ds_read_b64_tr_b16 a[14:15], v7 offset:25824
    v_mfma_f32_16x16x32_bf16 v[48:51], a[36:39], a[16:19], v[48:51]
    ds_read_b128 a[32:35], v5 offset:18432
    ds_read_b64_tr_b16 a[16:17], v8 offset:24768
    v_mfma_f32_16x16x32_bf16 v[56:59], a[36:39], a[20:23], v[56:59]
    ds_read_b64_tr_b16 a[18:19], v8 offset:25792
    v_mfma_f32_16x16x32_bf16 v[64:67], a[36:39], a[24:27], v[64:67]
    ds_read_b64_tr_b16 a[20:21], v8 offset:24800
    v_mfma_f32_16x16x32_bf16 v[72:75], a[36:39], a[28:31], v[72:75]
    ds_read_b64_tr_b16 a[22:23], v8 offset:25824
    s_waitcnt lgkmcnt(7)
    v_mfma_f32_16x16x32_bf16 v[12:15], a[40:43], a[0:3], v[12:15]
    ds_read_b64_tr_b16 a[24:25], v9 offset:24768
    v_mfma_f32_16x16x32_bf16 v[20:23], a[40:43], a[4:7], v[20:23]
    ds_read_b64_tr_b16 a[26:27], v9 offset:25792
    v_mfma_f32_16x16x32_bf16 v[28:31], a[40:43], a[8:11], v[28:31]
    ds_read_b64_tr_b16 a[28:29], v9 offset:24800
    s_waitcnt lgkmcnt(5)
    v_mfma_f32_16x16x32_bf16 v[36:39], a[40:43], a[12:15], v[36:39]
    ds_read_b64_tr_b16 a[30:31], v9 offset:25824
    v_mfma_f32_16x16x32_bf16 v[16:19], a[32:35], a[0:3], v[16:19]
    v_mfma_f32_16x16x32_bf16 v[24:27], a[32:35], a[4:7], v[24:27]
    v_mfma_f32_16x16x32_bf16 v[32:35], a[32:35], a[8:11], v[32:35]
    v_mfma_f32_16x16x32_bf16 v[40:43], a[32:35], a[12:15], v[40:43]
    v_mfma_f32_16x16x32_bf16 v[44:47], a[40:43], a[16:19], v[44:47]
    s_waitcnt lgkmcnt(0)
    v_mfma_f32_16x16x32_bf16 v[52:55], a[40:43], a[20:23], v[52:55]
    s_barrier
    v_cvt_pk_bf16_f32 v76, v12, v13
    v_cvt_pk_bf16_f32 v77, v14, v15
    v_mfma_f32_16x16x32_bf16 v[60:63], a[40:43], a[24:27], v[60:63]
    v_cvt_pk_bf16_f32 v78, v16, v17
    v_cvt_pk_bf16_f32 v79, v18, v19
    v_mfma_f32_16x16x32_bf16 v[68:71], a[40:43], a[28:31], v[68:71]
    v_cvt_pk_bf16_f32 v80, v20, v21
    v_cvt_pk_bf16_f32 v81, v22, v23
    v_mfma_f32_16x16x32_bf16 v[48:51], a[32:35], a[16:19], v[48:51]
    v_cvt_pk_bf16_f32 v82, v24, v25
    v_cvt_pk_bf16_f32 v83, v26, v27
    v_mfma_f32_16x16x32_bf16 v[56:59], a[32:35], a[20:23], v[56:59]
    v_cvt_pk_bf16_f32 v84, v28, v29
    v_cvt_pk_bf16_f32 v85, v30, v31
    v_mfma_f32_16x16x32_bf16 v[64:67], a[32:35], a[24:27], v[64:67]
    v_cvt_pk_bf16_f32 v86, v32, v33
    v_cvt_pk_bf16_f32 v87, v34, v35
    v_mfma_f32_16x16x32_bf16 v[72:75], a[32:35], a[28:31], v[72:75]
    v_cvt_pk_bf16_f32 v88, v36, v37
    v_cvt_pk_bf16_f32 v89, v38, v39
    v_mfma_f32_16x16x32_bf16 a[68:71], v[116:119], a[44:47], a[68:71]
    v_cvt_pk_bf16_f32 v90, v40, v41
    v_cvt_pk_bf16_f32 v91, v42, v43
    v_mfma_f32_16x16x32_bf16 a[72:75], v[116:119], a[48:51], a[72:75]
    v_cvt_pk_bf16_f32 v92, v44, v45
    v_cvt_pk_bf16_f32 v93, v46, v47
    v_mfma_f32_16x16x32_bf16 a[76:79], v[120:123], a[44:47], a[76:79]
    v_cvt_pk_bf16_f32 v94, v48, v49
    v_cvt_pk_bf16_f32 v95, v50, v51
    v_mfma_f32_16x16x32_bf16 a[80:83], v[120:123], a[48:51], a[80:83]
    ds_read_b128 a[36:39], v4 offset:32768
    v_cvt_pk_bf16_f32 v96, v52, v53
    v_mfma_f32_16x16x32_bf16 a[84:87], v[124:127], a[44:47], a[84:87]
    ds_read_b64_tr_b16 a[0:1], v6 offset:33024
    v_cvt_pk_bf16_f32 v97, v54, v55
    v_mfma_f32_16x16x32_bf16 a[88:91], v[124:127], a[48:51], a[88:91]
    ds_read_b64_tr_b16 a[2:3], v6 offset:34048
    v_cvt_pk_bf16_f32 v98, v56, v57
    v_mfma_f32_16x16x32_bf16 a[92:95], v[128:131], a[44:47], a[92:95]
    ds_read_b64_tr_b16 a[4:5], v6 offset:33056
    v_cvt_pk_bf16_f32 v99, v58, v59
    v_mfma_f32_16x16x32_bf16 a[96:99], v[128:131], a[48:51], a[96:99]
    ds_read_b64_tr_b16 a[6:7], v6 offset:34080
    v_cvt_pk_bf16_f32 v100, v60, v61
    v_mfma_f32_16x16x32_bf16 a[100:103], v[132:135], a[44:47], a[100:103]
    ds_read_b64_tr_b16 a[8:9], v7 offset:33024
    v_cvt_pk_bf16_f32 v101, v62, v63
    v_mfma_f32_16x16x32_bf16 a[104:107], v[132:135], a[48:51], a[104:107]
    ds_read_b64_tr_b16 a[10:11], v7 offset:34048
    v_cvt_pk_bf16_f32 v102, v64, v65
    v_mfma_f32_16x16x32_bf16 a[108:111], v[136:139], a[44:47], a[108:111]
    ds_read_b64_tr_b16 a[12:13], v7 offset:33056
    v_cvt_pk_bf16_f32 v103, v66, v67
    v_mfma_f32_16x16x32_bf16 a[112:115], v[136:139], a[48:51], a[112:115]
    ds_read_b64_tr_b16 a[14:15], v7 offset:34080
    ds_read_b128 a[40:43], v4 offset:34816
    v_cvt_pk_bf16_f32 v104, v68, v69
    v_mfma_f32_16x16x32_bf16 a[52:55], v[108:111], a[44:47], a[52:55]
    ds_read_b64_tr_b16 a[16:17], v8 offset:33024
    v_cvt_pk_bf16_f32 v105, v70, v71
    v_mfma_f32_16x16x32_bf16 a[56:59], v[108:111], a[48:51], a[56:59]
    ds_read_b64_tr_b16 a[18:19], v8 offset:34048
    v_cvt_pk_bf16_f32 v106, v72, v73
    v_mfma_f32_16x16x32_bf16 a[60:63], v[112:115], a[44:47], a[60:63]
    ds_read_b64_tr_b16 a[20:21], v8 offset:33056
    v_cvt_pk_bf16_f32 v107, v74, v75
    v_mfma_f32_16x16x32_bf16 a[64:67], v[112:115], a[48:51], a[64:67]
    ds_read_b64_tr_b16 a[22:23], v8 offset:34080
    s_waitcnt lgkmcnt(6)
    v_mfma_f32_16x16x32_bf16 v[12:15], a[36:39], a[0:3], 0
    ds_read_b64_tr_b16 a[24:25], v9 offset:33024
    v_mfma_f32_16x16x32_bf16 v[20:23], a[36:39], a[4:7], 0
    ds_read_b64_tr_b16 a[26:27], v9 offset:34048
    v_mfma_f32_16x16x32_bf16 v[28:31], a[36:39], a[8:11], 0
    ds_read_b64_tr_b16 a[28:29], v9 offset:33056
    s_waitcnt lgkmcnt(5)
    v_mfma_f32_16x16x32_bf16 v[36:39], a[36:39], a[12:15], 0
    ds_read_b64_tr_b16 a[30:31], v9 offset:34080
    ds_read_b128 a[32:35], v5 offset:32768
    v_mfma_f32_16x16x32_bf16 v[16:19], a[40:43], a[0:3], 0
    ds_read_b64_tr_b16 a[0:1], v6 offset:41280
    v_mfma_f32_16x16x32_bf16 v[24:27], a[40:43], a[4:7], 0
    ds_read_b64_tr_b16 a[2:3], v6 offset:42304
    v_mfma_f32_16x16x32_bf16 v[32:35], a[40:43], a[8:11], 0
    ds_read_b64_tr_b16 a[4:5], v6 offset:41312
    v_mfma_f32_16x16x32_bf16 v[40:43], a[40:43], a[12:15], 0
    ds_read_b64_tr_b16 a[6:7], v6 offset:42336
    v_mfma_f32_16x16x32_bf16 v[44:47], a[36:39], a[16:19], 0
    ds_read_b64_tr_b16 a[8:9], v7 offset:41280
    s_waitcnt lgkmcnt(5)
    v_mfma_f32_16x16x32_bf16 v[52:55], a[36:39], a[20:23], 0
    ds_read_b64_tr_b16 a[10:11], v7 offset:42304
    v_mfma_f32_16x16x32_bf16 v[60:63], a[36:39], a[24:27], 0
    ds_read_b64_tr_b16 a[12:13], v7 offset:41312
    v_mfma_f32_16x16x32_bf16 v[68:71], a[36:39], a[28:31], 0
    ds_read_b64_tr_b16 a[14:15], v7 offset:42336
    ds_read_b128 a[36:39], v5 offset:34816
    v_mfma_f32_16x16x32_bf16 v[48:51], a[40:43], a[16:19], 0
    ds_read_b64_tr_b16 a[16:17], v8 offset:41280
    v_mfma_f32_16x16x32_bf16 v[56:59], a[40:43], a[20:23], 0
    ds_read_b64_tr_b16 a[18:19], v8 offset:42304
    v_mfma_f32_16x16x32_bf16 v[64:67], a[40:43], a[24:27], 0
    ds_read_b64_tr_b16 a[20:21], v8 offset:41312
    v_mfma_f32_16x16x32_bf16 v[72:75], a[40:43], a[28:31], 0
    ds_read_b64_tr_b16 a[22:23], v8 offset:42336
    s_waitcnt lgkmcnt(6)
    v_mfma_f32_16x16x32_bf16 v[12:15], a[32:35], a[0:3], v[12:15]
    ds_read_b64_tr_b16 a[24:25], v9 offset:41280
    v_mfma_f32_16x16x32_bf16 v[20:23], a[32:35], a[4:7], v[20:23]
    ds_read_b64_tr_b16 a[26:27], v9 offset:42304
    v_mfma_f32_16x16x32_bf16 v[28:31], a[32:35], a[8:11], v[28:31]
    ds_read_b64_tr_b16 a[28:29], v9 offset:41312
    s_waitcnt lgkmcnt(5)
    v_mfma_f32_16x16x32_bf16 v[36:39], a[32:35], a[12:15], v[36:39]
    ds_read_b64_tr_b16 a[30:31], v9 offset:42336
    ds_read_b128 a[40:43], v4 offset:49152
    v_mfma_f32_16x16x32_bf16 v[16:19], a[36:39], a[0:3], v[16:19]
    ds_read_b64_tr_b16 a[0:1], v6 offset:49536
    v_mfma_f32_16x16x32_bf16 v[24:27], a[36:39], a[4:7], v[24:27]
    ds_read_b64_tr_b16 a[2:3], v6 offset:50560
    v_mfma_f32_16x16x32_bf16 v[32:35], a[36:39], a[8:11], v[32:35]
    ds_read_b64_tr_b16 a[4:5], v6 offset:49568
    v_mfma_f32_16x16x32_bf16 v[40:43], a[36:39], a[12:15], v[40:43]
    ds_read_b64_tr_b16 a[6:7], v6 offset:50592
    v_mfma_f32_16x16x32_bf16 v[44:47], a[32:35], a[16:19], v[44:47]
    ds_read_b64_tr_b16 a[8:9], v7 offset:49536
    s_waitcnt lgkmcnt(5)
    v_mfma_f32_16x16x32_bf16 v[52:55], a[32:35], a[20:23], v[52:55]
    s_barrier
    ds_read_b64_tr_b16 a[10:11], v7 offset:50560
    v_mfma_f32_16x16x32_bf16 v[60:63], a[32:35], a[24:27], v[60:63]
    ds_read_b64_tr_b16 a[12:13], v7 offset:49568
    v_mfma_f32_16x16x32_bf16 v[68:71], a[32:35], a[28:31], v[68:71]
    ds_read_b64_tr_b16 a[14:15], v7 offset:50592
    ds_read_b128 a[32:35], v4 offset:51200
    v_mfma_f32_16x16x32_bf16 v[48:51], a[36:39], a[16:19], v[48:51]
    ds_read_b64_tr_b16 a[16:17], v8 offset:49536
    v_mfma_f32_16x16x32_bf16 v[56:59], a[36:39], a[20:23], v[56:59]
    ds_read_b64_tr_b16 a[18:19], v8 offset:50560
    v_mfma_f32_16x16x32_bf16 v[64:67], a[36:39], a[24:27], v[64:67]
    ds_read_b64_tr_b16 a[20:21], v8 offset:49568
    v_mfma_f32_16x16x32_bf16 v[72:75], a[36:39], a[28:31], v[72:75]
    ds_read_b64_tr_b16 a[22:23], v8 offset:50592
    s_waitcnt lgkmcnt(6)
    v_mfma_f32_16x16x32_bf16 v[12:15], a[40:43], a[0:3], v[12:15]
    ds_read_b64_tr_b16 a[24:25], v9 offset:49536
    v_mfma_f32_16x16x32_bf16 v[20:23], a[40:43], a[4:7], v[20:23]
    ds_read_b64_tr_b16 a[26:27], v9 offset:50560
    v_mfma_f32_16x16x32_bf16 v[28:31], a[40:43], a[8:11], v[28:31]
    ds_read_b64_tr_b16 a[28:29], v9 offset:49568
    s_waitcnt lgkmcnt(5)
    v_mfma_f32_16x16x32_bf16 v[36:39], a[40:43], a[12:15], v[36:39]
    ds_read_b64_tr_b16 a[30:31], v9 offset:50592
    v_mfma_f32_16x16x32_bf16 v[16:19], a[32:35], a[0:3], v[16:19]
    v_mfma_f32_16x16x32_bf16 v[24:27], a[32:35], a[4:7], v[24:27]
    v_mfma_f32_16x16x32_bf16 v[32:35], a[32:35], a[8:11], v[32:35]
    ds_read_b128 a[44:47], v11 offset:0
    ds_read_b128 a[48:51], v11 offset:1024
    v_mfma_f32_16x16x32_bf16 v[40:43], a[32:35], a[12:15], v[40:43]
    ds_read_b128 a[36:39], v5 offset:49152
    v_mfma_f32_16x16x32_bf16 v[44:47], a[40:43], a[16:19], v[44:47]
    ds_read_b64_tr_b16 a[0:1], v6 offset:57792
    ds_read_b64_tr_b16 a[2:3], v6 offset:58816
    s_waitcnt lgkmcnt(5)
    v_mfma_f32_16x16x32_bf16 v[52:55], a[40:43], a[20:23], v[52:55]
    ds_read_b64_tr_b16 a[4:5], v6 offset:57824
    ds_read_b64_tr_b16 a[6:7], v6 offset:58848
    v_mfma_f32_16x16x32_bf16 v[60:63], a[40:43], a[24:27], v[60:63]
    ds_read_b64_tr_b16 a[8:9], v7 offset:57792
    ds_read_b64_tr_b16 a[10:11], v7 offset:58816
    v_mfma_f32_16x16x32_bf16 v[68:71], a[40:43], a[28:31], v[68:71]
    ds_read_b64_tr_b16 a[12:13], v7 offset:57824
    ds_read_b64_tr_b16 a[14:15], v7 offset:58848
    v_mfma_f32_16x16x32_bf16 v[48:51], a[32:35], a[16:19], v[48:51]
    ds_read_b128 a[40:43], v5 offset:51200
    ds_read_b64_tr_b16 a[16:17], v8 offset:57792
    v_mfma_f32_16x16x32_bf16 v[56:59], a[32:35], a[20:23], v[56:59]
    ds_read_b64_tr_b16 a[18:19], v8 offset:58816
    v_mfma_f32_16x16x32_bf16 v[64:67], a[32:35], a[24:27], v[64:67]
    ds_read_b64_tr_b16 a[20:21], v8 offset:57824
    v_mfma_f32_16x16x32_bf16 v[72:75], a[32:35], a[28:31], v[72:75]
    ds_read_b64_tr_b16 a[22:23], v8 offset:58848
    s_waitcnt lgkmcnt(7)
    v_mfma_f32_16x16x32_bf16 v[12:15], a[36:39], a[0:3], v[12:15]
    ds_read_b64_tr_b16 a[24:25], v9 offset:57792
    v_mfma_f32_16x16x32_bf16 v[20:23], a[36:39], a[4:7], v[20:23]
    ds_read_b64_tr_b16 a[26:27], v9 offset:58816
    v_mfma_f32_16x16x32_bf16 v[28:31], a[36:39], a[8:11], v[28:31]
    ds_read_b64_tr_b16 a[28:29], v9 offset:57824
    s_waitcnt lgkmcnt(5)
    v_mfma_f32_16x16x32_bf16 v[36:39], a[36:39], a[12:15], v[36:39]
    ds_read_b64_tr_b16 a[30:31], v9 offset:58848
    v_mfma_f32_16x16x32_bf16 v[16:19], a[40:43], a[0:3], v[16:19]
    v_mfma_f32_16x16x32_bf16 v[24:27], a[40:43], a[4:7], v[24:27]
    v_mfma_f32_16x16x32_bf16 v[32:35], a[40:43], a[8:11], v[32:35]
    v_mfma_f32_16x16x32_bf16 v[40:43], a[40:43], a[12:15], v[40:43]
    v_mfma_f32_16x16x32_bf16 v[44:47], a[36:39], a[16:19], v[44:47]
    s_waitcnt lgkmcnt(0)
    v_mfma_f32_16x16x32_bf16 v[52:55], a[36:39], a[20:23], v[52:55]
    s_barrier
    v_cvt_pk_bf16_f32 v108, v12, v13
    v_cvt_pk_bf16_f32 v109, v14, v15
    v_mfma_f32_16x16x32_bf16 v[60:63], a[36:39], a[24:27], v[60:63]
    v_cvt_pk_bf16_f32 v110, v16, v17
    v_cvt_pk_bf16_f32 v111, v18, v19
    v_mfma_f32_16x16x32_bf16 v[68:71], a[36:39], a[28:31], v[68:71]
    v_cvt_pk_bf16_f32 v112, v20, v21
    v_cvt_pk_bf16_f32 v113, v22, v23
    v_mfma_f32_16x16x32_bf16 v[48:51], a[40:43], a[16:19], v[48:51]
    v_cvt_pk_bf16_f32 v114, v24, v25
    v_cvt_pk_bf16_f32 v115, v26, v27
    v_mfma_f32_16x16x32_bf16 v[56:59], a[40:43], a[20:23], v[56:59]
    v_cvt_pk_bf16_f32 v116, v28, v29
    v_cvt_pk_bf16_f32 v117, v30, v31
    v_mfma_f32_16x16x32_bf16 v[64:67], a[40:43], a[24:27], v[64:67]
    v_cvt_pk_bf16_f32 v118, v32, v33
    v_cvt_pk_bf16_f32 v119, v34, v35
    v_mfma_f32_16x16x32_bf16 v[72:75], a[40:43], a[28:31], v[72:75]
    v_cvt_pk_bf16_f32 v120, v36, v37
    v_cvt_pk_bf16_f32 v121, v38, v39
    v_mfma_f32_16x16x32_bf16 a[68:71], v[84:87], a[44:47], a[68:71]
    v_cvt_pk_bf16_f32 v122, v40, v41
    v_cvt_pk_bf16_f32 v123, v42, v43
    v_mfma_f32_16x16x32_bf16 a[72:75], v[84:87], a[48:51], a[72:75]
    v_cvt_pk_bf16_f32 v124, v44, v45
    v_cvt_pk_bf16_f32 v125, v46, v47
    v_mfma_f32_16x16x32_bf16 a[76:79], v[88:91], a[44:47], a[76:79]
    v_cvt_pk_bf16_f32 v126, v48, v49
    v_cvt_pk_bf16_f32 v127, v50, v51
    v_mfma_f32_16x16x32_bf16 a[80:83], v[88:91], a[48:51], a[80:83]
    ds_read_b128 a[32:35], v11 offset:2048
    v_cvt_pk_bf16_f32 v128, v52, v53
    v_mfma_f32_16x16x32_bf16 a[84:87], v[92:95], a[44:47], a[84:87]
    ds_read_b128 a[36:39], v11 offset:3072
    v_cvt_pk_bf16_f32 v129, v54, v55
    v_mfma_f32_16x16x32_bf16 a[88:91], v[92:95], a[48:51], a[88:91]
    v_cvt_pk_bf16_f32 v130, v56, v57
    v_cvt_pk_bf16_f32 v131, v58, v59
    v_mfma_f32_16x16x32_bf16 a[92:95], v[96:99], a[44:47], a[92:95]
    v_cvt_pk_bf16_f32 v132, v60, v61
    v_cvt_pk_bf16_f32 v133, v62, v63
    v_mfma_f32_16x16x32_bf16 a[96:99], v[96:99], a[48:51], a[96:99]
    v_cvt_pk_bf16_f32 v134, v64, v65
    v_cvt_pk_bf16_f32 v135, v66, v67
    v_mfma_f32_16x16x32_bf16 a[100:103], v[100:103], a[44:47], a[100:103]
    v_cvt_pk_bf16_f32 v136, v68, v69
    v_cvt_pk_bf16_f32 v137, v70, v71
    v_mfma_f32_16x16x32_bf16 a[104:107], v[100:103], a[48:51], a[104:107]
    v_cvt_pk_bf16_f32 v138, v72, v73
    v_cvt_pk_bf16_f32 v139, v74, v75
    v_mfma_f32_16x16x32_bf16 a[108:111], v[104:107], a[44:47], a[108:111]
    v_mfma_f32_16x16x32_bf16 a[112:115], v[104:107], a[48:51], a[112:115]
    v_mfma_f32_16x16x32_bf16 a[52:55], v[76:79], a[44:47], a[52:55]
    v_mfma_f32_16x16x32_bf16 a[56:59], v[76:79], a[48:51], a[56:59]
    v_mfma_f32_16x16x32_bf16 a[60:63], v[80:83], a[44:47], a[60:63]
    v_mfma_f32_16x16x32_bf16 a[64:67], v[80:83], a[48:51], a[64:67]
    s_waitcnt lgkmcnt(0)
    v_mfma_f32_16x16x32_bf16 a[68:71], v[116:119], a[32:35], a[68:71]
    v_mfma_f32_16x16x32_bf16 a[72:75], v[116:119], a[36:39], a[72:75]
    v_mfma_f32_16x16x32_bf16 a[76:79], v[120:123], a[32:35], a[76:79]
    v_mfma_f32_16x16x32_bf16 a[80:83], v[120:123], a[36:39], a[80:83]
    v_mfma_f32_16x16x32_bf16 a[84:87], v[124:127], a[32:35], a[84:87]
    v_mfma_f32_16x16x32_bf16 a[88:91], v[124:127], a[36:39], a[88:91]
    ds_read_b128 v[12:15], v4 offset:0
    v_mfma_f32_16x16x32_bf16 a[92:95], v[128:131], a[32:35], a[92:95]
    ds_read_b64_tr_b16 a[0:1], v7 offset:0
    v_mfma_f32_16x16x32_bf16 a[96:99], v[128:131], a[36:39], a[96:99]
    ds_read_b64_tr_b16 a[2:3], v7 offset:1024
    v_mfma_f32_16x16x32_bf16 a[100:103], v[132:135], a[32:35], a[100:103]
    ds_read_b128 v[16:19], v4 offset:2048
    v_mfma_f32_16x16x32_bf16 a[104:107], v[132:135], a[36:39], a[104:107]
    ds_read_b64_tr_b16 a[4:5], v7 offset:32
    v_mfma_f32_16x16x32_bf16 a[108:111], v[136:139], a[32:35], a[108:111]
    ds_read_b64_tr_b16 a[6:7], v7 offset:1056
    ds_read_b128 v[20:23], v5 offset:0
    v_mfma_f32_16x16x32_bf16 a[112:115], v[136:139], a[36:39], a[112:115]
    ds_read_b64_tr_b16 a[8:9], v7 offset:8256
    v_mfma_f32_16x16x32_bf16 a[52:55], v[108:111], a[32:35], a[52:55]
    ds_read_b64_tr_b16 a[10:11], v7 offset:9280
    ds_read_b128 v[24:27], v5 offset:2048
    v_mfma_f32_16x16x32_bf16 a[56:59], v[108:111], a[36:39], a[56:59]
    ds_read_b64_tr_b16 a[12:13], v7 offset:8288
    v_mfma_f32_16x16x32_bf16 a[60:63], v[112:115], a[32:35], a[60:63]
    ds_read_b64_tr_b16 a[14:15], v7 offset:9312
    ds_read_b128 v[28:31], v4 offset:16384
    v_mfma_f32_16x16x32_bf16 a[64:67], v[112:115], a[36:39], a[64:67]
    ds_read_b64_tr_b16 a[16:17], v7 offset:16512
    s_waitcnt lgkmcnt(7)
    v_mfma_f32_16x16x32_bf16 v[76:79], v[12:15], a[0:3], 0
    ds_read_b64_tr_b16 a[18:19], v7 offset:17536
    ds_read_b128 v[32:35], v4 offset:18432
    v_mfma_f32_16x16x32_bf16 v[80:83], v[16:19], a[0:3], 0
    ds_read_b64_tr_b16 a[20:21], v7 offset:16544
    v_mfma_f32_16x16x32_bf16 v[84:87], v[12:15], a[4:7], 0
    ds_read_b64_tr_b16 a[22:23], v7 offset:17568
    ds_read_b128 v[36:39], v5 offset:16384
    v_mfma_f32_16x16x32_bf16 v[88:91], v[16:19], a[4:7], 0
    ds_read_b64_tr_b16 a[24:25], v7 offset:24768
    s_waitcnt lgkmcnt(7)
    v_mfma_f32_16x16x32_bf16 v[76:79], v[20:23], a[8:11], v[76:79]
    ds_read_b64_tr_b16 a[26:27], v7 offset:25792
    ds_read_b128 v[40:43], v5 offset:18432
    v_mfma_f32_16x16x32_bf16 v[80:83], v[24:27], a[8:11], v[80:83]
    ds_read_b64_tr_b16 a[28:29], v7 offset:24800
    v_mfma_f32_16x16x32_bf16 v[84:87], v[20:23], a[12:15], v[84:87]
    ds_read_b64_tr_b16 a[30:31], v7 offset:25824
    ds_read_b128 a[44:47], v11 offset:4096
    v_mfma_f32_16x16x32_bf16 v[88:91], v[24:27], a[12:15], v[88:91]
    ds_read_b128 a[48:51], v11 offset:5120
    s_waitcnt lgkmcnt(7)
    v_mfma_f32_16x16x32_bf16 v[76:79], v[28:31], a[16:19], v[76:79]
    ds_read_b64_tr_b16 a[0:1], v8 offset:0
    ds_read_b64_tr_b16 a[2:3], v8 offset:1024
    v_mfma_f32_16x16x32_bf16 v[80:83], v[32:35], a[16:19], v[80:83]
    ds_read_b64_tr_b16 a[4:5], v8 offset:32
    v_mfma_f32_16x16x32_bf16 v[84:87], v[28:31], a[20:23], v[84:87]
    ds_read_b64_tr_b16 a[6:7], v8 offset:1056
    ds_read_b64_tr_b16 a[8:9], v8 offset:8256
    v_mfma_f32_16x16x32_bf16 v[88:91], v[32:35], a[20:23], v[88:91]
    ds_read_b64_tr_b16 a[10:11], v8 offset:9280
    s_waitcnt lgkmcnt(7)
    v_mfma_f32_16x16x32_bf16 v[76:79], v[36:39], a[24:27], v[76:79]
    ds_read_b64_tr_b16 a[12:13], v8 offset:8288
    v_mfma_f32_16x16x32_bf16 v[80:83], v[40:43], a[24:27], v[80:83]
    ds_read_b64_tr_b16 a[14:15], v8 offset:9312
    v_mfma_f32_16x16x32_bf16 v[84:87], v[36:39], a[28:31], v[84:87]
    v_mfma_f32_16x16x32_bf16 v[88:91], v[40:43], a[28:31], v[88:91]
    s_waitcnt lgkmcnt(3)
    v_mfma_f32_16x16x32_bf16 v[92:95], v[12:15], a[0:3], 0
    v_mfma_f32_16x16x32_bf16 v[96:99], v[16:19], a[0:3], 0
    ds_read_b64_tr_b16 a[16:17], v8 offset:16512
    v_mfma_f32_16x16x32_bf16 v[100:103], v[12:15], a[4:7], 0
    ds_read_b64_tr_b16 a[18:19], v8 offset:17536
    v_cvt_pk_bf16_f32 v76, v76, v77
    v_cvt_pk_bf16_f32 v77, v78, v79
    v_mfma_f32_16x16x32_bf16 v[104:107], v[16:19], a[4:7], 0
    ds_read_b64_tr_b16 a[20:21], v8 offset:16544
    v_cvt_pk_bf16_f32 v78, v80, v81
    v_cvt_pk_bf16_f32 v79, v82, v83
    s_waitcnt lgkmcnt(3)
    v_mfma_f32_16x16x32_bf16 v[92:95], v[20:23], a[8:11], v[92:95]
    ds_read_b64_tr_b16 a[22:23], v8 offset:17568
    v_cvt_pk_bf16_f32 v84, v84, v85
    v_cvt_pk_bf16_f32 v85, v86, v87
    v_mfma_f32_16x16x32_bf16 v[96:99], v[24:27], a[8:11], v[96:99]
    ds_read_b64_tr_b16 a[24:25], v8 offset:24768
    v_cvt_pk_bf16_f32 v86, v88, v89
    v_cvt_pk_bf16_f32 v87, v90, v91
    v_mfma_f32_16x16x32_bf16 v[100:103], v[20:23], a[12:15], v[100:103]
    ds_read_b64_tr_b16 a[26:27], v8 offset:25792
    v_mfma_f32_16x16x32_bf16 v[104:107], v[24:27], a[12:15], v[104:107]
    ds_read_b64_tr_b16 a[28:29], v8 offset:24800
    v_mfma_f32_16x16x32_bf16 a[68:71], v[76:79], a[44:47], a[68:71]
    ds_read_b64_tr_b16 a[30:31], v8 offset:25824
    v_mfma_f32_16x16x32_bf16 a[72:75], v[76:79], a[48:51], a[72:75]
    s_barrier
    ds_read_b128 v[44:47], v4 offset:32768
    v_mfma_f32_16x16x32_bf16 a[76:79], v[84:87], a[44:47], a[76:79]
    ds_read_b64_tr_b16 a[0:1], v7 offset:33024
    v_mfma_f32_16x16x32_bf16 a[80:83], v[84:87], a[48:51], a[80:83]
    ds_read_b64_tr_b16 a[2:3], v7 offset:34048
    s_waitcnt lgkmcnt(5)
    v_mfma_f32_16x16x32_bf16 v[92:95], v[28:31], a[16:19], v[92:95]
    ds_read_b128 v[48:51], v4 offset:34816
    v_mfma_f32_16x16x32_bf16 v[96:99], v[32:35], a[16:19], v[96:99]
    ds_read_b64_tr_b16 a[4:5], v7 offset:33056
    v_mfma_f32_16x16x32_bf16 v[100:103], v[28:31], a[20:23], v[100:103]
    ds_read_b64_tr_b16 a[6:7], v7 offset:34080
    ds_read_b128 v[52:55], v5 offset:32768
    v_mfma_f32_16x16x32_bf16 v[104:107], v[32:35], a[20:23], v[104:107]
    ds_read_b64_tr_b16 a[8:9], v7 offset:41280
    v_mfma_f32_16x16x32_bf16 v[92:95], v[36:39], a[24:27], v[92:95]
    ds_read_b64_tr_b16 a[10:11], v7 offset:42304
    ds_read_b128 v[56:59], v5 offset:34816
    v_mfma_f32_16x16x32_bf16 v[96:99], v[40:43], a[24:27], v[96:99]
    ds_read_b64_tr_b16 a[12:13], v7 offset:41312
    s_waitcnt lgkmcnt(7)
    v_mfma_f32_16x16x32_bf16 v[100:103], v[36:39], a[28:31], v[100:103]
    ds_read_b64_tr_b16 a[14:15], v7 offset:42336
    v_mfma_f32_16x16x32_bf16 v[104:107], v[40:43], a[28:31], v[104:107]
    v_mfma_f32_16x16x32_bf16 v[108:111], v[44:47], a[0:3], 0
    v_mfma_f32_16x16x32_bf16 v[112:115], v[48:51], a[0:3], 0
    s_barrier
    ds_read_b128 v[60:63], v4 offset:49152
    s_waitcnt lgkmcnt(3)
    v_mfma_f32_16x16x32_bf16 v[116:119], v[44:47], a[4:7], 0
    ds_read_b64_tr_b16 a[16:17], v7 offset:49536
    v_cvt_pk_bf16_f32 v92, v92, v93
    v_cvt_pk_bf16_f32 v93, v94, v95
    v_mfma_f32_16x16x32_bf16 v[120:123], v[48:51], a[4:7], 0
    ds_read_b64_tr_b16 a[18:19], v7 offset:50560
    v_cvt_pk_bf16_f32 v94, v96, v97
    v_cvt_pk_bf16_f32 v95, v98, v99
    v_mfma_f32_16x16x32_bf16 v[108:111], v[52:55], a[8:11], v[108:111]
    ds_read_b128 v[64:67], v4 offset:51200
    v_cvt_pk_bf16_f32 v100, v100, v101
    v_cvt_pk_bf16_f32 v101, v102, v103
    v_mfma_f32_16x16x32_bf16 v[112:115], v[56:59], a[8:11], v[112:115]
    ds_read_b64_tr_b16 a[20:21], v7 offset:49568
    v_cvt_pk_bf16_f32 v102, v104, v105
    v_cvt_pk_bf16_f32 v103, v106, v107
    s_waitcnt lgkmcnt(5)
    v_mfma_f32_16x16x32_bf16 v[116:119], v[52:55], a[12:15], v[116:119]
    ds_read_b64_tr_b16 a[22:23], v7 offset:50592
    ds_read_b128 v[68:71], v5 offset:49152
    v_mfma_f32_16x16x32_bf16 v[120:123], v[56:59], a[12:15], v[120:123]
    ds_read_b64_tr_b16 a[24:25], v7 offset:57792
    v_mfma_f32_16x16x32_bf16 a[84:87], v[92:95], a[44:47], a[84:87]
    ds_read_b64_tr_b16 a[26:27], v7 offset:58816
    ds_read_b128 v[72:75], v5 offset:51200
    v_mfma_f32_16x16x32_bf16 a[88:91], v[92:95], a[48:51], a[88:91]
    ds_read_b64_tr_b16 a[28:29], v7 offset:57824
    v_mfma_f32_16x16x32_bf16 a[92:95], v[100:103], a[44:47], a[92:95]
    ds_read_b64_tr_b16 a[30:31], v7 offset:58848
    ds_read_b128 a[32:35], v11 offset:0
    v_mfma_f32_16x16x32_bf16 a[96:99], v[100:103], a[48:51], a[96:99]
    ds_read_b128 a[36:39], v11 offset:1024
    s_waitcnt lgkmcnt(7)
    v_mfma_f32_16x16x32_bf16 v[108:111], v[60:63], a[16:19], v[108:111]
    ds_read_b64_tr_b16 a[0:1], v8 offset:33024
    ds_read_b64_tr_b16 a[2:3], v8 offset:34048
    v_mfma_f32_16x16x32_bf16 v[112:115], v[64:67], a[16:19], v[112:115]
    ds_read_b64_tr_b16 a[4:5], v8 offset:33056
    v_mfma_f32_16x16x32_bf16 v[116:119], v[60:63], a[20:23], v[116:119]
    ds_read_b64_tr_b16 a[6:7], v8 offset:34080
    ds_read_b64_tr_b16 a[8:9], v8 offset:41280
    v_mfma_f32_16x16x32_bf16 v[120:123], v[64:67], a[20:23], v[120:123]
    ds_read_b64_tr_b16 a[10:11], v8 offset:42304
    s_waitcnt lgkmcnt(7)
    v_mfma_f32_16x16x32_bf16 v[108:111], v[68:71], a[24:27], v[108:111]
    ds_read_b64_tr_b16 a[12:13], v8 offset:41312
    v_and_b32 v1, 1, v2
    v_cmp_eq_u32 vcc, 0, v1
    v_mfma_f32_16x16x32_bf16 v[112:115], v[72:75], a[24:27], v[112:115]
    ds_read_b64_tr_b16 a[14:15], v8 offset:42336
    v_mov_b32 v1, s18
    v_mov_b32 v0, s16
    v_mfma_f32_16x16x32_bf16 v[116:119], v[68:71], a[28:31], v[116:119]
    v_cndmask_b32 v3, v1, v0, vcc
    v_mov_b32 v127, v3
    v_mov_b32 v131, v3
    v_mfma_f32_16x16x32_bf16 v[120:123], v[72:75], a[28:31], v[120:123]
    v_mov_b32 v135, v3
    s_waitcnt lgkmcnt(3)
    v_mfma_f32_16x16x32_bf16 v[76:79], v[44:47], a[0:3], 0
    v_mfma_f32_16x16x32_bf16 v[80:83], v[48:51], a[0:3], 0
    ds_read_b64_tr_b16 a[16:17], v8 offset:49536
    v_mfma_f32_16x16x32_bf16 v[84:87], v[44:47], a[4:7], 0
    ds_read_b64_tr_b16 a[18:19], v8 offset:50560
    v_cvt_pk_bf16_f32 v108, v108, v109
    v_cvt_pk_bf16_f32 v109, v110, v111
    v_mfma_f32_16x16x32_bf16 v[88:91], v[48:51], a[4:7], 0
    ds_read_b64_tr_b16 a[20:21], v8 offset:49568
    v_cvt_pk_bf16_f32 v110, v112, v113
    v_cvt_pk_bf16_f32 v111, v114, v115
    s_waitcnt lgkmcnt(3)
    v_mfma_f32_16x16x32_bf16 v[76:79], v[52:55], a[8:11], v[76:79]
    ds_read_b64_tr_b16 a[22:23], v8 offset:50592
    v_cvt_pk_bf16_f32 v116, v116, v117
    v_cvt_pk_bf16_f32 v117, v118, v119
    v_mfma_f32_16x16x32_bf16 v[80:83], v[56:59], a[8:11], v[80:83]
    ds_read_b64_tr_b16 a[24:25], v8 offset:57792
    v_cvt_pk_bf16_f32 v118, v120, v121
    v_cvt_pk_bf16_f32 v119, v122, v123
    v_mfma_f32_16x16x32_bf16 v[84:87], v[52:55], a[12:15], v[84:87]
    ds_read_b64_tr_b16 a[26:27], v8 offset:58816
    v_mfma_f32_16x16x32_bf16 v[88:91], v[56:59], a[12:15], v[88:91]
    ds_read_b64_tr_b16 a[28:29], v8 offset:57824
    v_mfma_f32_16x16x32_bf16 a[68:71], v[108:111], a[32:35], a[68:71]
    ds_read_b64_tr_b16 a[30:31], v8 offset:58848
    v_mfma_f32_16x16x32_bf16 a[72:75], v[108:111], a[36:39], a[72:75]
    ds_read_b64_tr_b16 a[0:1], v9 offset:0
    v_mfma_f32_16x16x32_bf16 a[76:79], v[116:119], a[32:35], a[76:79]
    ds_read_b64_tr_b16 a[2:3], v9 offset:1024
    v_mfma_f32_16x16x32_bf16 a[80:83], v[116:119], a[36:39], a[80:83]
    ds_read_b64_tr_b16 a[4:5], v9 offset:32
    s_waitcnt lgkmcnt(5)
    v_mfma_f32_16x16x32_bf16 v[76:79], v[60:63], a[16:19], v[76:79]
    ds_read_b64_tr_b16 a[6:7], v9 offset:1056
    v_mfma_f32_16x16x32_bf16 v[80:83], v[64:67], a[16:19], v[80:83]
    ds_read_b64_tr_b16 a[8:9], v9 offset:8256
    v_mfma_f32_16x16x32_bf16 v[84:87], v[60:63], a[20:23], v[84:87]
    ds_read_b64_tr_b16 a[10:11], v9 offset:9280
    v_mfma_f32_16x16x32_bf16 v[88:91], v[64:67], a[20:23], v[88:91]
    ds_read_b64_tr_b16 a[12:13], v9 offset:8288
    v_mfma_f32_16x16x32_bf16 v[76:79], v[68:71], a[24:27], v[76:79]
    ds_read_b64_tr_b16 a[14:15], v9 offset:9312
    v_accvgpr_read_b32 v136, a68
    v_accvgpr_read_b32 v137, a69
    v_mfma_f32_16x16x32_bf16 v[80:83], v[72:75], a[24:27], v[80:83]
    v_cvt_pk_bf16_f32 v124, v136, v137
    v_accvgpr_read_b32 v138, a70
    v_accvgpr_read_b32 v139, a71
    s_waitcnt lgkmcnt(4)
    v_mfma_f32_16x16x32_bf16 v[84:87], v[68:71], a[28:31], v[84:87]
    v_cvt_pk_bf16_f32 v125, v138, v139
    v_accvgpr_read_b32 v136, a72
    v_accvgpr_read_b32 v137, a73
    v_mfma_f32_16x16x32_bf16 v[88:91], v[72:75], a[28:31], v[88:91]
    v_cvt_pk_bf16_f32 v126, v136, v137
    buffer_store_dwordx4 v[124:127], v10, s[64:67], s22 offen offset:0 sc1
    v_accvgpr_read_b32 v138, a74
    v_mfma_f32_16x16x32_bf16 v[92:95], v[12:15], a[0:3], 0
    v_accvgpr_read_b32 v139, a75
    v_cvt_pk_bf16_f32 v128, v138, v139
    v_accvgpr_read_b32 v136, a76
    v_mfma_f32_16x16x32_bf16 v[96:99], v[16:19], a[0:3], 0
    ds_read_b64_tr_b16 a[16:17], v9 offset:16512
    v_accvgpr_read_b32 v137, a77
    v_cvt_pk_bf16_f32 v129, v136, v137
    v_mfma_f32_16x16x32_bf16 v[100:103], v[12:15], a[4:7], 0
    ds_read_b64_tr_b16 a[18:19], v9 offset:17536
    v_accvgpr_read_b32 v138, a78
    v_accvgpr_read_b32 v139, a79
    v_mfma_f32_16x16x32_bf16 v[104:107], v[16:19], a[4:7], 0
    ds_read_b64_tr_b16 a[20:21], v9 offset:16544
    v_cvt_pk_bf16_f32 v130, v138, v139
    buffer_store_dwordx4 v[128:131], v10, s[64:67], s22 offen offset:1024 sc1
    s_waitcnt lgkmcnt(3)
    v_mfma_f32_16x16x32_bf16 v[92:95], v[20:23], a[8:11], v[92:95]
    ds_read_b64_tr_b16 a[22:23], v9 offset:17568
    v_accvgpr_read_b32 v136, a80
    v_accvgpr_read_b32 v137, a81
    v_mfma_f32_16x16x32_bf16 v[96:99], v[24:27], a[8:11], v[96:99]
    ds_read_b64_tr_b16 a[24:25], v9 offset:24768
    v_cvt_pk_bf16_f32 v132, v136, v137
    v_accvgpr_read_b32 v138, a82
    v_mfma_f32_16x16x32_bf16 v[100:103], v[20:23], a[12:15], v[100:103]
    ds_read_b64_tr_b16 a[26:27], v9 offset:25792
    v_accvgpr_read_b32 v139, a83
    v_cvt_pk_bf16_f32 v133, v138, v139
    v_mfma_f32_16x16x32_bf16 v[104:107], v[24:27], a[12:15], v[104:107]
    ds_read_b64_tr_b16 a[28:29], v9 offset:24800
    buffer_store_dwordx4 v[132:135], v10, s[64:67], s22 offen offset:2048 sc1
    v_cvt_pk_bf16_f32 v76, v76, v77
    v_cvt_pk_bf16_f32 v77, v78, v79
    v_cvt_pk_bf16_f32 v78, v80, v81
    v_cvt_pk_bf16_f32 v79, v82, v83
    s_nop 1
    v_mfma_f32_16x16x32_bf16 a[84:87], v[76:79], a[32:35], a[84:87]
    ds_read_b64_tr_b16 a[30:31], v9 offset:25824
    v_cvt_pk_bf16_f32 v84, v84, v85
    v_cvt_pk_bf16_f32 v85, v86, v87
    v_mfma_f32_16x16x32_bf16 a[88:91], v[76:79], a[36:39], a[88:91]
    ds_read_b64_tr_b16 a[0:1], v9 offset:33024
    v_cvt_pk_bf16_f32 v86, v88, v89
    v_cvt_pk_bf16_f32 v87, v90, v91
    s_nop 1
    v_mfma_f32_16x16x32_bf16 a[92:95], v[84:87], a[32:35], a[92:95]
    ds_read_b64_tr_b16 a[2:3], v9 offset:34048
    v_mfma_f32_16x16x32_bf16 a[96:99], v[84:87], a[36:39], a[96:99]
    ds_read_b64_tr_b16 a[4:5], v9 offset:33056
    s_waitcnt lgkmcnt(5)
    v_mfma_f32_16x16x32_bf16 v[92:95], v[28:31], a[16:19], v[92:95]
    ds_read_b64_tr_b16 a[6:7], v9 offset:34080
    v_mfma_f32_16x16x32_bf16 v[96:99], v[32:35], a[16:19], v[96:99]
    ds_read_b64_tr_b16 a[8:9], v9 offset:41280
    v_mfma_f32_16x16x32_bf16 v[100:103], v[28:31], a[20:23], v[100:103]
    ds_read_b64_tr_b16 a[10:11], v9 offset:42304
    v_mfma_f32_16x16x32_bf16 v[104:107], v[32:35], a[20:23], v[104:107]
    ds_read_b64_tr_b16 a[12:13], v9 offset:41312
    v_mfma_f32_16x16x32_bf16 v[92:95], v[36:39], a[24:27], v[92:95]
    ds_read_b64_tr_b16 a[14:15], v9 offset:42336
    v_accvgpr_read_b32 v136, a84
    v_accvgpr_read_b32 v137, a85
    v_mfma_f32_16x16x32_bf16 v[96:99], v[40:43], a[24:27], v[96:99]
    v_cvt_pk_bf16_f32 v124, v136, v137
    v_accvgpr_read_b32 v138, a86
    v_accvgpr_read_b32 v139, a87
    s_waitcnt lgkmcnt(4)
    v_mfma_f32_16x16x32_bf16 v[100:103], v[36:39], a[28:31], v[100:103]
    v_cvt_pk_bf16_f32 v125, v138, v139
    v_accvgpr_read_b32 v136, a88
    v_accvgpr_read_b32 v137, a89
    v_mfma_f32_16x16x32_bf16 v[104:107], v[40:43], a[28:31], v[104:107]
    v_cvt_pk_bf16_f32 v126, v136, v137
    buffer_store_dwordx4 v[124:127], v10, s[64:67], s23 offen offset:0 sc1
    v_accvgpr_read_b32 v138, a90
    v_mfma_f32_16x16x32_bf16 v[108:111], v[44:47], a[0:3], 0
    v_accvgpr_read_b32 v139, a91
    v_cvt_pk_bf16_f32 v128, v138, v139
    v_accvgpr_read_b32 v136, a92
    v_mfma_f32_16x16x32_bf16 v[112:115], v[48:51], a[0:3], 0
    ds_read_b64_tr_b16 a[16:17], v9 offset:49536
    v_accvgpr_read_b32 v137, a93
    v_cvt_pk_bf16_f32 v129, v136, v137
    v_mfma_f32_16x16x32_bf16 v[116:119], v[44:47], a[4:7], 0
    ds_read_b64_tr_b16 a[18:19], v9 offset:50560
    v_accvgpr_read_b32 v138, a94
    v_accvgpr_read_b32 v139, a95
    v_mfma_f32_16x16x32_bf16 v[120:123], v[48:51], a[4:7], 0
    ds_read_b64_tr_b16 a[20:21], v9 offset:49568
    v_cvt_pk_bf16_f32 v130, v138, v139
    buffer_store_dwordx4 v[128:131], v10, s[64:67], s23 offen offset:1024 sc1
    s_waitcnt lgkmcnt(3)
    v_mfma_f32_16x16x32_bf16 v[108:111], v[52:55], a[8:11], v[108:111]
    ds_read_b64_tr_b16 a[22:23], v9 offset:50592
    v_accvgpr_read_b32 v136, a96
    v_accvgpr_read_b32 v137, a97
    v_mfma_f32_16x16x32_bf16 v[112:115], v[56:59], a[8:11], v[112:115]
    ds_read_b64_tr_b16 a[24:25], v9 offset:57792
    v_cvt_pk_bf16_f32 v132, v136, v137
    v_accvgpr_read_b32 v138, a98
    v_mfma_f32_16x16x32_bf16 v[116:119], v[52:55], a[12:15], v[116:119]
    ds_read_b64_tr_b16 a[26:27], v9 offset:58816
    v_accvgpr_read_b32 v139, a99
    v_cvt_pk_bf16_f32 v133, v138, v139
    v_mfma_f32_16x16x32_bf16 v[120:123], v[56:59], a[12:15], v[120:123]
    ds_read_b64_tr_b16 a[28:29], v9 offset:57824
    buffer_store_dwordx4 v[132:135], v10, s[64:67], s23 offen offset:2048 sc1
    v_cvt_pk_bf16_f32 v92, v92, v93
    v_cvt_pk_bf16_f32 v93, v94, v95
    v_cvt_pk_bf16_f32 v94, v96, v97
    v_cvt_pk_bf16_f32 v95, v98, v99
    s_nop 1
    v_mfma_f32_16x16x32_bf16 a[100:103], v[92:95], a[44:47], a[100:103]
    ds_read_b64_tr_b16 a[30:31], v9 offset:58848
    v_cvt_pk_bf16_f32 v100, v100, v101
    v_cvt_pk_bf16_f32 v101, v102, v103
    v_mfma_f32_16x16x32_bf16 a[104:107], v[92:95], a[48:51], a[104:107]
    ds_read_b64_tr_b16 a[0:1], v6 offset:0
    v_cvt_pk_bf16_f32 v102, v104, v105
    v_cvt_pk_bf16_f32 v103, v106, v107
    s_nop 1
    v_mfma_f32_16x16x32_bf16 a[108:111], v[100:103], a[44:47], a[108:111]
    ds_read_b64_tr_b16 a[2:3], v6 offset:1024
    v_mfma_f32_16x16x32_bf16 a[112:115], v[100:103], a[48:51], a[112:115]
    ds_read_b64_tr_b16 a[4:5], v6 offset:32
    s_waitcnt lgkmcnt(5)
    v_mfma_f32_16x16x32_bf16 v[108:111], v[60:63], a[16:19], v[108:111]
    ds_read_b64_tr_b16 a[6:7], v6 offset:1056
    v_mfma_f32_16x16x32_bf16 v[112:115], v[64:67], a[16:19], v[112:115]
    ds_read_b64_tr_b16 a[8:9], v6 offset:8256
    v_mfma_f32_16x16x32_bf16 v[116:119], v[60:63], a[20:23], v[116:119]
    ds_read_b64_tr_b16 a[10:11], v6 offset:9280
    v_mfma_f32_16x16x32_bf16 v[120:123], v[64:67], a[20:23], v[120:123]
    ds_read_b64_tr_b16 a[12:13], v6 offset:8288
    v_mfma_f32_16x16x32_bf16 v[108:111], v[68:71], a[24:27], v[108:111]
    ds_read_b64_tr_b16 a[14:15], v6 offset:9312
    v_mfma_f32_16x16x32_bf16 v[112:115], v[72:75], a[24:27], v[112:115]
    s_waitcnt lgkmcnt(4)
    v_mfma_f32_16x16x32_bf16 v[116:119], v[68:71], a[28:31], v[116:119]
    v_mfma_f32_16x16x32_bf16 v[120:123], v[72:75], a[28:31], v[120:123]
    v_mfma_f32_16x16x32_bf16 v[76:79], v[12:15], a[0:3], 0
    v_mfma_f32_16x16x32_bf16 v[80:83], v[16:19], a[0:3], 0
    ds_read_b64_tr_b16 a[16:17], v6 offset:16512
    v_mfma_f32_16x16x32_bf16 v[84:87], v[12:15], a[4:7], 0
    ds_read_b64_tr_b16 a[18:19], v6 offset:17536
    v_cvt_pk_bf16_f32 v108, v108, v109
    v_cvt_pk_bf16_f32 v109, v110, v111
    v_mfma_f32_16x16x32_bf16 v[88:91], v[16:19], a[4:7], 0
    ds_read_b64_tr_b16 a[20:21], v6 offset:16544
    v_cvt_pk_bf16_f32 v110, v112, v113
    v_cvt_pk_bf16_f32 v111, v114, v115
    s_waitcnt lgkmcnt(3)
    v_mfma_f32_16x16x32_bf16 v[76:79], v[20:23], a[8:11], v[76:79]
    ds_read_b64_tr_b16 a[22:23], v6 offset:17568
    v_cvt_pk_bf16_f32 v116, v116, v117
    v_cvt_pk_bf16_f32 v117, v118, v119
    v_mfma_f32_16x16x32_bf16 v[80:83], v[24:27], a[8:11], v[80:83]
    ds_read_b64_tr_b16 a[24:25], v6 offset:24768
    v_cvt_pk_bf16_f32 v118, v120, v121
    v_cvt_pk_bf16_f32 v119, v122, v123
    v_mfma_f32_16x16x32_bf16 v[84:87], v[20:23], a[12:15], v[84:87]
    ds_read_b64_tr_b16 a[26:27], v6 offset:25792
    v_mfma_f32_16x16x32_bf16 v[88:91], v[24:27], a[12:15], v[88:91]
    ds_read_b64_tr_b16 a[28:29], v6 offset:24800
    v_mfma_f32_16x16x32_bf16 a[100:103], v[108:111], a[32:35], a[100:103]
    ds_read_b64_tr_b16 a[30:31], v6 offset:25824
    v_mfma_f32_16x16x32_bf16 a[104:107], v[108:111], a[36:39], a[104:107]
    ds_read_b64_tr_b16 a[0:1], v6 offset:33024
    v_mfma_f32_16x16x32_bf16 a[108:111], v[116:119], a[32:35], a[108:111]
    ds_read_b64_tr_b16 a[2:3], v6 offset:34048
    v_mfma_f32_16x16x32_bf16 a[112:115], v[116:119], a[36:39], a[112:115]
    ds_read_b64_tr_b16 a[4:5], v6 offset:33056
    s_waitcnt lgkmcnt(5)
    v_mfma_f32_16x16x32_bf16 v[76:79], v[28:31], a[16:19], v[76:79]
    ds_read_b64_tr_b16 a[6:7], v6 offset:34080
    v_mfma_f32_16x16x32_bf16 v[80:83], v[32:35], a[16:19], v[80:83]
    ds_read_b64_tr_b16 a[8:9], v6 offset:41280
    v_mfma_f32_16x16x32_bf16 v[84:87], v[28:31], a[20:23], v[84:87]
    ds_read_b64_tr_b16 a[10:11], v6 offset:42304
    v_mfma_f32_16x16x32_bf16 v[88:91], v[32:35], a[20:23], v[88:91]
    ds_read_b64_tr_b16 a[12:13], v6 offset:41312
    v_mfma_f32_16x16x32_bf16 v[76:79], v[36:39], a[24:27], v[76:79]
    ds_read_b64_tr_b16 a[14:15], v6 offset:42336
    v_accvgpr_read_b32 v136, a100
    v_accvgpr_read_b32 v137, a101
    v_mfma_f32_16x16x32_bf16 v[80:83], v[40:43], a[24:27], v[80:83]
    v_cvt_pk_bf16_f32 v124, v136, v137
    v_accvgpr_read_b32 v138, a102
    v_accvgpr_read_b32 v139, a103
    s_waitcnt lgkmcnt(4)
    v_mfma_f32_16x16x32_bf16 v[84:87], v[36:39], a[28:31], v[84:87]
    v_cvt_pk_bf16_f32 v125, v138, v139
    v_accvgpr_read_b32 v136, a104
    v_accvgpr_read_b32 v137, a105
    v_mfma_f32_16x16x32_bf16 v[88:91], v[40:43], a[28:31], v[88:91]
    v_cvt_pk_bf16_f32 v126, v136, v137
    buffer_store_dwordx4 v[124:127], v10, s[64:67], s24 offen offset:0 sc1
    v_accvgpr_read_b32 v138, a106
    v_mfma_f32_16x16x32_bf16 v[92:95], v[44:47], a[0:3], 0
    v_accvgpr_read_b32 v139, a107
    v_cvt_pk_bf16_f32 v128, v138, v139
    v_accvgpr_read_b32 v136, a108
    v_mfma_f32_16x16x32_bf16 v[96:99], v[48:51], a[0:3], 0
    ds_read_b64_tr_b16 a[16:17], v6 offset:49536
    v_accvgpr_read_b32 v137, a109
    v_cvt_pk_bf16_f32 v129, v136, v137
    v_mfma_f32_16x16x32_bf16 v[100:103], v[44:47], a[4:7], 0
    ds_read_b64_tr_b16 a[18:19], v6 offset:50560
    v_accvgpr_read_b32 v138, a110
    v_accvgpr_read_b32 v139, a111
    v_mfma_f32_16x16x32_bf16 v[104:107], v[48:51], a[4:7], 0
    ds_read_b64_tr_b16 a[20:21], v6 offset:49568
    v_cvt_pk_bf16_f32 v130, v138, v139
    buffer_store_dwordx4 v[128:131], v10, s[64:67], s24 offen offset:1024 sc1
    s_waitcnt lgkmcnt(3)
    v_mfma_f32_16x16x32_bf16 v[92:95], v[52:55], a[8:11], v[92:95]
    ds_read_b64_tr_b16 a[22:23], v6 offset:50592
    v_accvgpr_read_b32 v136, a112
    v_accvgpr_read_b32 v137, a113
    v_mfma_f32_16x16x32_bf16 v[96:99], v[56:59], a[8:11], v[96:99]
    ds_read_b64_tr_b16 a[24:25], v6 offset:57792
    v_cvt_pk_bf16_f32 v132, v136, v137
    v_accvgpr_read_b32 v138, a114
    v_mfma_f32_16x16x32_bf16 v[100:103], v[52:55], a[12:15], v[100:103]
    ds_read_b64_tr_b16 a[26:27], v6 offset:58816
    v_accvgpr_read_b32 v139, a115
    v_cvt_pk_bf16_f32 v133, v138, v139
    v_mfma_f32_16x16x32_bf16 v[104:107], v[56:59], a[12:15], v[104:107]
    ds_read_b64_tr_b16 a[28:29], v6 offset:57824
    buffer_store_dwordx4 v[132:135], v10, s[64:67], s24 offen offset:2048 sc1
    v_cvt_pk_bf16_f32 v76, v76, v77
    v_cvt_pk_bf16_f32 v77, v78, v79
    v_cvt_pk_bf16_f32 v78, v80, v81
    v_cvt_pk_bf16_f32 v79, v82, v83
    s_nop 1
    v_mfma_f32_16x16x32_bf16 a[52:55], v[76:79], a[44:47], a[52:55]
    ds_read_b64_tr_b16 a[30:31], v6 offset:58848
    v_cvt_pk_bf16_f32 v84, v84, v85
    v_cvt_pk_bf16_f32 v85, v86, v87
    v_mfma_f32_16x16x32_bf16 a[56:59], v[76:79], a[48:51], a[56:59]
    v_cvt_pk_bf16_f32 v86, v88, v89
    v_cvt_pk_bf16_f32 v87, v90, v91
    s_nop 1
    v_mfma_f32_16x16x32_bf16 a[60:63], v[84:87], a[44:47], a[60:63]
    v_mfma_f32_16x16x32_bf16 a[64:67], v[84:87], a[48:51], a[64:67]
    s_waitcnt lgkmcnt(2)
    v_mfma_f32_16x16x32_bf16 v[92:95], v[60:63], a[16:19], v[92:95]
    v_mfma_f32_16x16x32_bf16 v[96:99], v[64:67], a[16:19], v[96:99]
    buffer_load_dwordx4 v[12:15], v10, s[64:67], s25 offen offset:0 sc1
    buffer_load_dwordx4 v[16:19], v10, s[64:67], s25 offen offset:1024 sc1
    buffer_load_dwordx4 v[20:23], v10, s[64:67], s25 offen offset:2048 sc1
    v_mfma_f32_16x16x32_bf16 v[100:103], v[60:63], a[20:23], v[100:103]
    buffer_load_dwordx4 v[24:27], v10, s[64:67], s26 offen offset:0 sc1
    buffer_load_dwordx4 v[28:31], v10, s[64:67], s26 offen offset:1024 sc1
    buffer_load_dwordx4 v[32:35], v10, s[64:67], s26 offen offset:2048 sc1
    v_mfma_f32_16x16x32_bf16 v[104:107], v[64:67], a[20:23], v[104:107]
    v_mfma_f32_16x16x32_bf16 v[92:95], v[68:71], a[24:27], v[92:95]
    v_mfma_f32_16x16x32_bf16 v[96:99], v[72:75], a[24:27], v[96:99]
    s_waitcnt lgkmcnt(0)
    v_mfma_f32_16x16x32_bf16 v[100:103], v[68:71], a[28:31], v[100:103]
    v_mfma_f32_16x16x32_bf16 v[104:107], v[72:75], a[28:31], v[104:107]
    v_and_b32 v4, 15, v2
    v_lshlrev_b32 v4, 12, v4
    v_bfe_u32 v1, v2, 4, 1
    v_lshl_add_u32 v4, v1, 5, v4
    v_lshrrev_b32 v1, 5, v2
    v_lshl_add_u32 v4, v1, 4, v4
    s_mov_b32 s33, 1048576
    s_mov_b32 s34, 0xffff0000
    s_add_u32 s35, s29, 65536
    v_cvt_pk_bf16_f32 v92, v92, v93
    v_cvt_pk_bf16_f32 v93, v94, v95
    v_cvt_pk_bf16_f32 v94, v96, v97
    v_cvt_pk_bf16_f32 v95, v98, v99
    v_cvt_pk_bf16_f32 v100, v100, v101
    v_cvt_pk_bf16_f32 v101, v102, v103
    v_cvt_pk_bf16_f32 v102, v104, v105
    v_cvt_pk_bf16_f32 v103, v106, v107
    buffer_load_dwordx4 v[36:39], v10, s[64:67], s28 offen offset:0 sc1
    buffer_load_dwordx4 v[40:43], v10, s[64:67], s28 offen offset:1024 sc1
    buffer_load_dwordx4 v[124:127], v10, s[64:67], s28 offen offset:2048 sc1
    v_mfma_f32_16x16x32_bf16 a[52:55], v[92:95], a[32:35], a[52:55]
    v_mfma_f32_16x16x32_bf16 a[56:59], v[92:95], a[36:39], a[56:59]
    v_mfma_f32_16x16x32_bf16 a[60:63], v[100:103], a[32:35], a[60:63]
    v_mfma_f32_16x16x32_bf16 a[64:67], v[100:103], a[36:39], a[64:67]
    s_waitcnt vmcnt(6)
    s_branch XC0
XR0:
    s_sub_u32 s33, s33, 1
    s_cbranch_scc1 K_END
    buffer_load_dwordx4 v[12:15], v10, s[64:67], s25 offen offset:0 sc1
    buffer_load_dwordx4 v[16:19], v10, s[64:67], s25 offen offset:1024 sc1
    buffer_load_dwordx4 v[20:23], v10, s[64:67], s25 offen offset:2048 sc1
    s_waitcnt vmcnt(0)
XC0:
    v_xor_b32 v6, v15, v3
    v_xor_b32 v7, v19, v3
    v_xor_b32 v8, v23, v3
    v_or3_b32 v0, v6, v7, v8
    v_cmp_ne_u32 vcc, 0, v0
    s_cbranch_vccnz XR0
    v_lshlrev_b32 v108, 16, v12
    v_and_b32 v109, s34, v12
    v_lshlrev_b32 v110, 16, v13
    v_and_b32 v111, s34, v13
    v_lshlrev_b32 v112, 16, v14
    v_and_b32 v113, s34, v14
    v_lshlrev_b32 v114, 16, v16
    v_and_b32 v115, s34, v16
    v_lshlrev_b32 v116, 16, v17
    v_and_b32 v117, s34, v17
    v_lshlrev_b32 v118, 16, v18
    v_and_b32 v119, s34, v18
    v_lshlrev_b32 v120, 16, v20
    v_and_b32 v121, s34, v20
    v_lshlrev_b32 v122, 16, v21
    v_and_b32 v123, s34, v21
    s_waitcnt vmcnt(3)
    s_branch XC1
XR1:
    s_sub_u32 s33, s33, 1
    s_cbranch_scc1 K_END
    buffer_load_dwordx4 v[24:27], v10, s[64:67], s26 offen offset:0 sc1
    buffer_load_dwordx4 v[28:31], v10, s[64:67], s26 offen offset:1024 sc1
    buffer_load_dwordx4 v[32:35], v10, s[64:67], s26 offen offset:2048 sc1
    s_waitcnt vmcnt(0)
XC1:
    v_xor_b32 v6, v27, v3
    v_xor_b32 v7, v31, v3
    v_xor_b32 v8, v35, v3
    v_or3_b32 v0, v6, v7, v8
    v_cmp_ne_u32 vcc, 0, v0
    s_cbranch_vccnz XR1
    v_lshlrev_b32 v6, 16, v24
    v_and_b32 v7, s34, v24
    v_add_f32 v108, v108, v6
    v_add_f32 v109, v109, v7
    v_lshlrev_b32 v8, 16, v25
    v_and_b32 v9, s34, v25
    v_add_f32 v110, v110, v8
    v_add_f32 v111, v111, v9
    v_lshlrev_b32 v6, 16, v26
    v_and_b32 v7, s34, v26
    v_add_f32 v112, v112, v6
    v_add_f32 v113, v113, v7
    v_lshlrev_b32 v8, 16, v28
    v_and_b32 v9, s34, v28
    v_add_f32 v114, v114, v8
    v_add_f32 v115, v115, v9
    v_lshlrev_b32 v6, 16, v29
    v_and_b32 v7, s34, v29
    v_add_f32 v116, v116, v6
    v_add_f32 v117, v117, v7
    v_lshlrev_b32 v8, 16, v30
    v_and_b32 v9, s34, v30
    v_add_f32 v118, v118, v8
    v_add_f32 v119, v119, v9
    v_lshlrev_b32 v6, 16, v32
    v_and_b32 v7, s34, v32
    v_add_f32 v120, v120, v6
    v_add_f32 v121, v121, v7
    v_lshlrev_b32 v8, 16, v33
    v_and_b32 v9, s34, v33
    v_add_f32 v122, v122, v8
    v_add_f32 v123, v123, v9
    v_accvgpr_read_b32 v6, a52
    v_add_f32 v108, v108, v6
    v_accvgpr_read_b32 v7, a53
    v_add_f32 v109, v109, v7
    v_accvgpr_read_b32 v8, a54
    v_add_f32 v110, v110, v8
    v_accvgpr_read_b32 v9, a55
    v_add_f32 v111, v111, v9
    v_accvgpr_read_b32 v6, a56
    v_add_f32 v112, v112, v6
    v_accvgpr_read_b32 v7, a57
    v_add_f32 v113, v113, v7
    v_accvgpr_read_b32 v8, a58
    v_add_f32 v114, v114, v8
    v_accvgpr_read_b32 v9, a59
    v_add_f32 v115, v115, v9
    v_accvgpr_read_b32 v6, a60
    v_add_f32 v116, v116, v6
    v_accvgpr_read_b32 v7, a61
    v_add_f32 v117, v117, v7
    v_accvgpr_read_b32 v8, a62
    v_add_f32 v118, v118, v8
    v_accvgpr_read_b32 v9, a63
    v_add_f32 v119, v119, v9
    v_accvgpr_read_b32 v6, a64
    v_add_f32 v120, v120, v6
    v_accvgpr_read_b32 v7, a65
    v_add_f32 v121, v121, v7
    v_accvgpr_read_b32 v8, a66
    v_add_f32 v122, v122, v8
    v_accvgpr_read_b32 v9, a67
    v_add_f32 v123, v123, v9
    s_waitcnt vmcnt(0)
    s_branch XC2
XR2:
    s_sub_u32 s33, s33, 1
    s_cbranch_scc1 K_END
    buffer_load_dwordx4 v[36:39], v10, s[64:67], s28 offen offset:0 sc1
    buffer_load_dwordx4 v[40:43], v10, s[64:67], s28 offen offset:1024 sc1
    buffer_load_dwordx4 v[124:127], v10, s[64:67], s28 offen offset:2048 sc1
    s_waitcnt vmcnt(0)
XC2:
    v_xor_b32 v6, v39, v3
    v_xor_b32 v7, v43, v3
    v_xor_b32 v8, v127, v3
    v_or3_b32 v0, v6, v7, v8
    v_cmp_ne_u32 vcc, 0, v0
    s_cbranch_vccnz XR2
    v_lshlrev_b32 v6, 16, v36
    v_and_b32 v7, s34, v36
    v_add_f32 v108, v108, v6
    v_add_f32 v109, v109, v7
    v_lshlrev_b32 v8, 16, v37
    v_and_b32 v9, s34, v37
    v_add_f32 v110, v110, v8
    v_add_f32 v111, v111, v9
    v_lshlrev_b32 v6, 16, v38
    v_and_b32 v7, s34, v38
    v_add_f32 v112, v112, v6
    v_add_f32 v113, v113, v7
    v_lshlrev_b32 v8, 16, v40
    v_and_b32 v9, s34, v40
    v_add_f32 v114, v114, v8
    v_add_f32 v115, v115, v9
    v_lshlrev_b32 v6, 16, v41
    v_and_b32 v7, s34, v41
    v_add_f32 v116, v116, v6
    v_add_f32 v117, v117, v7
    v_lshlrev_b32 v8, 16, v42
    v_and_b32 v9, s34, v42
    v_add_f32 v118, v118, v8
    v_add_f32 v119, v119, v9
    v_lshlrev_b32 v6, 16, v124
    v_and_b32 v7, s34, v124
    v_add_f32 v120, v120, v6
    v_add_f32 v121, v121, v7
    v_lshlrev_b32 v8, 16, v125
    v_and_b32 v9, s34, v125
    v_add_f32 v122, v122, v8
    v_add_f32 v123, v123, v9
    v_cvt_pk_bf16_f32 v76, v108, v109
    v_cvt_pk_bf16_f32 v77, v110, v111
    v_cvt_pk_bf16_f32 v80, v112, v113
    v_cvt_pk_bf16_f32 v81, v114, v115
    v_cvt_pk_bf16_f32 v78, v116, v117
    v_cvt_pk_bf16_f32 v79, v118, v119
    v_cvt_pk_bf16_f32 v82, v120, v121
    v_cvt_pk_bf16_f32 v83, v122, v123
    s_nop 1
    v_permlane16_swap_b32 v76, v78
    v_permlane16_swap_b32 v77, v79
    v_permlane16_swap_b32 v80, v82
    v_permlane16_swap_b32 v81, v83
    s_nop 1
    buffer_store_dwordx4 v[76:79], v4, s[68:71], s29 offen
    buffer_store_dwordx4 v[80:83], v4, s[68:71], s35 offen
K_END:
    s_endpgm
.section .rodata,"a"
.p2align 6
.amdhsa_kernel concat_heads__mha_block_cached__gqa_block_cached__near_ridge_kernel
  .amdhsa_next_free_vgpr 256
  .amdhsa_next_free_sgpr 102
  .amdhsa_accum_offset 140
  .amdhsa_group_segment_fixed_size 0
  .amdhsa_kernarg_size 104
  .amdhsa_user_sgpr_count 2
  .amdhsa_user_sgpr_kernarg_segment_ptr 1
  .amdhsa_system_sgpr_workgroup_id_x 1
.end_amdhsa_kernel
```
